```python
import torch

def _softmax(x, axis=-1):
    return torch.softmax(x, dim=axis)
def _gelu(x):
    return torch.nn.functional.gelu(x, approximate="tanh")
def _silu(x):
    return torch.nn.functional.silu(x)
def _sigmoid(x):
    return torch.sigmoid(x)
def _layernorm(x, axis=-1, eps=1e-5):
    m = x.mean(dim=axis, keepdim=True)
    v = x.var(dim=axis, keepdim=True, unbiased=False)
    return (x - m) / torch.sqrt(v + eps)
def _scatter_add(tgt, idx, src, axis=0):
    return tgt.clone().index_add_(axis, idx, src)
def _segment_sum(src, seg, n):
    out = torch.zeros((n,) + src.shape[1:], dtype=src.dtype)
    return out.index_add_(0, seg, src)
def _pad(x, pw):
    flat = tuple(v for pair in reversed(pw) for v in pair)
    return torch.nn.functional.pad(x, flat)

kernel_name = 'concat_heads__linear_kernel_hedgehog__ssm_conv_s4d__prompt'

def setup_inputs():

    _w = (lambda a: (lambda t: t.to(torch.bfloat16) if t.is_floating_point() else t)(torch.as_tensor(a)))
    def _A_setup():
        B, S, D, H = 1, 2048, 1024, 32
        Dh = D // H
        return {
            "x": _w((lambda *s: torch.randn(*s, dtype=torch.bfloat16) * 0.4)(B, S, D)),
            "wqkv": _w((lambda *s: torch.randn(*s, dtype=torch.bfloat16) * 0.4)(D, 3 * D)),
            "w_phi": _w((lambda *s: torch.randn(*s, dtype=torch.bfloat16) * 0.4)(H, Dh, Dh) * (Dh ** -0.5)),
            "wo": _w((lambda *s: torch.randn(*s, dtype=torch.bfloat16) * 0.05)(D, D)),
        }
    _A_in = _A_setup()

    def _B_setup():
        Bsz, L, D, N = 1, 2048, 1024, 128
        return {
            "u": _w((lambda *s: torch.randn(*s, dtype=torch.bfloat16) * 0.05)(Bsz, L, D)),
            "log_A_real": _w((lambda *s: torch.randn(*s, dtype=torch.bfloat16) * 3.2)(D, N) * 0.5),
            "A_imag": _w((lambda *s: torch.randn(*s, dtype=torch.bfloat16) * 0.2)(D, N) * 3.14),
            "C_real": _w((lambda *s: torch.randn(*s, dtype=torch.bfloat16) * 3.2)(D, N) / N ** 0.5),
            "C_imag": _w((lambda *s: torch.randn(*s, dtype=torch.bfloat16) * 3.2)(D, N) / N ** 0.5),
            "log_dt": _w((lambda *s: torch.randn(*s, dtype=torch.bfloat16) * 0.2)(D) * 0.5 - 4.0),
            "D_skip": _w((lambda *s: torch.randn(*s, dtype=torch.bfloat16) * 0.2)(D)),
        }
    _B_in = _B_setup()

    return {
        "A_x": _A_in["x"],
        "A_wqkv": _A_in["wqkv"],
        "A_w_phi": _A_in["w_phi"],
        "A_wo": _A_in["wo"],
        "B_u": _B_in["u"],
        "B_log_A_real": _B_in["log_A_real"],
        "B_A_imag": _B_in["A_imag"],
        "B_C_real": _B_in["C_real"],
        "B_C_imag": _B_in["C_imag"],
        "B_log_dt": _B_in["log_dt"],
        "B_D_skip": _B_in["D_skip"],
    }

def reference(A_x, A_wqkv, A_w_phi, A_wo, B_u, B_log_A_real, B_A_imag, B_C_real, B_C_imag, B_log_dt, B_D_skip):
    def _A_ref(x, wqkv, w_phi, wo):
        B, S, D = x.shape
        H = 32; Dh = D // H
        qkv = (lambda x, *d: x.permute(*d))((x @ wqkv).reshape(B, S, 3, H, Dh), 2, 0, 3, 1, 4)
        q, k, v = qkv[0], qkv[1], qkv[2]
        pq = torch.einsum("bhsd,hdf->bhsf", q, w_phi)
        pk = torch.einsum("bhsd,hdf->bhsf", k, w_phi)
        phi_q = torch.concatenate([_softmax(pq, axis=-1), _softmax(-pq, axis=-1)], axis=-1)
        phi_k = torch.concatenate([_softmax(pk, axis=-1), _softmax(-pk, axis=-1)], axis=-1)
        kv = torch.einsum("bhsf,bhsd->bhfd", phi_k, v)
        z  = torch.einsum("bhsf->bhf", phi_k)
        num = torch.einsum("bhqf,bhfd->bhqd", phi_q, kv)
        den = torch.einsum("bhqf,bhf->bhq", phi_q, z)[..., None] + 1e-6
        o = num / den
        return (lambda x, *d: x.permute(*d))(o, 0, 2, 1, 3).reshape(B, S, D) @ wo

    def _B_ref(u, log_A_real, A_imag, C_real, C_imag, log_dt, D_skip):
        L = u.shape[1]
        dt = torch.exp(log_dt)
        A = -torch.exp(log_A_real) + 1j * A_imag
        C = (C_real + 1j * C_imag) * dt[:, None]
        pos = (lambda x, dt: x.to(dt))(torch.arange(L), log_dt.dtype)
        P = torch.exp((A * dt[:, None])[:, :, None] * pos[None, None, :])
        K = 2.0 * torch.einsum("dn,dnl->dl", C, P).real
        L2 = 2 * L
        u_t = (lambda x, *d: x.permute(*d))(u, 0, 2, 1)
        Kf = (lambda x, *a, **k: torch.fft.rfft(x.float(), *a, **k))(K, L2)
        Uf = (lambda x, *a, **k: torch.fft.rfft(x.float(), *a, **k))(u_t, L2)
        y = (lambda x, *a, **k: torch.fft.irfft(x, *a, **k).to(torch.bfloat16))(Uf * Kf[None, :, :], L2)[:, :, :L]
        y = (lambda x, *d: x.permute(*d))(y, 0, 2, 1)
        return y + u * D_skip[None, None, :]

    a = _A_ref(A_x, A_wqkv, A_w_phi, A_wo)
    b = _B_ref(B_u, B_log_A_real, B_A_imag, B_C_real, B_C_imag, B_log_dt, B_D_skip)
    return torch.concatenate([a, b], axis=-1)
```

```asm
; @launch grid=(256,1,1) block=(256,1,1) lds=163840
.amdgcn_target "amdgcn-amd-amdhsa--gfx950"
.text
.p2align 12
.fill 832, 4, 0xbf810000
.globl concat_heads__linear_kernel_hedgehog__ssm_conv_s4d__prompt_kernel
.p2align 8
.type concat_heads__linear_kernel_hedgehog__ssm_conv_s4d__prompt_kernel,@function
concat_heads__linear_kernel_hedgehog__ssm_conv_s4d__prompt_kernel:
  s_cmp_ge_u32 s2, 256
  s_cbranch_scc1 L_end
  s_load_dwordx4 s[36:39], s[0:1], 72
  s_load_dwordx4 s[28:31], s[0:1], 40
  s_load_dwordx4 s[32:35], s[0:1], 56
  s_load_dwordx2 s[4:5], s[0:1], 0
  s_load_dwordx2 s[8:9], s[0:1], 8
  s_getpc_b64 s[42:43]
L_pc:
  s_lshr_b32 s61, s2, 3
  s_lshl_b32 s61, s61, 11
  v_lshrrev_b32 v4, 4, v0
  v_lshl_add_u32 v4, v4, 7, s61
  v_min_u32 v4, L_codeend-L_pc-4, v4
  global_load_dword v6, v4, s[42:43]
  v_lshrrev_b32 v2, 6, v0
  v_and_b32 v1, 63, v0
  v_readfirstlane_b32 s59, v2
  s_bfe_u32 s61, s2, 0x30003
  s_lshr_b32 s62, s2, 6
  s_and_b32 s57, s2, 1
  s_lshl3_add_u32 s57, s57, s61
  s_and_b32 s58, s2, 6
  s_lshl1_add_u32 s58, s58, s62
  s_cmp_eq_u32 s58, 1
  s_cselect_b32 s63, 11, s58
  s_cmp_eq_u32 s58, 11
  s_cselect_b32 s58, 1, s63
  s_lshl4_add_u32 s72, s58, s57
  s_xor_b32 s73, s72, 16
  s_lshl_b32 s63, s73, 10
  v_lshl_add_u32 v14, v0, 2, s63
  s_lshl_b32 s63, s73, 3
  v_lshl_add_u32 v15, v2, 1, s63
  s_xor_b32 s73, s58, 1
  s_mul_i32 s60, s61, 4
  s_mul_i32 s63, s62, 12
  s_add_u32 s60, s60, s63
  s_mov_b32 s74, 0x76543210
  s_sub_u32 s63, 0, s60
  s_lshl_b32 s76, s74, s63
  s_lshr_b32 s74, s74, s60
  s_or_b32 s74, s74, s76
  s_add_u32 s63, s61, s62
  s_and_b32 s63, s63, 1
  s_mul_i32 s63, s63, 0x11111111
  s_xor_b32 s75, s63, 0xfedcba98
  s_lshr_b32 s63, s2, 1
  s_xor_b32 s63, s63, s2
  s_and_b32 s63, s63, 1
  s_mul_i32 s63, s63, 0x88888888
  s_xor_b32 s74, s74, s63
  s_xor_b32 s75, s75, s63
  s_lshl2_add_u32 s61, s57, s59
  s_lshl_b32 s64, s61, 16
  s_lshl_b32 s66, s59, 12
  v_lshrrev_b32 v2, 3, v1
  v_lshrrev_b32 v3, 4, v1
  v_and_b32 v4, 7, v1
  v_xor_b32 v5, v3, v4
  v_lshlrev_b32 v5, 4, v5
  v_lshl_add_u32 v16, v2, 11, v5
  v_add_u32 v16, s64, v16
  v_xor_b32 v17, 64, v16
  v_add_u32 v17, 15360, v17
  v_add_u32 v18, 30720, v16
  v_add_u32 v19, 30720, v17
  s_mov_b32 s6, 4194304
  s_mov_b32 s7, 0x20000
  s_mov_b32 s56, 393216
  s_mov_b32 s55, 65536
  s_lshr_b32 s61, s59, 1
  s_add_u32 s61, s61, 1
  s_lshl4_add_u32 s61, s61, s58
  s_lshl_b32 s61, s61, 7
  s_and_b32 s62, s59, 1
  s_mul_i32 s62, s62, 196608
  s_add_u32 s67, s61, s62
  v_and_b32_e64 v3, 1, v3
  v_lshlrev_b32_e64 v3, 1, v3
  v_xor_b32_e64 v5, v3, v4
  v_lshlrev_b32_e64 v5, 4, v5
  v_mul_u32_u24 v3, 6144, v2
  v_add3_u32 v20, v3, v5, s67
  v_xor_b32_e64 v21, 64, v20
  v_add_u32 v21, 48128, v21
  v_add_u32 v22, 96256, v20
  v_add_u32 v23, 96256, v21
  s_mov_b32 s10, 6291456
  s_mov_b32 s11, 0x20000
  s_bfe_u32 s63, s74, 0x40000
  s_lshl_b32 s65, s63, 7
  s_add_u32 m0, s66, L_z2-L_z1+0
  s_waitcnt lgkmcnt(0)
  global_load_ushort v12, v15, s[36:37]
  global_load_dword v8, v14, s[28:29] nt
  global_load_dword v9, v14, s[30:31] nt
  global_load_dword v10, v14, s[32:33] nt
  global_load_dword v11, v14, s[34:35] nt
  global_load_ushort v13, v15, s[38:39]
  buffer_load_dwordx4 v16, s[4:7], s65 offen offset:0  lds
  buffer_load_dwordx4 v17, s[4:7], s65 offen offset:1024  lds
  s_load_dwordx2 s[24:25], s[0:1], 104
  s_load_dwordx2 s[16:17], s[0:1], 32
  s_load_dwordx2 s[40:41], s[0:1], 16
  s_load_dwordx2 s[12:13], s[0:1], 24
  s_load_dwordx2 s[20:21], s[0:1], 88
  s_load_dwordx2 s[44:45], s[0:1], 96
  v_lshl_add_u32 v24, v2, 11, v5
  v_xor_b32 v25, 64, v24
  v_add_u32 v25, 15360, v25
  s_mov_b32 s26, 268435456
  s_mov_b32 s27, s7
  s_mov_b32 s48, 1069066811
  buffer_load_dwordx4 v18, s[4:7], s65 offen offset:2048  lds
  s_mov_b32 s49, s48
  s_movk_i32 s54, 2048
  s_movk_i32 s53, 16383
  s_movk_i32 s52, 4096
  s_movk_i32 s51, 16384
  s_mov_b32 s50, 32768
  s_mov_b32 s3, 4294901760
  v_mov_b32 v26, -1
  v_mov_b32 v27, -1
  v_mov_b32 v28, -1
  v_mov_b32 v29, -1
  s_lshl_b32 s78, s72, 9
  s_add_u32 s78, s78, 11403328
  s_lshl_b32 s80, s72, 2
  s_add_u32 s80, s80, s59
  s_lshl_b32 s80, s80, L_z2-L_z1+7
  buffer_load_dwordx4 v19, s[4:7], s65 offen offset:3072  lds
  s_add_u32 s80, s80, 11403264
  s_lshr_b32 s79, s64, 12
  s_add_u32 s79, s79, s58
  s_lshl_b32 s79, s79, L_z2-L_z1+7
  s_add_u32 s79, s79, 11141120
  s_lshl2_add_u32 s62, s72, s59
  s_lshl_b32 s70, s62, 7
  s_add_u32 s70, s70, 11010048
  s_lshl_b32 s62, s62, L_z2-L_z1+9
  s_add_u32 s62, s62, 10485760
  v_lshl_add_u32 v30, v1, 4, s62
  v_and_b32 v32, 7, v1
  v_lshlrev_b32 v32, 4, v32
  s_add_u32 s62, s79, s7
  v_cmp_gt_u32 vcc, 32, v1
  v_add_u32 v31, s70, v32
  s_mul_i32 s65, s63, s56
  s_add_u32 m0, s66, s51
  s_nop 0
  buffer_load_dwordx4 v20, s[8:11], s65 offen offset:0  lds
  v_cndmask_b32 v30, v31, v30, vcc
  v_cmp_gt_u32 vcc, 40, v1
  v_add_u32 v31, s79, v32
  s_nop 0
  v_cndmask_b32 v30, v31, v30, vcc
  v_cmp_gt_u32 vcc, 48, v1
  v_add_u32 v31, s80, v32
  s_nop 0
  v_cndmask_b32 v30, v31, v30, vcc
  v_cmp_gt_u32 vcc, 56, v1
  v_add_u32 v31, s62, v32
  s_nop 0
  v_cndmask_b32 v30, v31, v30, vcc
  s_waitcnt lgkmcnt(0)
  v_and_b32 v2, 15, v1
  v_lshrrev_b32 v3, 1, v2
  v_lshrrev_b32 v4, 4, v1
  v_xor_b32 v3, v3, v4
  v_lshlrev_b32 v2, 7, v2
  buffer_load_dwordx4 v21, s[8:11], s65 offen offset:1024  lds
  v_lshl_add_u32 v2, v3, 4, v2
  v_add_u32 v33, s66, v2
  v_xor_b32 v34, 64, v33
  v_xor_b32 v35, s52, v33
  v_xor_b32 v36, s52, v34
  v_add_u32 v37, s55, v33
  v_add_u32 v38, s55, v34
  v_add_u32 v39, s55, v35
  v_add_u32 v40, s55, v36
  v_lshrrev_b32 v2, 4, v1
  v_bfe_u32 v3, v1, 2, 2
  v_lshl_add_u32 v4, v2, 3, v3
  v_lshlrev_b32 v4, 7, v4
  v_bfe_u32 v2, v1, 3, 2
  v_lshl_add_u32 v4, v2, 5, v4
  v_and_b32 v2, 3, v1
  buffer_load_dwordx4 v22, s[8:11], s65 offen offset:2048  lds
  v_lshl_add_u32 v14, v2, 3, v4
  s_and_b32 s61, s59, 1
  s_lshl_b32 s61, s61, 6
  s_add_u32 s61, s61, s51
  v_xor_b32 v41, s61, v14
  v_xor_b32 v42, 32, v41
  v_add_u32 v43, s55, v41
  v_add_u32_e64 v44, s55, v42
  s_mul_i32 s61, s59, 8704
  s_add_u32 s61, s61, 98304
  v_lshl_add_u32 v15, v1, 3, s61
  v_and_b32 v96, 15, v1
  v_lshrrev_b32 v97, 4, v1
  v_lshl_add_u32 v46, v97, 4, s61
  v_mul_u32_u24 v45, 544, v96
  v_add_u32_e64 v45, v46, v45
  buffer_load_dwordx4 v23, s[8:11], s65 offen offset:3072  lds
  s_mul_i32 s81, s59, 3200
  s_add_u32 s81, s81, 149760
  v_lshl_add_u32 v47, v1, 4, s81
  v_mov_b32 v102, 0
  v_mov_b32 v103, 0
  v_mov_b32 v104, 0
  v_mov_b32 v105, 0
  v_lshrrev_b32_e64 v99, 5, v1
  v_lshl_add_u32 v98, v99, 4, v96
  v_lshlrev_b32 v98, 1, v98
  v_and_b32 v101, 1, v97
  v_add_u32 v98, v98, v101
  v_lshlrev_b32 v98, 3, v98
  s_add_u32 s61, s81, 568
  v_sub_u32 v98, s61, v98
  v_lshl_add_u32 v99, v101, 1, v99
  v_lshrrev_b32 v101, 1, v96
  v_lshl_add_u32 v99, v99, 3, v101
  v_lshlrev_b32 v99, 2, v99
  v_and_b32 v101, 1, v96
  s_add_u32 s61, s81, 2524
  v_sub_u32 v99, s61, v99
  v_lshl_add_u32 v100, v101, 1, v99
  v_lshl_add_u32 v99, v101, 8, v99
  v_mov_b32 v101, s81
  ds_write_b128 v47, v[102:105] offset:0
  ds_write_b128 v47, v[102:105] offset:1024
  ds_write_b128 v47, v[102:105] offset:2048
  ds_write_b128 v47, v[102:105] offset:2176
  v_cmp_eq_u32 vcc, 0, v1
  s_mov_b64 exec, 0
  s_cmp_eq_u32 s59, 0
  s_cbranch_scc1 L_pg1
  s_cmp_eq_u32 s59, 1
  s_cbranch_scc1 L_pg2
  s_cmp_eq_u32 s59, 2
  s_cbranch_scc1 L_pg3
  s_branch L_pg4
L_back_prm:
  s_mov_b64 exec, -1
  s_bfe_u32 s63, s74, 0x40004
  s_lshl_b32 s65, s63, 7
  s_add_u32 m0, s66, 32768
  s_nop 0
  buffer_load_dwordx4 v16, s[4:7], s65 offen offset:0  lds
  buffer_load_dwordx4 v17, s[4:7], s65 offen offset:1024  lds
  buffer_load_dwordx4 v18, s[4:7], s65 offen offset:2048  lds
  buffer_load_dwordx4 v19, s[4:7], s65 offen offset:3072  lds
  s_waitcnt vmcnt(14)
  v_lshlrev_b32 v118, 16, v10
  s_waitcnt vmcnt(13)
  v_lshlrev_b32 v119, 16, v11
  v_and_b32 v132, s3, v10
  v_and_b32 v133, s3, v11
  v_max3_f32 v110, abs(v118), abs(v119), abs(v132)
  v_max_f32_e64 v110, v110, abs(v133)
  v_lshlrev_b32 v106, 16, v12
  v_mul_f32 v108, s48, v106
  v_lshlrev_b32 v111, 16, v8
  v_and_b32 v127, s3, v8
  v_max_f32_dpp v110, v110, v110 row_ror:8 row_mask:0xf bank_mask:0xf
  v_exp_f32 v108, v108
  v_mul_f32 v115, s48, v111
  v_mul_f32 v129, s48, v127
  v_exp_f32 v115, v115
  v_exp_f32_e64 v129, v129
  v_max_f32_dpp v110, v110, v110 row_ror:4 row_mask:0xf bank_mask:0xf
  v_cvt_pk_bf16_f32 v106, v108, v108
  v_and_b32 v106, s3, v106
  v_cvt_pk_bf16_f32 v111, v115, v115
  v_lshlrev_b32 v114, 16, v9
  v_cvt_pk_bf16_f32 v127, v129, v129
  v_and_b32 v128, s3, v9
  v_and_b32 v111, s3, v111
  v_mul_f32 v114, v114, v106
  v_and_b32 v127, s3, v127
  v_mul_f32 v128, v128, v106
  v_max_f32_dpp v110, v110, v110 row_ror:2 row_mask:0xf bank_mask:0xf
  v_mul_f32 v111, v111, v106
  v_mul_f32 v114, 0.15915494, v114
  v_mul_f32 v127, v127, v106
  v_mul_f32 v128, 0.15915494, v128
  v_mul_f32 v111, 0xbfb8aa3b, v111
  v_fract_f32 v122, v114
  v_mul_f32 v127, 0xbfb8aa3b, v127
  v_fract_f32 v136, v128
  v_exp_f32 v117, v111
  v_cos_f32_e64 v120, v122
  v_sin_f32_e64 v121, v122
  v_exp_f32_e64 v131, v127
  v_cos_f32_e64 v134, v136
  v_sin_f32_e64 v135, v136
  v_max_f32_dpp v110, v110, v110 row_ror:1 row_mask:0xf bank_mask:0xf
  v_mul_f32_e64 v120, v120, v117
  v_readlane_b32 s82, v110, 0
  v_readlane_b32 s83, v110, 16
  v_mul_f32_e64 v121, v121, v117
  v_mul_f32_e64 v134, v134, v131
  v_mul_f32 v135, v135, v131
  v_readlane_b32 s84, v110, 32
  v_readlane_b32 s85, v110, 48
  s_max_u32 s82, s82, s83
  v_pk_mul_f32 v[150:151], v[120:121], v[120:121] op_sel:[0,0] op_sel_hi:[0,1]
  v_pk_mul_f32 v[184:185], v[134:135], v[134:135] op_sel:[0,0] op_sel_hi:[0,1]
  s_max_u32 s84, s84, s85
  v_pk_fma_f32 v[150:151], v[120:121], v[120:121], v[150:151] op_sel:[1,1,0] op_sel_hi:[1,0,1] neg_lo:[1,0,0]
  v_pk_fma_f32 v[184:185], v[134:135], v[134:135], v[184:185] op_sel:[1,1,0] op_sel_hi:[1,0,1] neg_lo:[1,0,0]
  s_max_u32 s82, s82, s84
  v_pk_mul_f32 v[186:187], v[150:151], v[150:151] op_sel:[0,0] op_sel_hi:[0,1]
  v_pk_mul_f32 v[188:189], v[184:185], v[184:185] op_sel:[0,0] op_sel_hi:[0,1]
  s_and_b32 s82, s82, 0x7f800000
  v_pk_fma_f32 v[186:187], v[150:151], v[150:151], v[186:187] op_sel:[1,1,0] op_sel_hi:[1,0,1] neg_lo:[1,0,0]
  v_pk_fma_f32 v[188:189], v[184:185], v[184:185], v[188:189] op_sel:[1,1,0] op_sel_hi:[1,0,1] neg_lo:[1,0,0]
  s_sub_u32 s83, 0x7f000000, s82
  v_pk_mul_f32 v[190:191], v[186:187], v[186:187] op_sel:[0,0] op_sel_hi:[0,1]
  v_pk_mul_f32 v[192:193], v[188:189], v[188:189] op_sel:[0,0] op_sel_hi:[0,1]
  v_mul_f32 v118, s83, v118
  v_mul_f32 v119, s83, v119
  v_mul_f32 v132, s83, v132
  v_mul_f32 v133, s83, v133
  v_pk_fma_f32 v[190:191], v[186:187], v[186:187], v[190:191] op_sel:[1,1,0] op_sel_hi:[1,0,1] neg_lo:[1,0,0]
  v_pk_fma_f32 v[192:193], v[188:189], v[188:189], v[192:193] op_sel:[1,1,0] op_sel_hi:[1,0,1] neg_lo:[1,0,0]
  v_pk_mul_f32 v[194:195], v[190:191], v[190:191] op_sel:[0,0] op_sel_hi:[0,1]
  v_pk_mul_f32 v[196:197], v[192:193], v[192:193] op_sel:[0,0] op_sel_hi:[0,1]
  v_pk_mul_f32 v[198:199], v[118:119], v[190:191] op_sel:[0,0] op_sel_hi:[0,1]
  v_pk_mul_f32 v[200:201], v[132:133], v[192:193] op_sel:[0,0] op_sel_hi:[0,1]
  v_pk_fma_f32 v[194:195], v[190:191], v[190:191], v[194:195] op_sel:[1,1,0] op_sel_hi:[1,0,1] neg_lo:[1,0,0]
  v_pk_fma_f32 v[196:197], v[192:193], v[192:193], v[196:197] op_sel:[1,1,0] op_sel_hi:[1,0,1] neg_lo:[1,0,0]
  v_pk_fma_f32 v[198:199], v[118:119], v[190:191], v[198:199] op_sel:[1,1,0] op_sel_hi:[1,0,1] neg_lo:[1,0,0]
  v_pk_fma_f32 v[200:201], v[132:133], v[192:193], v[200:201] op_sel:[1,1,0] op_sel_hi:[1,0,1] neg_lo:[1,0,0]
  v_pk_mul_f32 v[202:203], v[118:119], v[194:195] op_sel:[0,0] op_sel_hi:[0,1]
  v_pk_mul_f32 v[204:205], v[132:133], v[196:197] op_sel:[0,0] op_sel_hi:[0,1]
  v_pk_mul_f32 v[206:207], v[198:199], v[194:195] op_sel:[0,0] op_sel_hi:[0,1]
  v_pk_mul_f32 v[208:209], v[200:201], v[196:197] op_sel:[0,0] op_sel_hi:[0,1]
  v_pk_fma_f32 v[202:203], v[118:119], v[194:195], v[202:203] op_sel:[1,1,0] op_sel_hi:[1,0,1] neg_lo:[1,0,0]
  v_pk_fma_f32 v[204:205], v[132:133], v[196:197], v[204:205] op_sel:[1,1,0] op_sel_hi:[1,0,1] neg_lo:[1,0,0]
  v_pk_fma_f32 v[206:207], v[198:199], v[194:195], v[206:207] op_sel:[1,1,0] op_sel_hi:[1,0,1] neg_lo:[1,0,0]
  v_pk_fma_f32 v[208:209], v[200:201], v[196:197], v[208:209] op_sel:[1,1,0] op_sel_hi:[1,0,1] neg_lo:[1,0,0]
  v_cvt_pk_f16_f32 v142, v118, -v119
  v_cvt_pk_f16_f32 v143, v132, -v133
  v_cvt_pk_f16_f32 v144, v198, -v199
  v_cvt_pk_f16_f32 v145, v200, -v201
  v_cvt_pk_f16_f32 v146, v202, -v203
  v_cvt_pk_f16_f32 v147, v204, -v205
  v_cvt_pk_f16_f32 v148, v206, -v207
  v_cvt_pk_f16_f32 v149, v208, -v209
  ds_write_b64 v15, v[142:143] offset:0
  ds_write_b64 v15, v[144:145] offset:544
  ds_write_b64 v15, v[146:147] offset:1088
  ds_write_b64 v15, v[148:149] offset:1632
  v_pk_mul_f32 v[118:119], v[202:203], v[194:195] op_sel:[0,0] op_sel_hi:[0,1]
  v_pk_mul_f32 v[132:133], v[204:205], v[196:197] op_sel:[0,0] op_sel_hi:[0,1]
  v_pk_mul_f32 v[198:199], v[206:207], v[194:195] op_sel:[0,0] op_sel_hi:[0,1]
  v_pk_mul_f32 v[200:201], v[208:209], v[196:197] op_sel:[0,0] op_sel_hi:[0,1]
  v_pk_fma_f32 v[118:119], v[202:203], v[194:195], v[118:119] op_sel:[1,1,0] op_sel_hi:[1,0,1] neg_lo:[1,0,0]
  v_pk_fma_f32 v[132:133], v[204:205], v[196:197], v[132:133] op_sel:[1,1,0] op_sel_hi:[1,0,1] neg_lo:[1,0,0]
  v_pk_fma_f32 v[198:199], v[206:207], v[194:195], v[198:199] op_sel:[1,1,0] op_sel_hi:[1,0,1] neg_lo:[1,0,0]
  v_pk_fma_f32 v[200:201], v[208:209], v[196:197], v[200:201] op_sel:[1,1,0] op_sel_hi:[1,0,1] neg_lo:[1,0,0]
  v_pk_mul_f32 v[202:203], v[118:119], v[194:195] op_sel:[0,0] op_sel_hi:[0,1]
  v_pk_mul_f32 v[204:205], v[132:133], v[196:197] op_sel:[0,0] op_sel_hi:[0,1]
  v_pk_mul_f32 v[206:207], v[198:199], v[194:195] op_sel:[0,0] op_sel_hi:[0,1]
  v_pk_mul_f32 v[208:209], v[200:201], v[196:197] op_sel:[0,0] op_sel_hi:[0,1]
  v_pk_fma_f32 v[202:203], v[118:119], v[194:195], v[202:203] op_sel:[1,1,0] op_sel_hi:[1,0,1] neg_lo:[1,0,0]
  v_pk_fma_f32 v[204:205], v[132:133], v[196:197], v[204:205] op_sel:[1,1,0] op_sel_hi:[1,0,1] neg_lo:[1,0,0]
  v_pk_fma_f32 v[206:207], v[198:199], v[194:195], v[206:207] op_sel:[1,1,0] op_sel_hi:[1,0,1] neg_lo:[1,0,0]
  v_pk_fma_f32 v[208:209], v[200:201], v[196:197], v[208:209] op_sel:[1,1,0] op_sel_hi:[1,0,1] neg_lo:[1,0,0]
  v_cvt_pk_f16_f32 v142, v118, -v119
  v_cvt_pk_f16_f32 v143, v132, -v133
  v_cvt_pk_f16_f32 v144, v198, -v199
  v_cvt_pk_f16_f32 v145, v200, -v201
  v_cvt_pk_f16_f32 v146, v202, -v203
  v_cvt_pk_f16_f32 v147, v204, -v205
  v_cvt_pk_f16_f32 v148, v206, -v207
  v_cvt_pk_f16_f32 v149, v208, -v209
  ds_write_b64 v15, v[142:143] offset:2176
  ds_write_b64 v15, v[144:145] offset:2720
  ds_write_b64 v15, v[146:147] offset:3264
  ds_write_b64 v15, v[148:149] offset:3808
  v_pk_mul_f32 v[118:119], v[202:203], v[194:195] op_sel:[0,0] op_sel_hi:[0,1]
  v_pk_mul_f32 v[132:133], v[204:205], v[196:197] op_sel:[0,0] op_sel_hi:[0,1]
  v_pk_mul_f32 v[198:199], v[206:207], v[194:195] op_sel:[0,0] op_sel_hi:[0,1]
  v_pk_mul_f32 v[200:201], v[208:209], v[196:197] op_sel:[0,0] op_sel_hi:[0,1]
  v_pk_fma_f32 v[118:119], v[202:203], v[194:195], v[118:119] op_sel:[1,1,0] op_sel_hi:[1,0,1] neg_lo:[1,0,0]
  v_pk_fma_f32 v[132:133], v[204:205], v[196:197], v[132:133] op_sel:[1,1,0] op_sel_hi:[1,0,1] neg_lo:[1,0,0]
  v_pk_fma_f32 v[198:199], v[206:207], v[194:195], v[198:199] op_sel:[1,1,0] op_sel_hi:[1,0,1] neg_lo:[1,0,0]
  v_pk_fma_f32 v[200:201], v[208:209], v[196:197], v[200:201] op_sel:[1,1,0] op_sel_hi:[1,0,1] neg_lo:[1,0,0]
  v_pk_mul_f32 v[202:203], v[118:119], v[194:195] op_sel:[0,0] op_sel_hi:[0,1]
  v_pk_mul_f32 v[204:205], v[132:133], v[196:197] op_sel:[0,0] op_sel_hi:[0,1]
  v_pk_mul_f32 v[206:207], v[198:199], v[194:195] op_sel:[0,0] op_sel_hi:[0,1]
  v_pk_mul_f32 v[208:209], v[200:201], v[196:197] op_sel:[0,0] op_sel_hi:[0,1]
  v_pk_fma_f32 v[202:203], v[118:119], v[194:195], v[202:203] op_sel:[1,1,0] op_sel_hi:[1,0,1] neg_lo:[1,0,0]
  v_pk_fma_f32 v[204:205], v[132:133], v[196:197], v[204:205] op_sel:[1,1,0] op_sel_hi:[1,0,1] neg_lo:[1,0,0]
  v_pk_fma_f32 v[206:207], v[198:199], v[194:195], v[206:207] op_sel:[1,1,0] op_sel_hi:[1,0,1] neg_lo:[1,0,0]
  v_pk_fma_f32 v[208:209], v[200:201], v[196:197], v[208:209] op_sel:[1,1,0] op_sel_hi:[1,0,1] neg_lo:[1,0,0]
  v_cvt_pk_f16_f32 v142, v118, -v119
  v_cvt_pk_f16_f32 v143, v132, -v133
  v_cvt_pk_f16_f32 v144, v198, -v199
  v_cvt_pk_f16_f32 v145, v200, -v201
  v_cvt_pk_f16_f32 v146, v202, -v203
  v_cvt_pk_f16_f32 v147, v204, -v205
  v_cvt_pk_f16_f32 v148, v206, -v207
  v_cvt_pk_f16_f32 v149, v208, -v209
  ds_write_b64 v15, v[142:143] offset:4352
  ds_write_b64 v15, v[144:145] offset:4896
  ds_write_b64 v15, v[146:147] offset:5440
  ds_write_b64 v15, v[148:149] offset:5984
  v_pk_mul_f32 v[118:119], v[202:203], v[194:195] op_sel:[0,0] op_sel_hi:[0,1]
  v_pk_mul_f32 v[132:133], v[204:205], v[196:197] op_sel:[0,0] op_sel_hi:[0,1]
  v_pk_mul_f32 v[198:199], v[206:207], v[194:195] op_sel:[0,0] op_sel_hi:[0,1]
  v_pk_mul_f32 v[200:201], v[208:209], v[196:197] op_sel:[0,0] op_sel_hi:[0,1]
  v_pk_fma_f32 v[118:119], v[202:203], v[194:195], v[118:119] op_sel:[1,1,0] op_sel_hi:[1,0,1] neg_lo:[1,0,0]
  v_pk_fma_f32 v[132:133], v[204:205], v[196:197], v[132:133] op_sel:[1,1,0] op_sel_hi:[1,0,1] neg_lo:[1,0,0]
  v_pk_fma_f32 v[198:199], v[206:207], v[194:195], v[198:199] op_sel:[1,1,0] op_sel_hi:[1,0,1] neg_lo:[1,0,0]
  v_pk_fma_f32 v[200:201], v[208:209], v[196:197], v[200:201] op_sel:[1,1,0] op_sel_hi:[1,0,1] neg_lo:[1,0,0]
  v_pk_mul_f32 v[202:203], v[118:119], v[194:195] op_sel:[0,0] op_sel_hi:[0,1]
  v_pk_mul_f32 v[204:205], v[132:133], v[196:197] op_sel:[0,0] op_sel_hi:[0,1]
  v_pk_mul_f32 v[206:207], v[198:199], v[194:195] op_sel:[0,0] op_sel_hi:[0,1]
  v_pk_mul_f32 v[208:209], v[200:201], v[196:197] op_sel:[0,0] op_sel_hi:[0,1]
  v_pk_fma_f32 v[202:203], v[118:119], v[194:195], v[202:203] op_sel:[1,1,0] op_sel_hi:[1,0,1] neg_lo:[1,0,0]
  v_pk_fma_f32 v[204:205], v[132:133], v[196:197], v[204:205] op_sel:[1,1,0] op_sel_hi:[1,0,1] neg_lo:[1,0,0]
  v_pk_fma_f32 v[206:207], v[198:199], v[194:195], v[206:207] op_sel:[1,1,0] op_sel_hi:[1,0,1] neg_lo:[1,0,0]
  v_pk_fma_f32 v[208:209], v[200:201], v[196:197], v[208:209] op_sel:[1,1,0] op_sel_hi:[1,0,1] neg_lo:[1,0,0]
  v_cvt_pk_f16_f32 v142, v118, -v119
  v_cvt_pk_f16_f32 v143, v132, -v133
  v_cvt_pk_f16_f32 v144, v198, -v199
  v_cvt_pk_f16_f32 v145, v200, -v201
  v_cvt_pk_f16_f32 v146, v202, -v203
  v_cvt_pk_f16_f32 v147, v204, -v205
  v_cvt_pk_f16_f32 v148, v206, -v207
  v_cvt_pk_f16_f32 v149, v208, -v209
  ds_write_b64 v15, v[142:143] offset:6528
  ds_write_b64 v15, v[144:145] offset:7072
  ds_write_b64 v15, v[146:147] offset:7616
  ds_write_b64 v15, v[148:149] offset:8160
  ds_read_b128 v[152:155], v45 offset:0
  ds_read_b128 v[156:159], v45 offset:64
  ds_read_b128 v[160:163], v45 offset:128
  ds_read_b128 v[164:167], v45 offset:192
  ds_read_b128 v[168:171], v45 offset:256
  ds_read_b128 v[172:175], v45 offset:320
  ds_read_b128 v[176:179], v45 offset:384
  ds_read_b128 v[180:183], v45 offset:448
  v_pk_mul_f32 v[118:119], v[150:151], v[120:121] op_sel:[0,0] op_sel_hi:[0,1]
  v_pk_mul_f32 v[132:133], v[184:185], v[134:135] op_sel:[0,0] op_sel_hi:[0,1]
  v_pk_fma_f32 v[118:119], v[150:151], v[120:121], v[118:119] op_sel:[1,1,0] op_sel_hi:[1,0,1] neg_lo:[1,0,0]
  v_pk_fma_f32 v[132:133], v[184:185], v[134:135], v[132:133] op_sel:[1,1,0] op_sel_hi:[1,0,1] neg_lo:[1,0,0]
  v_mov_b32 v142, 0x3c00
  v_mov_b32 v143, 0x3c00
  v_cvt_pk_f16_f32 v144, v120, v121
  v_cvt_pk_f16_f32 v145, v134, v135
  v_cvt_pk_f16_f32 v146, v150, v151
  v_cvt_pk_f16_f32 v147, v184, v185
  v_cvt_pk_f16_f32 v148, v118, v119
  v_cvt_pk_f16_f32 v149, v132, v133
  ds_write_b64 v15, v[142:143] offset:0
  ds_write_b64 v15, v[144:145] offset:544
  ds_write_b64 v15, v[146:147] offset:1088
  ds_write_b64 v15, v[148:149] offset:1632
  v_pk_mul_f32 v[194:195], v[186:187], v[120:121] op_sel:[0,0] op_sel_hi:[0,1]
  v_pk_mul_f32 v[196:197], v[188:189], v[134:135] op_sel:[0,0] op_sel_hi:[0,1]
  v_pk_mul_f32 v[198:199], v[186:187], v[150:151] op_sel:[0,0] op_sel_hi:[0,1]
  v_pk_mul_f32 v[200:201], v[188:189], v[184:185] op_sel:[0,0] op_sel_hi:[0,1]
  v_pk_mul_f32 v[202:203], v[186:187], v[118:119] op_sel:[0,0] op_sel_hi:[0,1]
  buffer_store_dwordx4 v[26:29], v30, s[24:27], 0 offen sc1
  s_mul_i32 s65, s63, s56
  s_add_u32 m0, s66, 49152
  s_nop 0
  buffer_load_dwordx4 v20, s[8:11], s65 offen offset:0  lds
  buffer_load_dwordx4 v21, s[8:11], s65 offen offset:1024  lds
  v_pk_mul_f32 v[204:205], v[188:189], v[132:133] op_sel:[0,0] op_sel_hi:[0,1]
  v_pk_fma_f32 v[194:195], v[186:187], v[120:121], v[194:195] op_sel:[1,1,0] op_sel_hi:[1,0,1] neg_lo:[1,0,0]
  v_pk_fma_f32 v[196:197], v[188:189], v[134:135], v[196:197] op_sel:[1,1,0] op_sel_hi:[1,0,1] neg_lo:[1,0,0]
  v_pk_fma_f32 v[198:199], v[186:187], v[150:151], v[198:199] op_sel:[1,1,0] op_sel_hi:[1,0,1] neg_lo:[1,0,0]
  v_pk_fma_f32 v[200:201], v[188:189], v[184:185], v[200:201] op_sel:[1,1,0] op_sel_hi:[1,0,1] neg_lo:[1,0,0]
  v_pk_fma_f32 v[202:203], v[186:187], v[118:119], v[202:203] op_sel:[1,1,0] op_sel_hi:[1,0,1] neg_lo:[1,0,0]
  v_pk_fma_f32 v[204:205], v[188:189], v[132:133], v[204:205] op_sel:[1,1,0] op_sel_hi:[1,0,1] neg_lo:[1,0,0]
  v_cvt_pk_f16_f32 v142, v186, v187
  v_cvt_pk_f16_f32 v143, v188, v189
  v_cvt_pk_f16_f32 v144, v194, v195
  v_cvt_pk_f16_f32 v145, v196, v197
  v_cvt_pk_f16_f32 v146, v198, v199
  v_cvt_pk_f16_f32 v147, v200, v201
  v_cvt_pk_f16_f32 v148, v202, v203
  v_cvt_pk_f16_f32 v149, v204, v205
  ds_write_b64 v15, v[142:143] offset:2176
  ds_write_b64 v15, v[144:145] offset:2720
  ds_write_b64 v15, v[146:147] offset:3264
  ds_write_b64 v15, v[148:149] offset:3808
  v_mul_f32 v126, 0x43000000, v114
  v_mul_f32 v140, 0x43000000, v128
  v_mul_f32 v123, 0x43000000, v111
  v_fract_f32 v126, v126
  v_mul_f32 v137, 0x43000000, v127
  v_fract_f32 v140, v140
  v_exp_f32 v123, v123
  v_cos_f32 v124, v126
  v_sin_f32 v125, v126
  v_exp_f32 v137, v137
  v_cos_f32 v138, v140
  v_sin_f32 v139, v140
  v_mul_f32_e64 v124, v124, v123
  v_mul_f32_e64 v125, v125, v123
  v_mul_f32_e64 v138, v138, v137
  v_mul_f32_e64 v139, v139, v137
  v_pk_mul_f32 v[118:119], v[124:125], v[124:125] op_sel:[0,0] op_sel_hi:[0,1]
  v_pk_mul_f32 v[120:121], v[138:139], v[138:139] op_sel:[0,0] op_sel_hi:[0,1]
  v_pk_fma_f32 v[118:119], v[124:125], v[124:125], v[118:119] op_sel:[1,1,0] op_sel_hi:[1,0,1] neg_lo:[1,0,0]
  v_pk_fma_f32 v[120:121], v[138:139], v[138:139], v[120:121] op_sel:[1,1,0] op_sel_hi:[1,0,1] neg_lo:[1,0,0]
  v_pk_mul_f32 v[132:133], v[118:119], v[118:119] op_sel:[0,0] op_sel_hi:[0,1]
  v_pk_mul_f32 v[134:135], v[120:121], v[120:121] op_sel:[0,0] op_sel_hi:[0,1]
  v_pk_fma_f32 v[132:133], v[118:119], v[118:119], v[132:133] op_sel:[1,1,0] op_sel_hi:[1,0,1] neg_lo:[1,0,0]
  v_pk_fma_f32 v[134:135], v[120:121], v[120:121], v[134:135] op_sel:[1,1,0] op_sel_hi:[1,0,1] neg_lo:[1,0,0]
  v_pk_mul_f32 v[150:151], v[132:133], v[186:187] op_sel:[0,0] op_sel_hi:[0,1]
  v_pk_mul_f32 v[184:185], v[134:135], v[188:189] op_sel:[0,0] op_sel_hi:[0,1]
  v_pk_fma_f32 v[150:151], v[132:133], v[186:187], v[150:151] op_sel:[1,1,0] op_sel_hi:[1,0,1] neg_lo:[1,0,0]
  v_pk_fma_f32 v[184:185], v[134:135], v[188:189], v[184:185] op_sel:[1,1,0] op_sel_hi:[1,0,1] neg_lo:[1,0,0]
  v_cvt_pk_f16_f32 v142, v124, v125
  v_cvt_pk_f16_f32 v143, v138, v139
  v_cvt_pk_f16_f32 v144, v118, -v119
  v_cvt_pk_f16_f32 v145, v120, -v121
  v_cvt_pk_f16_f32 v146, v132, v133
  v_cvt_pk_f16_f32 v147, v134, v135
  v_cvt_pk_f16_f32 v148, v150, v151
  v_cvt_pk_f16_f32 v149, v184, v185
  ds_write_b64 v15, v[142:143] offset:7616
  ds_write_b64 v15, v[144:145] offset:8160
  ds_write_b64 v15, v[146:147] offset:6528
  ds_write_b64 v15, v[148:149] offset:4352
  v_pk_mul_f32 v[194:195], v[132:133], v[190:191] op_sel:[0,0] op_sel_hi:[0,1]
  v_pk_mul_f32 v[196:197], v[134:135], v[192:193] op_sel:[0,0] op_sel_hi:[0,1]
  v_pk_fma_f32 v[194:195], v[132:133], v[190:191], v[194:195] op_sel:[1,1,0] op_sel_hi:[1,0,1] neg_lo:[1,0,0]
  v_pk_fma_f32 v[196:197], v[134:135], v[192:193], v[196:197] op_sel:[1,1,0] op_sel_hi:[1,0,1] neg_lo:[1,0,0]
  v_pk_mul_f32 v[198:199], v[194:195], v[132:133] op_sel:[0,0] op_sel_hi:[0,1]
  v_pk_mul_f32 v[200:201], v[196:197], v[134:135] op_sel:[0,0] op_sel_hi:[0,1]
  v_pk_fma_f32 v[198:199], v[194:195], v[132:133], v[198:199] op_sel:[1,1,0] op_sel_hi:[1,0,1] neg_lo:[1,0,0]
  v_pk_fma_f32 v[200:201], v[196:197], v[134:135], v[200:201] op_sel:[1,1,0] op_sel_hi:[1,0,1] neg_lo:[1,0,0]
  v_pk_mul_f32 v[202:203], v[198:199], v[132:133] op_sel:[0,0] op_sel_hi:[0,1]
  v_pk_mul_f32 v[204:205], v[200:201], v[134:135] op_sel:[0,0] op_sel_hi:[0,1]
  v_pk_fma_f32 v[202:203], v[198:199], v[132:133], v[202:203] op_sel:[1,1,0] op_sel_hi:[1,0,1] neg_lo:[1,0,0]
  v_pk_fma_f32 v[204:205], v[200:201], v[134:135], v[204:205] op_sel:[1,1,0] op_sel_hi:[1,0,1] neg_lo:[1,0,0]
  v_cvt_pk_f16_f32 v142, v194, v195
  v_cvt_pk_f16_f32 v143, v196, v197
  v_cvt_pk_f16_f32 v144, v198, v199
  v_cvt_pk_f16_f32 v145, v200, v201
  v_cvt_pk_f16_f32 v146, v202, v203
  v_cvt_pk_f16_f32 v147, v204, v205
  ds_write_b64 v15, v[142:143] offset:4896
  ds_write_b64 v15, v[144:145] offset:5440
  ds_write_b64 v15, v[146:147] offset:5984
  ds_read_b128 v[196:199], v45 offset:0
  ds_read_b128 v[200:203], v46 offset:7616
  ds_read_b128 v[204:207], v46 offset:8160
  ds_read_b128 v[208:211], v45 offset:64
  ds_read_b128 v[212:215], v46 offset:7680
  ds_read_b128 v[216:219], v46 offset:8224
  buffer_load_dwordx4 v22, s[8:11], s65 offen offset:2048  lds
  s_waitcnt vmcnt(16)
  v_lshlrev_b32 v107, 16, v13
  v_add_f32_e64 v112, v106, v106
  v_cndmask_b32_e64 v107, 0, v107, vcc
  v_mul_f32 v112, s82, v112
  s_waitcnt lgkmcnt(3)
  v_pk_mul_f16 v232, v196, v200 op_sel:[0,0] op_sel_hi:[0,1]
  v_pk_mul_f16 v233, v197, v201 op_sel:[0,0] op_sel_hi:[0,1]
  v_pk_mul_f16 v234, v198, v202 op_sel:[0,0] op_sel_hi:[0,1]
  v_pk_mul_f16 v235, v199, v203 op_sel:[0,0] op_sel_hi:[0,1]
  v_pk_fma_f16 v232, v196, v200, v232 op_sel:[1,1,0] op_sel_hi:[1,0,1] neg_lo:[1,0,0]
  v_pk_fma_f16 v233, v197, v201, v233 op_sel:[1,1,0] op_sel_hi:[1,0,1] neg_lo:[1,0,0]
  v_pk_fma_f16 v234, v198, v202, v234 op_sel:[1,1,0] op_sel_hi:[1,0,1] neg_lo:[1,0,0]
  v_pk_fma_f16 v235, v199, v203, v235 op_sel:[1,1,0] op_sel_hi:[1,0,1] neg_lo:[1,0,0]
  v_pk_mul_f16 v236, v152, v204 op_sel:[0,0] op_sel_hi:[0,1]
  v_pk_mul_f16 v237, v153, v205 op_sel:[0,0] op_sel_hi:[0,1]
  v_pk_mul_f16 v238, v154, v206 op_sel:[0,0] op_sel_hi:[0,1]
  v_pk_mul_f16 v239, v155, v207 op_sel:[0,0] op_sel_hi:[0,1]
  v_pk_fma_f16 v236, v152, v204, v236 op_sel:[1,1,0] op_sel_hi:[1,0,1] neg_lo:[1,0,0]
  v_pk_fma_f16 v237, v153, v205, v237 op_sel:[1,1,0] op_sel_hi:[1,0,1] neg_lo:[1,0,0]
  v_pk_fma_f16 v238, v154, v206, v238 op_sel:[1,1,0] op_sel_hi:[1,0,1] neg_lo:[1,0,0]
  v_pk_fma_f16 v239, v155, v207, v239 op_sel:[1,1,0] op_sel_hi:[1,0,1] neg_lo:[1,0,0]
  s_waitcnt lgkmcnt(0)
  v_mfma_f32_16x16x32_f16 v[132:135], v[196:199], v[152:155], 0
  v_pk_mul_f16 v240, v208, v212 op_sel:[0,0] op_sel_hi:[0,1]
  s_nop 0
  v_pk_mul_f16 v241, v209, v213 op_sel:[0,0] op_sel_hi:[0,1]
  v_pk_mul_f16 v242, v210, v214 op_sel:[0,0] op_sel_hi:[0,1]
  v_pk_mul_f16 v243, v211, v215 op_sel:[0,0] op_sel_hi:[0,1]
  v_mfma_f32_16x16x32_f16 v[184:187], v[232:235], v[152:155], 0
  ds_read_b128 v[220:223], v45 offset:128
  buffer_load_dwordx4 v23, s[8:11], s65 offen offset:3072  lds
  v_pk_fma_f16 v240, v208, v212, v240 op_sel:[1,1,0] op_sel_hi:[1,0,1] neg_lo:[1,0,0]
  v_pk_fma_f16 v241, v209, v213, v241 op_sel:[1,1,0] op_sel_hi:[1,0,1] neg_lo:[1,0,0]
  v_pk_fma_f16 v242, v210, v214, v242 op_sel:[1,1,0] op_sel_hi:[1,0,1] neg_lo:[1,0,0]
  v_pk_fma_f16 v243, v211, v215, v243 op_sel:[1,1,0] op_sel_hi:[1,0,1] neg_lo:[1,0,0]
  v_mfma_f32_16x16x32_f16 v[188:191], v[196:199], v[236:239], 0
  ds_read_b128 v[224:227], v46 offset:7744
  s_bfe_u32 s63, s74, 0x40008
  v_pk_mul_f16 v244, v156, v216 op_sel:[0,0] op_sel_hi:[0,1]
  v_pk_mul_f16 v245, v157, v217 op_sel:[0,0] op_sel_hi:[0,1]
  v_pk_mul_f16 v246, v158, v218 op_sel:[0,0] op_sel_hi:[0,1]
  v_pk_mul_f16 v247, v159, v219 op_sel:[0,0] op_sel_hi:[0,1]
  v_mfma_f32_16x16x32_f16 v[192:195], v[232:235], v[236:239], 0
  ds_read_b128 v[228:231], v46 offset:8288
  s_lshl_b32 s65, s63, L_z2-L_z1+7
  v_pk_fma_f16 v244, v156, v216, v244 op_sel:[1,1,0] op_sel_hi:[1,0,1] neg_lo:[1,0,0]
  v_pk_fma_f16 v245, v157, v217, v245 op_sel:[1,1,0] op_sel_hi:[1,0,1] neg_lo:[1,0,0]
  v_pk_fma_f16 v246, v158, v218, v246 op_sel:[1,1,0] op_sel_hi:[1,0,1] neg_lo:[1,0,0]
  v_pk_fma_f16 v247, v159, v219, v247 op_sel:[1,1,0] op_sel_hi:[1,0,1] neg_lo:[1,0,0]
  s_waitcnt lgkmcnt(0)
  v_mfma_f32_16x16x32_f16 v[132:135], v[208:211], v[156:159], v[132:135]
  s_add_u32 m0, s66, s55
  v_pk_mul_f16 v232, v220, v224 op_sel:[0,0] op_sel_hi:[0,1]
  v_pk_mul_f16 v233, v221, v225 op_sel:[0,0] op_sel_hi:[0,1]
  v_pk_mul_f16 v234, v222, v226 op_sel:[0,0] op_sel_hi:[0,1]
  v_pk_mul_f16 v235, v223, v227 op_sel:[0,0] op_sel_hi:[0,1]
L_pg1:
  s_cbranch_execz L_back_prm
  v_mfma_f32_16x16x32_f16 v[184:187], v[240:243], v[156:159], v[184:187]
  s_nop 0
  ds_read_b128 v[196:199], v45 offset:192
  buffer_load_dwordx4 v16, s[4:7], s65 offen offset:0  lds
  v_pk_fma_f16 v232, v220, v224, v232 op_sel:[1,1,0] op_sel_hi:[1,0,1] neg_lo:[1,0,0]
  v_pk_fma_f16 v233, v221, v225, v233 op_sel:[1,1,0] op_sel_hi:[1,0,1] neg_lo:[1,0,0]
  v_pk_fma_f16 v234, v222, v226, v234 op_sel:[1,1,0] op_sel_hi:[1,0,1] neg_lo:[1,0,0]
  v_pk_fma_f16 v235, v223, v227, v235 op_sel:[1,1,0] op_sel_hi:[1,0,1] neg_lo:[1,0,0]
  v_mfma_f32_16x16x32_f16 v[188:191], v[208:211], v[244:247], v[188:191]
  ds_read_b128 v[200:203], v46 offset:7808
  v_pk_mul_f16 v236, v160, v228 op_sel:[0,0] op_sel_hi:[0,1]
  v_pk_mul_f16 v237, v161, v229 op_sel:[0,0] op_sel_hi:[0,1]
  v_pk_mul_f16 v238, v162, v230 op_sel:[0,0] op_sel_hi:[0,1]
  v_pk_mul_f16 v239, v163, v231 op_sel:[0,0] op_sel_hi:[0,1]
  v_mfma_f32_16x16x32_f16 v[192:195], v[240:243], v[244:247], v[192:195]
  ds_read_b128 v[204:207], v46 offset:8352
  buffer_load_dwordx4 v17, s[4:7], s65 offen offset:1024  lds
  v_pk_fma_f16 v236, v160, v228, v236 op_sel:[1,1,0] op_sel_hi:[1,0,1] neg_lo:[1,0,0]
  v_pk_fma_f16 v237, v161, v229, v237 op_sel:[1,1,0] op_sel_hi:[1,0,1] neg_lo:[1,0,0]
  v_pk_fma_f16 v238, v162, v230, v238 op_sel:[1,1,0] op_sel_hi:[1,0,1] neg_lo:[1,0,0]
  v_pk_fma_f16 v239, v163, v231, v239 op_sel:[1,1,0] op_sel_hi:[1,0,1] neg_lo:[1,0,0]
  s_waitcnt lgkmcnt(0)
  s_nop 0
  v_mfma_f32_16x16x32_f16 v[132:135], v[220:223], v[160:163], v[132:135]
  v_pk_mul_f16 v240, v196, v200 op_sel:[0,0] op_sel_hi:[0,1]
  v_pk_mul_f16 v241, v197, v201 op_sel:[0,0] op_sel_hi:[0,1]
  v_pk_mul_f16 v242, v198, v202 op_sel:[0,0] op_sel_hi:[0,1]
  v_pk_mul_f16 v243, v199, v203 op_sel:[0,0] op_sel_hi:[0,1]
  v_mfma_f32_16x16x32_f16 v[184:187], v[232:235], v[160:163], v[184:187]
  ds_read_b128 v[208:211], v45 offset:256
  buffer_load_dwordx4 v18, s[4:7], s65 offen offset:2048  lds
  v_pk_fma_f16 v240, v196, v200, v240 op_sel:[1,1,0] op_sel_hi:[1,0,1] neg_lo:[1,0,0]
  v_pk_fma_f16 v241, v197, v201, v241 op_sel:[1,1,0] op_sel_hi:[1,0,1] neg_lo:[1,0,0]
  v_pk_fma_f16 v242, v198, v202, v242 op_sel:[1,1,0] op_sel_hi:[1,0,1] neg_lo:[1,0,0]
  v_pk_fma_f16 v243, v199, v203, v243 op_sel:[1,1,0] op_sel_hi:[1,0,1] neg_lo:[1,0,0]
  v_mfma_f32_16x16x32_f16 v[188:191], v[220:223], v[236:239], v[188:191]
  ds_read_b128 v[212:215], v46 offset:7872
  v_pk_mul_f16 v244, v164, v204 op_sel:[0,0] op_sel_hi:[0,1]
  v_pk_mul_f16 v245, v165, v205 op_sel:[0,0] op_sel_hi:[0,1]
  v_pk_mul_f16 v246, v166, v206 op_sel:[0,0] op_sel_hi:[0,1]
  v_pk_mul_f16 v247, v167, v207 op_sel:[0,0] op_sel_hi:[0,1]
  v_mfma_f32_16x16x32_f16 v[192:195], v[232:235], v[236:239], v[192:195]
  ds_read_b128 v[216:219], v46 offset:8416
  buffer_load_dwordx4 v19, s[4:7], s65 offen offset:3072  lds
  v_pk_fma_f16 v244, v164, v204, v244 op_sel:[1,1,0] op_sel_hi:[1,0,1] neg_lo:[1,0,0]
  v_pk_fma_f16 v245, v165, v205, v245 op_sel:[1,1,0] op_sel_hi:[1,0,1] neg_lo:[1,0,0]
  v_pk_fma_f16 v246, v166, v206, v246 op_sel:[1,1,0] op_sel_hi:[1,0,1] neg_lo:[1,0,0]
  v_pk_fma_f16 v247, v167, v207, v247 op_sel:[1,1,0] op_sel_hi:[1,0,1] neg_lo:[1,0,0]
  s_waitcnt lgkmcnt(0)
  v_mfma_f32_16x16x32_f16 v[132:135], v[196:199], v[164:167], v[132:135]
  s_mul_i32 s65, s63, s56
  v_pk_mul_f16 v232, v208, v212 op_sel:[0,0] op_sel_hi:[0,1]
  v_pk_mul_f16 v233, v209, v213 op_sel:[0,0] op_sel_hi:[0,1]
  v_pk_mul_f16 v234, v210, v214 op_sel:[0,0] op_sel_hi:[0,1]
  v_pk_mul_f16 v235, v211, v215 op_sel:[0,0] op_sel_hi:[0,1]
  v_mfma_f32_16x16x32_f16 v[184:187], v[240:243], v[164:167], v[184:187]
  ds_read_b128 v[220:223], v45 offset:320
  s_add_u32 m0, s66, 81920
  v_pk_fma_f16 v232, v208, v212, v232 op_sel:[1,1,0] op_sel_hi:[1,0,1] neg_lo:[1,0,0]
  v_pk_fma_f16 v233, v209, v213, v233 op_sel:[1,1,0] op_sel_hi:[1,0,1] neg_lo:[1,0,0]
  v_pk_fma_f16 v234, v210, v214, v234 op_sel:[1,1,0] op_sel_hi:[1,0,1] neg_lo:[1,0,0]
  v_pk_fma_f16 v235, v211, v215, v235 op_sel:[1,1,0] op_sel_hi:[1,0,1] neg_lo:[1,0,0]
  v_mfma_f32_16x16x32_f16 v[188:191], v[196:199], v[244:247], v[188:191]
  ds_read_b128 v[224:227], v46 offset:7936
  buffer_load_dwordx4 v20, s[8:11], s65 offen offset:0  lds
  v_pk_mul_f16 v236, v168, v216 op_sel:[0,0] op_sel_hi:[0,1]
  v_pk_mul_f16 v237, v169, v217 op_sel:[0,0] op_sel_hi:[0,1]
  v_pk_mul_f16 v238, v170, v218 op_sel:[0,0] op_sel_hi:[0,1]
  v_pk_mul_f16 v239, v171, v219 op_sel:[0,0] op_sel_hi:[0,1]
  v_mfma_f32_16x16x32_f16 v[192:195], v[240:243], v[244:247], v[192:195]
  ds_read_b128 v[228:231], v46 offset:8480
  v_pk_fma_f16 v236, v168, v216, v236 op_sel:[1,1,0] op_sel_hi:[1,0,1] neg_lo:[1,0,0]
  v_pk_fma_f16 v237, v169, v217, v237 op_sel:[1,1,0] op_sel_hi:[1,0,1] neg_lo:[1,0,0]
  v_pk_fma_f16 v238, v170, v218, v238 op_sel:[1,1,0] op_sel_hi:[1,0,1] neg_lo:[1,0,0]
  v_pk_fma_f16 v239, v171, v219, v239 op_sel:[1,1,0] op_sel_hi:[1,0,1] neg_lo:[1,0,0]
  s_waitcnt lgkmcnt(0)
  s_nop 0
  v_mfma_f32_16x16x32_f16 v[132:135], v[208:211], v[168:171], v[132:135]
  buffer_load_dwordx4 v21, s[8:11], s65 offen offset:1024  lds
  v_pk_mul_f16 v240, v220, v224 op_sel:[0,0] op_sel_hi:[0,1]
  v_pk_mul_f16 v241, v221, v225 op_sel:[0,0] op_sel_hi:[0,1]
  v_pk_mul_f16 v242, v222, v226 op_sel:[0,0] op_sel_hi:[0,1]
  v_pk_mul_f16 v243, v223, v227 op_sel:[0,0] op_sel_hi:[0,1]
  v_mfma_f32_16x16x32_f16 v[184:187], v[232:235], v[168:171], v[184:187]
  ds_read_b128 v[196:199], v45 offset:384
  v_pk_fma_f16 v240, v220, v224, v240 op_sel:[1,1,0] op_sel_hi:[1,0,1] neg_lo:[1,0,0]
  v_pk_fma_f16 v241, v221, v225, v241 op_sel:[1,1,0] op_sel_hi:[1,0,1] neg_lo:[1,0,0]
  v_pk_fma_f16 v242, v222, v226, v242 op_sel:[1,1,0] op_sel_hi:[1,0,1] neg_lo:[1,0,0]
  v_pk_fma_f16 v243, v223, v227, v243 op_sel:[1,1,0] op_sel_hi:[1,0,1] neg_lo:[1,0,0]
  v_mfma_f32_16x16x32_f16 v[188:191], v[208:211], v[236:239], v[188:191]
  ds_read_b128 v[200:203], v46 offset:8000
  buffer_load_dwordx4 v22, s[8:11], s65 offen offset:2048  lds
  v_pk_mul_f16 v244, v172, v228 op_sel:[0,0] op_sel_hi:[0,1]
  v_pk_mul_f16 v245, v173, v229 op_sel:[0,0] op_sel_hi:[0,1]
  v_pk_mul_f16 v246, v174, v230 op_sel:[0,0] op_sel_hi:[0,1]
  v_pk_mul_f16 v247, v175, v231 op_sel:[0,0] op_sel_hi:[0,1]
  v_mfma_f32_16x16x32_f16 v[192:195], v[232:235], v[236:239], v[192:195]
  ds_read_b128 v[204:207], v46 offset:8544
  v_pk_fma_f16 v244, v172, v228, v244 op_sel:[1,1,0] op_sel_hi:[1,0,1] neg_lo:[1,0,0]
  v_pk_fma_f16 v245, v173, v229, v245 op_sel:[1,1,0] op_sel_hi:[1,0,1] neg_lo:[1,0,0]
  v_pk_fma_f16 v246, v174, v230, v246 op_sel:[1,1,0] op_sel_hi:[1,0,1] neg_lo:[1,0,0]
  v_pk_fma_f16 v247, v175, v231, v247 op_sel:[1,1,0] op_sel_hi:[1,0,1] neg_lo:[1,0,0]
  s_waitcnt vmcnt(16)
  s_barrier
  s_waitcnt lgkmcnt(0)
  v_mfma_f32_16x16x32_f16 v[132:135], v[220:223], v[172:175], v[132:135]
  s_nop 0
  ds_read_b64_tr_b16 v[64:65], v41 offset:0
  ds_read_b64_tr_b16 v[66:67], v41 offset:512
  buffer_load_dwordx4 v23, s[8:11], s65 offen offset:3072  lds
  v_pk_mul_f16 v232, v196, v200 op_sel:[0,0] op_sel_hi:[0,1]
  v_pk_mul_f16 v233, v197, v201 op_sel:[0,0] op_sel_hi:[0,1]
  v_pk_mul_f16 v234, v198, v202 op_sel:[0,0] op_sel_hi:[0,1]
  v_pk_mul_f16 v235, v199, v203 op_sel:[0,0] op_sel_hi:[0,1]
  v_mfma_f32_16x16x32_f16 v[184:187], v[240:243], v[172:175], v[184:187]
  ds_read_b128 v[208:211], v45 offset:448
  ds_read_b64_tr_b16 v[68:69], v41 offset:4096
  s_lshl_b32 s62, s58, L_z2-L_z1+12
  v_pk_fma_f16 v232, v196, v200, v232 op_sel:[1,1,0] op_sel_hi:[1,0,1] neg_lo:[1,0,0]
  v_pk_fma_f16 v233, v197, v201, v233 op_sel:[1,1,0] op_sel_hi:[1,0,1] neg_lo:[1,0,0]
  v_pk_fma_f16 v234, v198, v202, v234 op_sel:[1,1,0] op_sel_hi:[1,0,1] neg_lo:[1,0,0]
  v_pk_fma_f16 v235, v199, v203, v235 op_sel:[1,1,0] op_sel_hi:[1,0,1] neg_lo:[1,0,0]
  v_mfma_f32_16x16x32_f16 v[188:191], v[220:223], v[244:247], v[188:191]
  ds_read_b128 v[212:215], v46 offset:8064
  ds_read_b64_tr_b16 v[70:71], v41 offset:4608
  v_lshl_add_u32 v2, v0, 4, s62
  v_pk_mul_f16 v236, v176, v204 op_sel:[0,0] op_sel_hi:[0,1]
  v_pk_mul_f16 v237, v177, v205 op_sel:[0,0] op_sel_hi:[0,1]
  v_pk_mul_f16 v238, v178, v206 op_sel:[0,0] op_sel_hi:[0,1]
  v_pk_mul_f16 v239, v179, v207 op_sel:[0,0] op_sel_hi:[0,1]
  v_mfma_f32_16x16x32_f16 v[192:195], v[240:243], v[244:247], v[192:195]
  ds_read_b128 v[216:219], v46 offset:8608
  ds_read_b128 a[0:3], v33 offset:0
  s_lshr_b32 s62, s66, 2
  v_pk_fma_f16 v236, v176, v204, v236 op_sel:[1,1,0] op_sel_hi:[1,0,1] neg_lo:[1,0,0]
  v_pk_fma_f16 v237, v177, v205, v237 op_sel:[1,1,0] op_sel_hi:[1,0,1] neg_lo:[1,0,0]
  v_pk_fma_f16 v238, v178, v206, v238 op_sel:[1,1,0] op_sel_hi:[1,0,1] neg_lo:[1,0,0]
  v_pk_fma_f16 v239, v179, v207, v239 op_sel:[1,1,0] op_sel_hi:[1,0,1] neg_lo:[1,0,0]
  s_waitcnt lgkmcnt(1)
  v_mfma_f32_16x16x32_f16 v[132:135], v[196:199], v[176:179], v[132:135]
  ds_read_b128 a[4:7], v34 offset:0
  ds_read_b128 a[8:11], v33 offset:2048
  s_add_u32 m0, s62, 133120
  v_pk_mul_f16 v240, v208, v212 op_sel:[0,0] op_sel_hi:[0,1]
  v_pk_mul_f16 v241, v209, v213 op_sel:[0,0] op_sel_hi:[0,1]
  v_pk_mul_f16 v242, v210, v214 op_sel:[0,0] op_sel_hi:[0,1]
  v_pk_mul_f16 v243, v211, v215 op_sel:[0,0] op_sel_hi:[0,1]
  v_mfma_f32_16x16x32_f16 v[184:187], v[232:235], v[176:179], v[184:187]
  ds_read_b128 a[12:15], v34 offset:2048
  ds_read_b128 v[48:51], v35 offset:0
  global_load_lds_dwordx4 v2, s[40:41]
  v_pk_fma_f16 v240, v208, v212, v240 op_sel:[1,1,0] op_sel_hi:[1,0,1] neg_lo:[1,0,0]
  v_pk_fma_f16 v241, v209, v213, v241 op_sel:[1,1,0] op_sel_hi:[1,0,1] neg_lo:[1,0,0]
  v_pk_fma_f16 v242, v210, v214, v242 op_sel:[1,1,0] op_sel_hi:[1,0,1] neg_lo:[1,0,0]
  v_pk_fma_f16 v243, v211, v215, v243 op_sel:[1,1,0] op_sel_hi:[1,0,1] neg_lo:[1,0,0]
  v_mfma_f32_16x16x32_f16 v[188:191], v[196:199], v[236:239], v[188:191]
  ds_read_b128 v[52:55], v36 offset:0
  ds_read_b128 v[56:59], v35 offset:2048
  v_pk_mul_f16 v244, v180, v216 op_sel:[0,0] op_sel_hi:[0,1]
  v_pk_mul_f16 v245, v181, v217 op_sel:[0,0] op_sel_hi:[0,1]
  v_pk_mul_f16 v246, v182, v218 op_sel:[0,0] op_sel_hi:[0,1]
  v_pk_mul_f16 v247, v183, v219 op_sel:[0,0] op_sel_hi:[0,1]
  v_mfma_f32_16x16x32_f16 v[192:195], v[232:235], v[236:239], v[192:195]
  ds_read_b128 v[60:63], v36 offset:2048
  ds_read_b64_tr_b16 v[72:73], v42 offset:0
  v_pk_fma_f16 v244, v180, v216, v244 op_sel:[1,1,0] op_sel_hi:[1,0,1] neg_lo:[1,0,0]
  v_pk_fma_f16 v245, v181, v217, v245 op_sel:[1,1,0] op_sel_hi:[1,0,1] neg_lo:[1,0,0]
  v_pk_fma_f16 v246, v182, v218, v246 op_sel:[1,1,0] op_sel_hi:[1,0,1] neg_lo:[1,0,0]
  v_pk_fma_f16 v247, v183, v219, v247 op_sel:[1,1,0] op_sel_hi:[1,0,1] neg_lo:[1,0,0]
  v_mfma_f32_16x16x32_f16 v[132:135], v[208:211], v[180:183], v[132:135]
  ds_read_b64_tr_b16 v[74:75], v42 offset:512
  ds_read_b64_tr_b16 v[76:77], v42 offset:4096
  v_mfma_f32_16x16x32_f16 v[184:187], v[240:243], v[180:183], v[184:187]
  ds_read_b64_tr_b16 v[78:79], v42 offset:4608
  ds_read_b64_tr_b16 v[80:81], v41 offset:8192
  v_mfma_f32_16x16x32_f16 v[188:191], v[208:211], v[244:247], v[188:191]
  ds_read_b64_tr_b16 v[82:83], v41 offset:8704
  ds_read_b64_tr_b16 v[84:85], v41 offset:12288
  v_mfma_f32_16x16x32_f16 v[192:195], v[240:243], v[244:247], v[192:195]
  ds_read_b64_tr_b16 v[86:87], v41 offset:12800
  ds_read_b64_tr_b16 v[88:89], v42 offset:8192
  ds_read_b64_tr_b16 v[90:91], v42 offset:8704
  ds_read_b64_tr_b16 v[92:93], v42 offset:12288
  ds_read_b64_tr_b16 v[94:95], v42 offset:12800
  s_nop 2
  v_permlane32_swap_b32 v188, v192
  v_permlane32_swap_b32 v189, v193
  v_permlane32_swap_b32 v190, v194
  v_permlane32_swap_b32 v191, v195
  v_permlane32_swap_b32 v132, v184
  v_permlane32_swap_b32 v133, v185
  v_permlane32_swap_b32 v134, v186
  v_permlane32_swap_b32 v135, v187
  v_permlane16_swap_b32 v184, v192
  v_permlane16_swap_b32 v185, v193
  v_permlane16_swap_b32 v186, v194
  v_permlane16_swap_b32 v187, v195
  v_mul_f32 v188, v188, v112
  v_mul_f32 v190, v190, v112
  v_mul_f32 v192, v192, v112
  v_fma_f32 v132, v132, v112, v107
  v_mul_f32_e64 v133, v133, v112
  v_pk_mul_f32 v[134:135], v[134:135], v[112:113] op_sel:[0,0] op_sel_hi:[1,0]
  v_pk_mul_f32 v[184:185], v[184:185], v[112:113] op_sel:[0,0] op_sel_hi:[1,0]
  v_pk_mul_f32 v[186:187], v[186:187], v[112:113] op_sel:[0,0] op_sel_hi:[1,0]
  v_cvt_pk_bf16_f32 v118, v190, v188
  v_cvt_pk_bf16_f32 v119, v188, v188
  v_cvt_pk_bf16_f32 v120, v135, v134
  v_cvt_pk_bf16_f32 v121, v133, v132
  v_cvt_pk_bf16_f32 v124, v134, v133
  v_cvt_pk_bf16_f32 v125, v184, v185
  v_cvt_pk_bf16_f32 v138, v186, v187
  v_cvt_pk_bf16_f32 v150, v192, v192
  v_cvt_pk_bf16_f32 v151, v192, v192
  ds_write_b64 v98, v[118:119] offset:1200
  ds_write_b16 v98, v118 offset:2
  ds_write_b32 v98, v119 offset:4
  ds_write_b16 v98, v119 offset:8
  ds_write_b64 v98, v[120:121] offset:512
  ds_write_b16 v98, v120 offset:1710
  ds_write_b32 v98, v124 offset:1712
  ds_write_b16_d16_hi v98, v121 offset:1716
  ds_write_b32 v99, v125
  ds_write_b16 v100, v138 offset:576
  ds_write_b16_d16_hi v100, v138 offset:448
  s_mov_b64 exec, 1
  ds_write_b64 v101, v[150:151] offset:58
  ds_write_b64 v101, v[150:151] offset:1256
  s_mov_b64 exec, -1
  s_waitcnt vmcnt(9) lgkmcnt(0)
  s_barrier
  v_mfma_f32_16x16x32_bf16 v[8:11], v[64:67], a[0:3], 0
  s_bfe_u32 s63, s74, 0x4000c
  s_lshl_b32 s65, s63, L_z2-L_z1+7
  v_mfma_f32_16x16x32_bf16 v[8:11], v[68:71], a[4:7], v[8:11]
  ds_read_b64_tr_b16 v[168:169], v41 offset:32768
  ds_read_b64_tr_b16 v[170:171], v41 offset:33280
  v_mfma_f32_16x16x32_bf16 v[28:31], v[68:71], a[12:15], 0
  ds_read_b128 a[16:19], v33 offset:32768
  s_add_u32 m0, s66, L_z2-L_z1+0
  v_mfma_f32_16x16x32_bf16 v[28:31], v[64:67], a[8:11], v[28:31]
  buffer_load_dwordx4 v16, s[4:7], s65 offen offset:0  lds
  v_mfma_f32_16x16x32_bf16 v[96:99], v[64:67], v[48:51], 0
  ds_read_b64_tr_b16 v[172:173], v41 offset:36864
  ds_read_b64_tr_b16 v[174:175], v41 offset:37376
  v_mfma_f32_16x16x32_bf16 v[96:99], v[68:71], v[52:55], v[96:99]
  ds_read_b128 a[20:23], v34 offset:32768
  v_mfma_f32_16x16x32_bf16 v[100:103], v[68:71], v[60:63], 0
  s_mul_i32 s76, s59, 98304
  s_lshl_b32 s62, s58, L_z2-L_z1+7
  v_mfma_f32_16x16x32_bf16 v[100:103], v[64:67], v[56:59], v[100:103]
  buffer_load_dwordx4 v17, s[4:7], s65 offen offset:1024  lds
  v_mfma_f32_16x16x32_bf16 v[104:107], v[72:75], a[0:3], 0
  ds_read_b64_tr_b16 v[176:177], v42 offset:32768
  ds_read_b64_tr_b16 v[178:179], v42 offset:33280
  v_mfma_f32_16x16x32_bf16 v[104:107], v[76:79], a[4:7], v[104:107]
  ds_read_b128 a[24:27], v33 offset:34816
  v_mfma_f32_16x16x32_bf16 v[108:111], v[76:79], a[12:15], 0
  s_add_u32 s76, s76, s62
  s_sub_u32 s76, s76, s67
  v_mfma_f32_16x16x32_bf16 v[108:111], v[72:75], a[8:11], v[108:111]
  buffer_load_dwordx4 v18, s[4:7], s65 offen offset:2048  lds
  v_mfma_f32_16x16x32_bf16 v[112:115], v[72:75], v[48:51], 0
  ds_read_b64_tr_b16 v[180:181], v42 offset:36864
  ds_read_b64_tr_b16 v[182:183], v42 offset:37376
  v_mfma_f32_16x16x32_bf16 v[112:115], v[76:79], v[52:55], v[112:115]
  ds_read_b128 a[28:31], v34 offset:34816
  v_mfma_f32_16x16x32_bf16 v[116:119], v[76:79], v[60:63], 0
  buffer_load_dwordx4 v19, s[4:7], s65 offen offset:3072  lds
  v_mfma_f32_16x16x32_bf16 v[116:119], v[72:75], v[56:59], v[116:119]
  s_mul_i32 s65, s63, s56
  s_add_u32 m0, s66, s51
  v_mfma_f32_16x16x32_bf16 v[120:123], a[0:3], v[80:83], 0
  ds_read_b64_tr_b16 v[184:185], v41 offset:40960
  ds_read_b64_tr_b16 v[186:187], v41 offset:41472
  v_mfma_f32_16x16x32_bf16 v[120:123], a[4:7], v[84:87], v[120:123]
  ds_read_b128 v[152:155], v35 offset:32768
  v_mfma_f32_16x16x32_bf16 v[124:127], a[12:15], v[84:87], 0
  buffer_load_dwordx4 v20, s[8:11], s65 offen offset:0  lds
  v_mfma_f32_16x16x32_bf16 v[124:127], a[8:11], v[80:83], v[124:127]
  ds_read_b64_tr_b16 v[188:189], v41 offset:45056
  ds_read_b64_tr_b16 v[190:191], v41 offset:45568
  v_mfma_f32_16x16x32_bf16 v[128:131], v[48:51], v[80:83], 0
  ds_read_b128 v[156:159], v36 offset:32768
  v_mfma_f32_16x16x32_bf16 v[128:131], v[52:55], v[84:87], v[128:131]
  buffer_load_dwordx4 v21, s[8:11], s65 offen offset:1024  lds
  v_mfma_f32_16x16x32_bf16 v[132:135], v[60:63], v[84:87], 0
  ds_read_b64_tr_b16 v[192:193], v42 offset:40960
  ds_read_b64_tr_b16 v[194:195], v42 offset:41472
  v_mfma_f32_16x16x32_bf16 v[132:135], v[56:59], v[80:83], v[132:135]
  ds_read_b128 v[160:163], v35 offset:34816
  v_mfma_f32_16x16x32_bf16 v[136:139], a[0:3], v[88:91], 0
  s_lshl_b32 s77, s59, 11
  s_and_b32 s68, s2, 7
  v_mfma_f32_16x16x32_bf16 v[136:139], a[4:7], v[92:95], v[136:139]
  buffer_load_dwordx4 v22, s[8:11], s65 offen offset:2048  lds
  v_mfma_f32_16x16x32_bf16 v[140:143], a[12:15], v[92:95], 0
  ds_read_b64_tr_b16 v[196:197], v42 offset:45056
  ds_read_b64_tr_b16 v[198:199], v42 offset:45568
  v_mfma_f32_16x16x32_bf16 v[140:143], a[8:11], v[88:91], v[140:143]
  ds_read_b128 v[164:167], v36 offset:34816
  v_mfma_f32_16x16x32_bf16 v[144:147], v[48:51], v[88:91], 0
  buffer_load_dwordx4 v23, s[8:11], s65 offen offset:3072  lds
  v_mfma_f32_16x16x32_bf16 v[144:147], v[52:55], v[92:95], v[144:147]
  s_bfe_u32 s62, s2, 0x10003
  s_lshl1_add_u32 s68, s68, s62
  v_mfma_f32_16x16x32_bf16 v[148:151], v[60:63], v[92:95], 0
  s_lshr_b32 s69, s2, 4
  s_add_u32 s71, s69, s68
  v_mfma_f32_16x16x32_bf16 v[148:151], v[56:59], v[88:91], v[148:151]
  s_waitcnt vmcnt(8) lgkmcnt(0)
  s_barrier
  v_mfma_f32_16x16x32_bf16 v[8:11], v[168:171], a[16:19], v[8:11]
  s_bfe_u32 s63, s74, 0x40010
  s_lshl_b32 s65, s63, 7
  v_mfma_f32_16x16x32_bf16 v[8:11], v[172:175], a[20:23], v[8:11]
  ds_read_b64_tr_b16 v[64:65], v43 offset:0
  ds_read_b64_tr_b16 v[66:67], v43 offset:512
  v_mfma_f32_16x16x32_bf16 v[28:31], v[172:175], a[28:31], v[28:31]
  ds_read_b128 a[32:35], v37 offset:0
  s_add_u32 m0, s66, 32768
  v_mfma_f32_16x16x32_bf16 v[28:31], v[168:171], a[24:27], v[28:31]
  buffer_load_dwordx4 v16, s[4:7], s65 offen offset:0  lds
  v_mfma_f32_16x16x32_bf16 v[96:99], v[168:171], v[152:155], v[96:99]
  ds_read_b64_tr_b16 v[68:69], v43 offset:4096
  ds_read_b64_tr_b16 v[70:71], v43 offset:4608
  v_mfma_f32_16x16x32_bf16 v[96:99], v[172:175], v[156:159], v[96:99]
  ds_read_b128 a[36:39], v38 offset:0
  v_mfma_f32_16x16x32_bf16 v[100:103], v[172:175], v[164:167], v[100:103]
  s_and_b32 s71, s71, 14
  s_mov_b32 s14, 2097152
  v_mfma_f32_16x16x32_bf16 v[100:103], v[168:171], v[160:163], v[100:103]
  buffer_load_dwordx4 v17, s[4:7], s65 offen offset:1024  lds
  v_mfma_f32_16x16x32_bf16 v[104:107], v[176:179], a[16:19], v[104:107]
  ds_read_b64_tr_b16 v[72:73], v44 offset:0
  ds_read_b64_tr_b16 v[74:75], v44 offset:512
  v_mfma_f32_16x16x32_bf16 v[104:107], v[180:183], a[20:23], v[104:107]
  ds_read_b128 a[40:43], v37 offset:2048
  v_mfma_f32_16x16x32_bf16 v[108:111], v[180:183], a[28:31], v[108:111]
  s_mov_b32 s15, s7
  s_mov_b32 s18, 4194304
  v_mfma_f32_16x16x32_bf16 v[108:111], v[176:179], a[24:27], v[108:111]
  buffer_load_dwordx4 v18, s[4:7], s65 offen offset:2048  lds
  v_mfma_f32_16x16x32_bf16 v[112:115], v[176:179], v[152:155], v[112:115]
  ds_read_b64_tr_b16 v[76:77], v44 offset:4096
  ds_read_b64_tr_b16 v[78:79], v44 offset:4608
  v_mfma_f32_16x16x32_bf16 v[112:115], v[180:183], v[156:159], v[112:115]
  ds_read_b128 a[44:47], v38 offset:2048
  v_mfma_f32_16x16x32_bf16 v[116:119], v[180:183], v[164:167], v[116:119]
  buffer_load_dwordx4 v19, s[4:7], s65 offen offset:3072  lds
  v_mfma_f32_16x16x32_bf16 v[116:119], v[176:179], v[160:163], v[116:119]
  s_mul_i32 s65, s63, 393216
  s_add_u32 m0, s66, 49152
  v_mfma_f32_16x16x32_bf16 v[120:123], a[16:19], v[184:187], v[120:123]
  ds_read_b64_tr_b16 v[80:81], v43 offset:8192
  ds_read_b64_tr_b16 v[82:83], v43 offset:8704
  v_mfma_f32_16x16x32_bf16 v[120:123], a[20:23], v[188:191], v[120:123]
  ds_read_b128 v[48:51], v39 offset:0
  v_mfma_f32_16x16x32_bf16 v[124:127], a[28:31], v[188:191], v[124:127]
  buffer_load_dwordx4 v20, s[8:11], s65 offen offset:0  lds
  v_mfma_f32_16x16x32_bf16 v[124:127], a[24:27], v[184:187], v[124:127]
  ds_read_b64_tr_b16 v[84:85], v43 offset:12288
  ds_read_b64_tr_b16 v[86:87], v43 offset:12800
  v_mfma_f32_16x16x32_bf16 v[128:131], v[152:155], v[184:187], v[128:131]
  ds_read_b128 v[52:55], v40 offset:0
  v_mfma_f32_16x16x32_bf16 v[128:131], v[156:159], v[188:191], v[128:131]
  buffer_load_dwordx4 v21, s[8:11], s65 offen offset:1024  lds
  v_mfma_f32_16x16x32_bf16 v[132:135], v[164:167], v[188:191], v[132:135]
  ds_read_b64_tr_b16 v[88:89], v44 offset:8192
  ds_read_b64_tr_b16 v[90:91], v44 offset:8704
  v_mfma_f32_16x16x32_bf16 v[132:135], v[160:163], v[184:187], v[132:135]
  ds_read_b128 v[56:59], v39 offset:2048
  v_mfma_f32_16x16x32_bf16 v[136:139], a[16:19], v[192:195], v[136:139]
  s_mov_b32 s19, s7
  s_mov_b32 s22, 8388608
  v_mfma_f32_16x16x32_bf16 v[136:139], a[20:23], v[196:199], v[136:139]
  buffer_load_dwordx4 v22, s[8:11], s65 offen offset:2048  lds
  v_mfma_f32_16x16x32_bf16 v[140:143], a[28:31], v[196:199], v[140:143]
  ds_read_b64_tr_b16 v[92:93], v44 offset:12288
  ds_read_b64_tr_b16 v[94:95], v44 offset:12800
  v_mfma_f32_16x16x32_bf16 v[140:143], a[24:27], v[192:195], v[140:143]
  ds_read_b128 v[60:63], v40 offset:2048
  v_mfma_f32_16x16x32_bf16 v[144:147], v[152:155], v[192:195], v[144:147]
  buffer_load_dwordx4 v23, s[8:11], s65 offen offset:3072  lds
  v_mfma_f32_16x16x32_bf16 v[144:147], v[156:159], v[196:199], v[144:147]
  s_mov_b32 s23, s7
  s_mov_b32 s46, 256
  v_mfma_f32_16x16x32_bf16 v[148:151], v[164:167], v[196:199], v[148:151]
  s_mov_b32 s47, s7
  s_add_u32 s42, s42, L_tab-L_pc
  s_addc_u32 s43, s43, 0
  v_mfma_f32_16x16x32_bf16 v[148:151], v[160:163], v[192:195], v[148:151]
  s_waitcnt vmcnt(8) lgkmcnt(0)
  s_barrier
  v_mfma_f32_16x16x32_bf16 v[8:11], v[64:67], a[32:35], v[8:11]
  s_bfe_u32 s63, s74, 0x40014
  s_lshl_b32 s65, s63, L_z2-L_z1+7
  v_mfma_f32_16x16x32_bf16 v[8:11], v[68:71], a[36:39], v[8:11]
  ds_read_b64_tr_b16 v[168:169], v41 offset:0
  ds_read_b64_tr_b16 v[170:171], v41 offset:512
  v_mfma_f32_16x16x32_bf16 v[28:31], v[68:71], a[44:47], v[28:31]
  ds_read_b128 a[48:51], v33 offset:0
  s_add_u32 m0, s66, 65536
  v_mfma_f32_16x16x32_bf16 v[28:31], v[64:67], a[40:43], v[28:31]
  buffer_load_dwordx4 v16, s[4:7], s65 offen offset:0  lds
  v_mfma_f32_16x16x32_bf16 v[96:99], v[64:67], v[48:51], v[96:99]
  ds_read_b64_tr_b16 v[172:173], v41 offset:4096
  ds_read_b64_tr_b16 v[174:175], v41 offset:4608
  v_mfma_f32_16x16x32_bf16 v[96:99], v[68:71], v[52:55], v[96:99]
  ds_read_b128 a[52:55], v34 offset:0
  v_mfma_f32_16x16x32_bf16 v[100:103], v[68:71], v[60:63], v[100:103]
  v_lshlrev_b32 v13, 4, v1
  v_and_b32 v15, 15, v1
  v_mfma_f32_16x16x32_bf16 v[100:103], v[64:67], v[56:59], v[100:103]
  buffer_load_dwordx4 v17, s[4:7], s65 offen offset:1024  lds
  v_mfma_f32_16x16x32_bf16 v[104:107], v[72:75], a[32:35], v[104:107]
  ds_read_b64_tr_b16 v[176:177], v42 offset:0
  ds_read_b64_tr_b16 v[178:179], v42 offset:512
  v_mfma_f32_16x16x32_bf16 v[104:107], v[76:79], a[36:39], v[104:107]
  ds_read_b128 a[56:59], v33 offset:2048
  v_mfma_f32_16x16x32_bf16 v[108:111], v[76:79], a[44:47], v[108:111]
  v_lshrrev_b32 v26, 4, v1
  s_lshl_b32 s82, s59, 13
  v_mfma_f32_16x16x32_bf16 v[108:111], v[72:75], a[40:43], v[108:111]
  buffer_load_dwordx4 v18, s[4:7], s65 offen offset:2048  lds
  v_mfma_f32_16x16x32_bf16 v[112:115], v[72:75], v[48:51], v[112:115]
  ds_read_b64_tr_b16 v[180:181], v42 offset:4096
  ds_read_b64_tr_b16 v[182:183], v42 offset:4608
  v_mfma_f32_16x16x32_bf16 v[112:115], v[76:79], v[52:55], v[112:115]
  ds_read_b128 a[60:63], v34 offset:2048
  v_mfma_f32_16x16x32_bf16 v[116:119], v[76:79], v[60:63], v[116:119]
  buffer_load_dwordx4 v19, s[4:7], s65 offen offset:3072  lds
  v_mfma_f32_16x16x32_bf16 v[116:119], v[72:75], v[56:59], v[116:119]
  s_mul_i32 s65, s63, 393216
  s_add_u32 m0, s66, 81920
  v_mfma_f32_16x16x32_bf16 v[120:123], a[32:35], v[80:83], v[120:123]
  ds_read_b64_tr_b16 v[184:185], v41 offset:8192
  ds_read_b64_tr_b16 v[186:187], v41 offset:8704
  v_mfma_f32_16x16x32_bf16 v[120:123], a[36:39], v[84:87], v[120:123]
  ds_read_b128 v[152:155], v35 offset:0
  v_mfma_f32_16x16x32_bf16 v[124:127], a[44:47], v[84:87], v[124:127]
  buffer_load_dwordx4 v20, s[8:11], s65 offen offset:0  lds
  v_mfma_f32_16x16x32_bf16 v[124:127], a[40:43], v[80:83], v[124:127]
  ds_read_b64_tr_b16 v[188:189], v41 offset:12288
  ds_read_b64_tr_b16 v[190:191], v41 offset:12800
  v_mfma_f32_16x16x32_bf16 v[128:131], v[48:51], v[80:83], v[128:131]
  ds_read_b128 v[156:159], v36 offset:0
  v_mfma_f32_16x16x32_bf16 v[128:131], v[52:55], v[84:87], v[128:131]
  buffer_load_dwordx4 v21, s[8:11], s65 offen offset:1024  lds
  v_mfma_f32_16x16x32_bf16 v[132:135], v[60:63], v[84:87], v[132:135]
  ds_read_b64_tr_b16 v[192:193], v42 offset:8192
  ds_read_b64_tr_b16 v[194:195], v42 offset:8704
  v_mfma_f32_16x16x32_bf16 v[132:135], v[56:59], v[80:83], v[132:135]
  ds_read_b128 v[160:163], v35 offset:2048
  v_mfma_f32_16x16x32_bf16 v[136:139], a[32:35], v[88:91], v[136:139]
  s_add_u32 s61, s66, 114688
  v_add_u32_e64 v27, s61, v13
  v_mfma_f32_16x16x32_bf16 v[136:139], a[36:39], v[92:95], v[136:139]
  buffer_load_dwordx4 v22, s[8:11], s65 offen offset:2048  lds
  v_mfma_f32_16x16x32_bf16 v[140:143], a[44:47], v[92:95], v[140:143]
  ds_read_b64_tr_b16 v[196:197], v42 offset:12288
  ds_read_b64_tr_b16 v[198:199], v42 offset:12800
  v_mfma_f32_16x16x32_bf16 v[140:143], a[40:43], v[88:91], v[140:143]
  ds_read_b128 v[164:167], v36 offset:2048
  v_mfma_f32_16x16x32_bf16 v[144:147], v[48:51], v[88:91], v[144:147]
  buffer_load_dwordx4 v23, s[8:11], s65 offen offset:3072  lds
  v_mfma_f32_16x16x32_bf16 v[144:147], v[52:55], v[92:95], v[144:147]
  v_bfe_u32 v3, v1, 1, 2
  v_xor_b32 v3, v3, v26
  v_mfma_f32_16x16x32_bf16 v[148:151], v[60:63], v[92:95], v[148:151]
  v_lshlrev_b32 v2, 6, v15
  v_lshl_add_u32 v2, v3, 4, v2
  v_mfma_f32_16x16x32_bf16 v[148:151], v[56:59], v[88:91], v[148:151]
  s_waitcnt vmcnt(8) lgkmcnt(0)
  s_barrier
  v_mfma_f32_16x16x32_bf16 v[8:11], v[168:171], a[48:51], v[8:11]
  s_bfe_u32 s63, s74, 0x40018
  s_lshl_b32 s65, s63, L_z2-L_z1+7
  v_mfma_f32_16x16x32_bf16 v[8:11], v[172:175], a[52:55], v[8:11]
  ds_read_b64_tr_b16 v[64:65], v41 offset:32768
  ds_read_b64_tr_b16 v[66:67], v41 offset:33280
  v_mfma_f32_16x16x32_bf16 v[28:31], v[172:175], a[60:63], v[28:31]
  ds_read_b128 a[64:67], v33 offset:32768
  s_add_u32 m0, s66, L_z2-L_z1+0
  v_mfma_f32_16x16x32_bf16 v[28:31], v[168:171], a[56:59], v[28:31]
  buffer_load_dwordx4 v16, s[4:7], s65 offen offset:0  lds
  v_mfma_f32_16x16x32_bf16 v[96:99], v[168:171], v[152:155], v[96:99]
  ds_read_b64_tr_b16 v[68:69], v41 offset:36864
  ds_read_b64_tr_b16 v[70:71], v41 offset:37376
  v_mfma_f32_16x16x32_bf16 v[96:99], v[172:175], v[156:159], v[96:99]
  ds_read_b128 a[68:71], v34 offset:32768
  v_mfma_f32_16x16x32_bf16 v[100:103], v[172:175], v[164:167], v[100:103]
  v_add_u32 v32, s82, v2
  v_lshrrev_b32 v2, 2, v1
  v_mfma_f32_16x16x32_bf16 v[100:103], v[168:171], v[160:163], v[100:103]
  buffer_load_dwordx4 v17, s[4:7], s65 offen offset:1024  lds
  v_mfma_f32_16x16x32_bf16 v[104:107], v[176:179], a[48:51], v[104:107]
  ds_read_b64_tr_b16 v[72:73], v42 offset:32768
  ds_read_b64_tr_b16 v[74:75], v42 offset:33280
  v_mfma_f32_16x16x32_bf16 v[104:107], v[180:183], a[52:55], v[104:107]
  ds_read_b128 a[72:75], v33 offset:34816
  v_mfma_f32_16x16x32_bf16 v[108:111], v[180:183], a[60:63], v[108:111]
  v_bfe_u32 v3, v1, 3, 2
  v_and_b32_e64 v4, 3, v1
  v_mfma_f32_16x16x32_bf16 v[108:111], v[176:179], a[56:59], v[108:111]
  buffer_load_dwordx4 v18, s[4:7], s65 offen offset:2048  lds
  v_mfma_f32_16x16x32_bf16 v[112:115], v[176:179], v[152:155], v[112:115]
  ds_read_b64_tr_b16 v[76:77], v42 offset:36864
  ds_read_b64_tr_b16 v[78:79], v42 offset:37376
  v_mfma_f32_16x16x32_bf16 v[112:115], v[180:183], v[156:159], v[112:115]
  ds_read_b128 a[76:79], v34 offset:34816
  v_mfma_f32_16x16x32_bf16 v[116:119], v[180:183], v[164:167], v[116:119]
  buffer_load_dwordx4 v19, s[4:7], s65 offen offset:3072  lds
  v_mfma_f32_16x16x32_bf16 v[116:119], v[176:179], v[160:163], v[116:119]
  s_mul_i32 s65, s63, 393216
  s_add_u32 m0, s66, 16384
  v_mfma_f32_16x16x32_bf16 v[120:123], a[48:51], v[184:187], v[120:123]
  ds_read_b64_tr_b16 v[80:81], v41 offset:40960
  ds_read_b64_tr_b16 v[82:83], v41 offset:41472
  v_mfma_f32_16x16x32_bf16 v[120:123], a[52:55], v[188:191], v[120:123]
  ds_read_b128 v[48:51], v35 offset:32768
  v_mfma_f32_16x16x32_bf16 v[124:127], a[60:63], v[188:191], v[124:127]
  buffer_load_dwordx4 v20, s[8:11], s65 offen offset:0  lds
  v_mfma_f32_16x16x32_bf16 v[124:127], a[56:59], v[184:187], v[124:127]
  ds_read_b64_tr_b16 v[84:85], v41 offset:45056
  ds_read_b64_tr_b16 v[86:87], v41 offset:45568
  v_mfma_f32_16x16x32_bf16 v[128:131], v[152:155], v[184:187], v[128:131]
  ds_read_b128 v[52:55], v36 offset:32768
  v_mfma_f32_16x16x32_bf16 v[128:131], v[156:159], v[188:191], v[128:131]
  buffer_load_dwordx4 v21, s[8:11], s65 offen offset:1024  lds
  v_mfma_f32_16x16x32_bf16 v[132:135], v[164:167], v[188:191], v[132:135]
  ds_read_b64_tr_b16 v[88:89], v42 offset:40960
  ds_read_b64_tr_b16 v[90:91], v42 offset:41472
  v_mfma_f32_16x16x32_bf16 v[132:135], v[160:163], v[184:187], v[132:135]
  ds_read_b128 v[56:59], v35 offset:34816
  v_mfma_f32_16x16x32_bf16 v[136:139], a[48:51], v[192:195], v[136:139]
  v_xor_b32_e64 v3, v3, v4
  v_lshlrev_b32 v5, 6, v2
  v_mfma_f32_16x16x32_bf16 v[136:139], a[52:55], v[196:199], v[136:139]
  buffer_load_dwordx4 v22, s[8:11], s65 offen offset:2048  lds
  v_mfma_f32_16x16x32_bf16 v[140:143], a[60:63], v[196:199], v[140:143]
L_pg2:
  s_cbranch_execz L_back_prm
  ds_read_b64_tr_b16 v[92:93], v42 offset:45056
  ds_read_b64_tr_b16 v[94:95], v42 offset:45568
  v_mfma_f32_16x16x32_bf16 v[140:143], a[56:59], v[192:195], v[140:143]
  ds_read_b128 v[60:63], v36 offset:34816
  v_mfma_f32_16x16x32_bf16 v[144:147], v[152:155], v[192:195], v[144:147]
  buffer_load_dwordx4 v23, s[8:11], s65 offen offset:3072  lds
  v_mfma_f32_16x16x32_bf16 v[144:147], v[156:159], v[196:199], v[144:147]
  v_lshl_add_u32 v5, v3, 4, v5
  s_lshl_b32 s62, s59, 30
  v_mfma_f32_16x16x32_bf16 v[148:151], v[164:167], v[196:199], v[148:151]
  s_and_b32 s62, s62, 0x80000000
  s_xor_b32 s84, s62, s48
  v_mfma_f32_16x16x32_bf16 v[148:151], v[160:163], v[192:195], v[148:151]
  s_waitcnt vmcnt(8) lgkmcnt(0)
  s_barrier
  v_mfma_f32_16x16x32_bf16 v[8:11], v[64:67], a[64:67], v[8:11]
  s_bfe_u32 s63, s74, 0x4001c
  s_lshl_b32 s65, s63, L_z2-L_z1+7
  v_mfma_f32_16x16x32_bf16 v[8:11], v[68:71], a[68:71], v[8:11]
  ds_read_b64_tr_b16 v[168:169], v43 offset:0
  ds_read_b64_tr_b16 v[170:171], v43 offset:512
  v_mfma_f32_16x16x32_bf16 v[28:31], v[68:71], a[76:79], v[28:31]
  ds_read_b128 a[80:83], v37 offset:0
  s_add_u32 m0, s66, 32768
  v_mfma_f32_16x16x32_bf16 v[28:31], v[64:67], a[72:75], v[28:31]
  buffer_load_dwordx4 v16, s[4:7], s65 offen offset:0  lds
  v_mfma_f32_16x16x32_bf16 v[96:99], v[64:67], v[48:51], v[96:99]
  ds_read_b64_tr_b16 v[172:173], v43 offset:4096
  ds_read_b64_tr_b16 v[174:175], v43 offset:4608
  v_mfma_f32_16x16x32_bf16 v[96:99], v[68:71], v[52:55], v[96:99]
  ds_read_b128 a[84:87], v38 offset:0
  v_mfma_f32_16x16x32_bf16 v[100:103], v[68:71], v[60:63], v[100:103]
  s_mov_b32 s85, s84
  v_add_u32 v45, s82, v5
  v_mfma_f32_16x16x32_bf16 v[100:103], v[64:67], v[56:59], v[100:103]
  buffer_load_dwordx4 v17, s[4:7], s65 offen offset:1024  lds
  v_mfma_f32_16x16x32_bf16 v[104:107], v[72:75], a[64:67], v[104:107]
  ds_read_b64_tr_b16 v[176:177], v44 offset:0
  ds_read_b64_tr_b16 v[178:179], v44 offset:512
  v_mfma_f32_16x16x32_bf16 v[104:107], v[76:79], a[68:71], v[104:107]
  ds_read_b128 a[88:91], v37 offset:2048
  v_mfma_f32_16x16x32_bf16 v[108:111], v[76:79], a[76:79], v[108:111]
  v_xor_b32 v46, 20480, v45
  v_lshlrev_b32_e64 v4, 2, v4
  v_mfma_f32_16x16x32_bf16 v[108:111], v[72:75], a[72:75], v[108:111]
  buffer_load_dwordx4 v18, s[4:7], s65 offen offset:2048  lds
  v_mfma_f32_16x16x32_bf16 v[112:115], v[72:75], v[48:51], v[112:115]
  ds_read_b64_tr_b16 v[180:181], v44 offset:4096
  ds_read_b64_tr_b16 v[182:183], v44 offset:4608
  v_mfma_f32_16x16x32_bf16 v[112:115], v[76:79], v[52:55], v[112:115]
  ds_read_b128 a[92:95], v38 offset:2048
  v_mfma_f32_16x16x32_bf16 v[116:119], v[76:79], v[60:63], v[116:119]
  buffer_load_dwordx4 v19, s[4:7], s65 offen offset:3072  lds
  v_mfma_f32_16x16x32_bf16 v[116:119], v[72:75], v[56:59], v[116:119]
  s_mul_i32 s65, s63, 393216
  s_add_u32 m0, s66, 49152
  v_mfma_f32_16x16x32_bf16 v[120:123], a[64:67], v[80:83], v[120:123]
  ds_read_b64_tr_b16 v[184:185], v43 offset:8192
  ds_read_b64_tr_b16 v[186:187], v43 offset:8704
  v_mfma_f32_16x16x32_bf16 v[120:123], a[68:71], v[84:87], v[120:123]
  ds_read_b128 v[152:155], v39 offset:0
  v_mfma_f32_16x16x32_bf16 v[124:127], a[76:79], v[84:87], v[124:127]
  buffer_load_dwordx4 v20, s[8:11], s65 offen offset:0  lds
  v_mfma_f32_16x16x32_bf16 v[124:127], a[72:75], v[80:83], v[124:127]
  ds_read_b64_tr_b16 v[188:189], v43 offset:12288
  ds_read_b64_tr_b16 v[190:191], v43 offset:12800
  v_mfma_f32_16x16x32_bf16 v[128:131], v[48:51], v[80:83], v[128:131]
  ds_read_b128 v[156:159], v40 offset:0
  v_mfma_f32_16x16x32_bf16 v[128:131], v[52:55], v[84:87], v[128:131]
  buffer_load_dwordx4 v21, s[8:11], s65 offen offset:1024  lds
  v_mfma_f32_16x16x32_bf16 v[132:135], v[60:63], v[84:87], v[132:135]
  ds_read_b64_tr_b16 v[192:193], v44 offset:8192
  ds_read_b64_tr_b16 v[194:195], v44 offset:8704
  v_mfma_f32_16x16x32_bf16 v[132:135], v[56:59], v[80:83], v[132:135]
  ds_read_b128 v[160:163], v39 offset:2048
  v_mfma_f32_16x16x32_bf16 v[136:139], a[64:67], v[88:91], v[136:139]
  v_lshl_add_u32 v47, v2, 7, v4
  v_lshrrev_b32_e64 v2, 5, v1
  v_mfma_f32_16x16x32_bf16 v[136:139], a[68:71], v[92:95], v[136:139]
  buffer_load_dwordx4 v22, s[8:11], s65 offen offset:2048  lds
  v_mfma_f32_16x16x32_bf16 v[140:143], a[76:79], v[92:95], v[140:143]
  ds_read_b64_tr_b16 v[196:197], v44 offset:12288
  ds_read_b64_tr_b16 v[198:199], v44 offset:12800
  v_mfma_f32_16x16x32_bf16 v[140:143], a[72:75], v[88:91], v[140:143]
  ds_read_b128 v[164:167], v40 offset:2048
  v_mfma_f32_16x16x32_bf16 v[144:147], v[48:51], v[88:91], v[144:147]
  buffer_load_dwordx4 v23, s[8:11], s65 offen offset:3072  lds
  v_mfma_f32_16x16x32_bf16 v[144:147], v[52:55], v[92:95], v[144:147]
  v_and_b32 v3, 31, v1
  v_lshlrev_b32 v4, 3, v15
  v_mfma_f32_16x16x32_bf16 v[148:151], v[60:63], v[92:95], v[148:151]
  v_lshl_add_u32 v200, v26, 11, v4
  v_lshlrev_b32_e64 v3, 4, v3
  v_mfma_f32_16x16x32_bf16 v[148:151], v[56:59], v[88:91], v[148:151]
  s_waitcnt vmcnt(8) lgkmcnt(0)
  s_barrier
  v_mfma_f32_16x16x32_bf16 v[8:11], v[168:171], a[80:83], v[8:11]
  s_bfe_u32 s63, s75, 0x40000
  s_lshl_b32 s65, s63, L_z2-L_z1+7
  v_mfma_f32_16x16x32_bf16 v[8:11], v[172:175], a[84:87], v[8:11]
  ds_read_b64_tr_b16 v[64:65], v41 offset:0
  ds_read_b64_tr_b16 v[66:67], v41 offset:512
  v_mfma_f32_16x16x32_bf16 v[28:31], v[172:175], a[92:95], v[28:31]
  ds_read_b128 a[96:99], v33 offset:0
  s_add_u32 m0, s66, 65536
  v_mfma_f32_16x16x32_bf16 v[28:31], v[168:171], a[88:91], v[28:31]
  buffer_load_dwordx4 v16, s[4:7], s65 offen offset:0  lds
  v_mfma_f32_16x16x32_bf16 v[96:99], v[168:171], v[152:155], v[96:99]
  ds_read_b64_tr_b16 v[68:69], v41 offset:4096
  ds_read_b64_tr_b16 v[70:71], v41 offset:4608
  v_mfma_f32_16x16x32_bf16 v[96:99], v[172:175], v[156:159], v[96:99]
  ds_read_b128 a[100:103], v34 offset:0
  v_mfma_f32_16x16x32_bf16 v[100:103], v[172:175], v[164:167], v[100:103]
  v_lshl_add_u32 v201, v2, 13, v3
  v_lshlrev_b32_e64 v202, 11, v26
  v_mfma_f32_16x16x32_bf16 v[100:103], v[168:171], v[160:163], v[100:103]
  buffer_load_dwordx4 v17, s[4:7], s65 offen offset:1024  lds
  v_mfma_f32_16x16x32_bf16 v[104:107], v[176:179], a[80:83], v[104:107]
  ds_read_b64_tr_b16 v[72:73], v42 offset:0
  ds_read_b64_tr_b16 v[74:75], v42 offset:512
  v_mfma_f32_16x16x32_bf16 v[104:107], v[180:183], a[84:87], v[104:107]
  ds_read_b128 a[104:107], v33 offset:2048
  v_mfma_f32_16x16x32_bf16 v[108:111], v[180:183], a[92:95], v[108:111]
  v_min_u32_e64 v2, 1, v15
  v_lshl_or_b32 v202, v2, 28, v202
  v_mfma_f32_16x16x32_bf16 v[108:111], v[176:179], a[88:91], v[108:111]
  buffer_load_dwordx4 v18, s[4:7], s65 offen offset:2048  lds
  v_mfma_f32_16x16x32_bf16 v[112:115], v[176:179], v[152:155], v[112:115]
  ds_read_b64_tr_b16 v[76:77], v42 offset:4096
  ds_read_b64_tr_b16 v[78:79], v42 offset:4608
  v_mfma_f32_16x16x32_bf16 v[112:115], v[180:183], v[156:159], v[112:115]
  ds_read_b128 a[108:111], v34 offset:2048
  v_mfma_f32_16x16x32_bf16 v[116:119], v[180:183], v[164:167], v[116:119]
  buffer_load_dwordx4 v19, s[4:7], s65 offen offset:3072  lds
  v_mfma_f32_16x16x32_bf16 v[116:119], v[176:179], v[160:163], v[116:119]
  s_mul_i32 s65, s63, 393216
  s_add_u32 m0, s66, 81920
  v_mfma_f32_16x16x32_bf16 v[120:123], a[80:83], v[184:187], v[120:123]
  ds_read_b64_tr_b16 v[80:81], v41 offset:8192
  ds_read_b64_tr_b16 v[82:83], v41 offset:8704
  v_mfma_f32_16x16x32_bf16 v[120:123], a[84:87], v[188:191], v[120:123]
  ds_read_b128 v[48:51], v35 offset:0
  v_mfma_f32_16x16x32_bf16 v[124:127], a[92:95], v[188:191], v[124:127]
  buffer_load_dwordx4 v20, s[8:11], s65 offen offset:0  lds
  v_mfma_f32_16x16x32_bf16 v[124:127], a[88:91], v[184:187], v[124:127]
  ds_read_b64_tr_b16 v[84:85], v41 offset:12288
  ds_read_b64_tr_b16 v[86:87], v41 offset:12800
  v_mfma_f32_16x16x32_bf16 v[128:131], v[152:155], v[184:187], v[128:131]
  ds_read_b128 v[52:55], v36 offset:0
  v_mfma_f32_16x16x32_bf16 v[128:131], v[156:159], v[188:191], v[128:131]
  buffer_load_dwordx4 v21, s[8:11], s65 offen offset:1024  lds
  v_mfma_f32_16x16x32_bf16 v[132:135], v[164:167], v[188:191], v[132:135]
  ds_read_b64_tr_b16 v[88:89], v42 offset:8192
  ds_read_b64_tr_b16 v[90:91], v42 offset:8704
  v_mfma_f32_16x16x32_bf16 v[132:135], v[160:163], v[184:187], v[132:135]
  ds_read_b128 v[56:59], v35 offset:2048
  v_mfma_f32_16x16x32_bf16 v[136:139], a[80:83], v[192:195], v[136:139]
  s_lshl2_add_u32 s61, s58, s59
  s_lshl_b32 s62, s61, 6
  v_mfma_f32_16x16x32_bf16 v[136:139], a[84:87], v[196:199], v[136:139]
  buffer_load_dwordx4 v22, s[8:11], s65 offen offset:2048  lds
  v_mfma_f32_16x16x32_bf16 v[140:143], a[92:95], v[196:199], v[140:143]
  ds_read_b64_tr_b16 v[92:93], v42 offset:12288
  ds_read_b64_tr_b16 v[94:95], v42 offset:12800
  v_mfma_f32_16x16x32_bf16 v[140:143], a[88:91], v[192:195], v[140:143]
  ds_read_b128 v[60:63], v36 offset:2048
  v_mfma_f32_16x16x32_bf16 v[144:147], v[152:155], v[192:195], v[144:147]
  buffer_load_dwordx4 v23, s[8:11], s65 offen offset:3072  lds
  v_mfma_f32_16x16x32_bf16 v[144:147], v[156:159], v[196:199], v[144:147]
  s_add_u32 s62, s62, s57
  s_lshl_b32 s86, s62, 7
  v_mfma_f32_16x16x32_bf16 v[148:151], v[164:167], v[196:199], v[148:151]
  s_add_u32 s86, s86, 10485760
  s_lshl_b32 s87, s62, 9
  v_mfma_f32_16x16x32_bf16 v[148:151], v[160:163], v[192:195], v[148:151]
  s_waitcnt vmcnt(8) lgkmcnt(0)
  s_barrier
  v_mfma_f32_16x16x32_bf16 v[8:11], v[64:67], a[96:99], v[8:11]
  s_bfe_u32 s63, s75, 0x40004
  s_lshl_b32 s65, s63, 7
  v_mfma_f32_16x16x32_bf16 v[8:11], v[68:71], a[100:103], v[8:11]
  ds_read_b64_tr_b16 v[168:169], v41 offset:32768
  ds_read_b64_tr_b16 v[170:171], v41 offset:33280
  v_mfma_f32_16x16x32_bf16 v[28:31], v[68:71], a[108:111], v[28:31]
  ds_read_b128 a[112:115], v33 offset:32768
  s_add_u32 m0, s66, L_z2-L_z1+0
  v_mfma_f32_16x16x32_bf16 v[28:31], v[64:67], a[104:107], v[28:31]
  buffer_load_dwordx4 v16, s[4:7], s65 offen offset:0  lds
  v_mfma_f32_16x16x32_bf16 v[96:99], v[64:67], v[48:51], v[96:99]
  ds_read_b64_tr_b16 v[172:173], v41 offset:36864
  ds_read_b64_tr_b16 v[174:175], v41 offset:37376
  v_mfma_f32_16x16x32_bf16 v[96:99], v[68:71], v[52:55], v[96:99]
  ds_read_b128 a[116:119], v34 offset:32768
  v_mfma_f32_16x16x32_bf16 v[100:103], v[68:71], v[60:63], v[100:103]
  s_add_u32 s87, s87, 8388608
  s_add_u32 s88, s87, 16384
  v_mfma_f32_16x16x32_bf16 v[100:103], v[64:67], v[56:59], v[100:103]
  buffer_load_dwordx4 v17, s[4:7], s65 offen offset:1024  lds
  v_mfma_f32_16x16x32_bf16 v[104:107], v[72:75], a[96:99], v[104:107]
  ds_read_b64_tr_b16 v[176:177], v42 offset:32768
  ds_read_b64_tr_b16 v[178:179], v42 offset:33280
  v_mfma_f32_16x16x32_bf16 v[104:107], v[76:79], a[100:103], v[104:107]
  ds_read_b128 a[120:123], v33 offset:34816
  v_mfma_f32_16x16x32_bf16 v[108:111], v[76:79], a[108:111], v[108:111]
  s_lshl_b32 s89, s61, L_z2-L_z1+11
  s_add_u32 s89, s89, 11010048
  v_mfma_f32_16x16x32_bf16 v[108:111], v[72:75], a[104:107], v[108:111]
  buffer_load_dwordx4 v18, s[4:7], s65 offen offset:2048  lds
  v_mfma_f32_16x16x32_bf16 v[112:115], v[72:75], v[48:51], v[112:115]
  ds_read_b64_tr_b16 v[180:181], v42 offset:36864
  ds_read_b64_tr_b16 v[182:183], v42 offset:37376
  v_mfma_f32_16x16x32_bf16 v[112:115], v[76:79], v[52:55], v[112:115]
  ds_read_b128 a[124:127], v34 offset:34816
  v_mfma_f32_16x16x32_bf16 v[116:119], v[76:79], v[60:63], v[116:119]
  buffer_load_dwordx4 v19, s[4:7], s65 offen offset:3072  lds
  v_mfma_f32_16x16x32_bf16 v[116:119], v[72:75], v[56:59], v[116:119]
  s_mul_i32 s65, s63, s56
  s_add_u32 m0, s66, s51
  v_mfma_f32_16x16x32_bf16 v[120:123], a[96:99], v[80:83], v[120:123]
  ds_read_b64_tr_b16 v[184:185], v41 offset:40960
  ds_read_b64_tr_b16 v[186:187], v41 offset:41472
  v_mfma_f32_16x16x32_bf16 v[120:123], a[100:103], v[84:87], v[120:123]
  ds_read_b128 v[152:155], v35 offset:32768
  v_mfma_f32_16x16x32_bf16 v[124:127], a[108:111], v[84:87], v[124:127]
  buffer_load_dwordx4 v20, s[8:11], s65 offen offset:0  lds
  v_mfma_f32_16x16x32_bf16 v[124:127], a[104:107], v[80:83], v[124:127]
  ds_read_b64_tr_b16 v[188:189], v41 offset:45056
  ds_read_b64_tr_b16 v[190:191], v41 offset:45568
  v_mfma_f32_16x16x32_bf16 v[128:131], v[48:51], v[80:83], v[128:131]
  ds_read_b128 v[156:159], v36 offset:32768
  v_mfma_f32_16x16x32_bf16 v[128:131], v[52:55], v[84:87], v[128:131]
  buffer_load_dwordx4 v21, s[8:11], s65 offen offset:1024  lds
  v_mfma_f32_16x16x32_bf16 v[132:135], v[60:63], v[84:87], v[132:135]
  ds_read_b64_tr_b16 v[192:193], v42 offset:40960
  ds_read_b64_tr_b16 v[194:195], v42 offset:41472
  v_mfma_f32_16x16x32_bf16 v[132:135], v[56:59], v[80:83], v[132:135]
  ds_read_b128 v[160:163], v35 offset:34816
  v_mfma_f32_16x16x32_bf16 v[136:139], a[96:99], v[88:91], v[136:139]
  s_lshl_b32 s90, s61, L_z2-L_z1+11
  s_add_u32 s90, s90, 11403328
  v_mfma_f32_16x16x32_bf16 v[136:139], a[100:103], v[92:95], v[136:139]
  buffer_load_dwordx4 v22, s[8:11], s65 offen offset:2048  lds
  v_mfma_f32_16x16x32_bf16 v[140:143], a[108:111], v[92:95], v[140:143]
  ds_read_b64_tr_b16 v[196:197], v42 offset:45056
  ds_read_b64_tr_b16 v[198:199], v42 offset:45568
  v_mfma_f32_16x16x32_bf16 v[140:143], a[104:107], v[88:91], v[140:143]
  ds_read_b128 v[164:167], v36 offset:34816
  v_mfma_f32_16x16x32_bf16 v[144:147], v[48:51], v[88:91], v[144:147]
  buffer_load_dwordx4 v23, s[8:11], s65 offen offset:3072  lds
  v_mfma_f32_16x16x32_bf16 v[144:147], v[52:55], v[92:95], v[144:147]
  s_lshl_b32 s91, s72, 11
  s_add_u32 s91, s91, 10485760
  v_mfma_f32_16x16x32_bf16 v[148:151], v[60:63], v[92:95], v[148:151]
  s_lshl_b32 s61, s72, L_z2-L_z1+6
  s_add_u32 s61, s61, s59
  v_mfma_f32_16x16x32_bf16 v[148:151], v[56:59], v[88:91], v[148:151]
  s_waitcnt vmcnt(8) lgkmcnt(0)
  s_barrier
  v_mfma_f32_16x16x32_bf16 v[8:11], v[168:171], a[112:115], v[8:11]
  s_bfe_u32 s63, s75, 0x40008
  s_lshl_b32 s65, s63, L_z2-L_z1+7
  v_mfma_f32_16x16x32_bf16 v[8:11], v[172:175], a[116:119], v[8:11]
  ds_read_b64_tr_b16 v[64:65], v43 offset:0
  ds_read_b64_tr_b16 v[66:67], v43 offset:512
  v_mfma_f32_16x16x32_bf16 v[28:31], v[172:175], a[124:127], v[28:31]
  ds_read_b128 a[128:131], v37 offset:0
  s_add_u32 m0, s66, 32768
  v_mfma_f32_16x16x32_bf16 v[28:31], v[168:171], a[120:123], v[28:31]
  buffer_load_dwordx4 v16, s[4:7], s65 offen offset:0  lds
  v_mfma_f32_16x16x32_bf16 v[96:99], v[168:171], v[152:155], v[96:99]
  ds_read_b64_tr_b16 v[68:69], v43 offset:4096
  ds_read_b64_tr_b16 v[70:71], v43 offset:4608
  v_mfma_f32_16x16x32_bf16 v[96:99], v[172:175], v[156:159], v[96:99]
  ds_read_b128 a[132:135], v38 offset:0
  v_mfma_f32_16x16x32_bf16 v[100:103], v[172:175], v[164:167], v[100:103]
  s_lshl_b32 s92, s61, L_z2-L_z1+7
  s_add_u32 s92, s92, 8388608
  v_mfma_f32_16x16x32_bf16 v[100:103], v[168:171], v[160:163], v[100:103]
  buffer_load_dwordx4 v17, s[4:7], s65 offen offset:1024  lds
  v_mfma_f32_16x16x32_bf16 v[104:107], v[176:179], a[112:115], v[104:107]
  ds_read_b64_tr_b16 v[72:73], v44 offset:0
  ds_read_b64_tr_b16 v[74:75], v44 offset:512
  v_mfma_f32_16x16x32_bf16 v[104:107], v[180:183], a[116:119], v[104:107]
  ds_read_b128 a[136:139], v37 offset:2048
  v_mfma_f32_16x16x32_bf16 v[108:111], v[180:183], a[124:127], v[108:111]
  s_and_b32 s61, s59, 1
  s_lshl_b32 s61, s61, 6
  v_mfma_f32_16x16x32_bf16 v[108:111], v[176:179], a[120:123], v[108:111]
  buffer_load_dwordx4 v18, s[4:7], s65 offen offset:2048  lds
  v_mfma_f32_16x16x32_bf16 v[112:115], v[176:179], v[152:155], v[112:115]
  ds_read_b64_tr_b16 v[76:77], v44 offset:4096
  ds_read_b64_tr_b16 v[78:79], v44 offset:4608
  v_mfma_f32_16x16x32_bf16 v[112:115], v[180:183], v[156:159], v[112:115]
  ds_read_b128 a[140:143], v38 offset:2048
  v_mfma_f32_16x16x32_bf16 v[116:119], v[180:183], v[164:167], v[116:119]
  buffer_load_dwordx4 v19, s[4:7], s65 offen offset:3072  lds
  v_mfma_f32_16x16x32_bf16 v[116:119], v[176:179], v[160:163], v[116:119]
  s_mul_i32 s65, s63, 393216
  s_add_u32 m0, s66, 49152
  v_mfma_f32_16x16x32_bf16 v[120:123], a[112:115], v[184:187], v[120:123]
  ds_read_b64_tr_b16 v[80:81], v43 offset:8192
  ds_read_b64_tr_b16 v[82:83], v43 offset:8704
  v_mfma_f32_16x16x32_bf16 v[120:123], a[116:119], v[188:191], v[120:123]
  ds_read_b128 v[48:51], v39 offset:0
  v_mfma_f32_16x16x32_bf16 v[124:127], a[124:127], v[188:191], v[124:127]
  buffer_load_dwordx4 v20, s[8:11], s65 offen offset:0  lds
  v_mfma_f32_16x16x32_bf16 v[124:127], a[120:123], v[184:187], v[124:127]
  ds_read_b64_tr_b16 v[84:85], v43 offset:12288
  ds_read_b64_tr_b16 v[86:87], v43 offset:12800
  v_mfma_f32_16x16x32_bf16 v[128:131], v[152:155], v[184:187], v[128:131]
  ds_read_b128 v[52:55], v40 offset:0
  v_mfma_f32_16x16x32_bf16 v[128:131], v[156:159], v[188:191], v[128:131]
  buffer_load_dwordx4 v21, s[8:11], s65 offen offset:1024  lds
  v_mfma_f32_16x16x32_bf16 v[132:135], v[164:167], v[188:191], v[132:135]
  ds_read_b64_tr_b16 v[88:89], v44 offset:8192
  ds_read_b64_tr_b16 v[90:91], v44 offset:8704
  v_mfma_f32_16x16x32_bf16 v[132:135], v[160:163], v[184:187], v[132:135]
  ds_read_b128 v[56:59], v39 offset:2048
  v_mfma_f32_16x16x32_bf16 v[136:139], a[112:115], v[192:195], v[136:139]
  v_xor_b32 v203, s61, v14
  v_xor_b32 v204, 32, v203
  v_mfma_f32_16x16x32_bf16 v[136:139], a[116:119], v[196:199], v[136:139]
  buffer_load_dwordx4 v22, s[8:11], s65 offen offset:2048  lds
  v_mfma_f32_16x16x32_bf16 v[140:143], a[124:127], v[196:199], v[140:143]
  ds_read_b64_tr_b16 v[92:93], v44 offset:12288
  ds_read_b64_tr_b16 v[94:95], v44 offset:12800
  v_mfma_f32_16x16x32_bf16 v[140:143], a[120:123], v[192:195], v[140:143]
  ds_read_b128 v[60:63], v40 offset:2048
  v_mfma_f32_16x16x32_bf16 v[144:147], v[152:155], v[192:195], v[144:147]
  buffer_load_dwordx4 v23, s[8:11], s65 offen offset:3072  lds
  v_mfma_f32_16x16x32_bf16 v[144:147], v[156:159], v[196:199], v[144:147]
  v_xor_b32_e64 v205, 64, v203
  v_xor_b32 v206, 96, v203
  v_mfma_f32_16x16x32_bf16 v[148:151], v[164:167], v[196:199], v[148:151]
  v_add_u32 v207, s55, v203
  v_add_u32 v208, s55, v204
  v_mfma_f32_16x16x32_bf16 v[148:151], v[160:163], v[192:195], v[148:151]
  s_waitcnt vmcnt(8) lgkmcnt(0)
  s_barrier
  v_mfma_f32_16x16x32_bf16 v[8:11], v[64:67], a[128:131], v[8:11]
  s_bfe_u32 s63, s75, 0x4000c
  s_lshl_b32 s65, s63, L_z2-L_z1+7
  v_mfma_f32_16x16x32_bf16 v[8:11], v[68:71], a[132:135], v[8:11]
  ds_read_b64_tr_b16 v[168:169], v41 offset:0
  ds_read_b64_tr_b16 v[170:171], v41 offset:512
  v_mfma_f32_16x16x32_bf16 v[28:31], v[68:71], a[140:143], v[28:31]
  ds_read_b128 a[144:147], v33 offset:0
  s_add_u32 m0, s66, 65536
  v_mfma_f32_16x16x32_bf16 v[28:31], v[64:67], a[136:139], v[28:31]
  buffer_load_dwordx4 v16, s[4:7], s65 offen offset:0  lds
  v_mfma_f32_16x16x32_bf16 v[96:99], v[64:67], v[48:51], v[96:99]
  ds_read_b64_tr_b16 v[172:173], v41 offset:4096
  ds_read_b64_tr_b16 v[174:175], v41 offset:4608
  v_mfma_f32_16x16x32_bf16 v[96:99], v[68:71], v[52:55], v[96:99]
  ds_read_b128 a[148:151], v34 offset:0
  v_mfma_f32_16x16x32_bf16 v[100:103], v[68:71], v[60:63], v[100:103]
  v_add_u32 v209, s55, v205
  v_add_u32 v210, s55, v206
  v_mfma_f32_16x16x32_bf16 v[100:103], v[64:67], v[56:59], v[100:103]
  buffer_load_dwordx4 v17, s[4:7], s65 offen offset:1024  lds
  v_mfma_f32_16x16x32_bf16 v[104:107], v[72:75], a[128:131], v[104:107]
  ds_read_b64_tr_b16 v[176:177], v42 offset:0
  ds_read_b64_tr_b16 v[178:179], v42 offset:512
  v_mfma_f32_16x16x32_bf16 v[104:107], v[76:79], a[132:135], v[104:107]
  ds_read_b128 a[152:155], v33 offset:2048
  v_mfma_f32_16x16x32_bf16 v[108:111], v[76:79], a[140:143], v[108:111]
  v_and_b32_e64 v2, 3, v1
  v_bfe_u32 v3, v1, 2, 2
  v_mfma_f32_16x16x32_bf16 v[108:111], v[72:75], a[136:139], v[108:111]
  buffer_load_dwordx4 v18, s[4:7], s65 offen offset:2048  lds
  v_mfma_f32_16x16x32_bf16 v[112:115], v[72:75], v[48:51], v[112:115]
  ds_read_b64_tr_b16 v[180:181], v42 offset:4096
  ds_read_b64_tr_b16 v[182:183], v42 offset:4608
  v_mfma_f32_16x16x32_bf16 v[112:115], v[76:79], v[52:55], v[112:115]
  ds_read_b128 a[156:159], v34 offset:2048
  v_mfma_f32_16x16x32_bf16 v[116:119], v[76:79], v[60:63], v[116:119]
  buffer_load_dwordx4 v19, s[4:7], s65 offen offset:3072  lds
  v_mfma_f32_16x16x32_bf16 v[116:119], v[72:75], v[56:59], v[116:119]
  s_mul_i32 s65, s63, 393216
  s_add_u32 m0, s66, 81920
  v_mfma_f32_16x16x32_bf16 v[120:123], a[128:131], v[80:83], v[120:123]
  ds_read_b64_tr_b16 v[184:185], v41 offset:8192
  ds_read_b64_tr_b16 v[186:187], v41 offset:8704
  v_mfma_f32_16x16x32_bf16 v[120:123], a[132:135], v[84:87], v[120:123]
  ds_read_b128 v[152:155], v35 offset:0
  v_mfma_f32_16x16x32_bf16 v[124:127], a[140:143], v[84:87], v[124:127]
  buffer_load_dwordx4 v20, s[8:11], s65 offen offset:0  lds
  v_mfma_f32_16x16x32_bf16 v[124:127], a[136:139], v[80:83], v[124:127]
  ds_read_b64_tr_b16 v[188:189], v41 offset:12288
  ds_read_b64_tr_b16 v[190:191], v41 offset:12800
  v_mfma_f32_16x16x32_bf16 v[128:131], v[48:51], v[80:83], v[128:131]
  ds_read_b128 v[156:159], v36 offset:0
  v_mfma_f32_16x16x32_bf16 v[128:131], v[52:55], v[84:87], v[128:131]
  buffer_load_dwordx4 v21, s[8:11], s65 offen offset:1024  lds
  v_mfma_f32_16x16x32_bf16 v[132:135], v[60:63], v[84:87], v[132:135]
  ds_read_b64_tr_b16 v[192:193], v42 offset:8192
  ds_read_b64_tr_b16 v[194:195], v42 offset:8704
  v_mfma_f32_16x16x32_bf16 v[132:135], v[56:59], v[80:83], v[132:135]
  ds_read_b128 v[160:163], v35 offset:2048
  v_mfma_f32_16x16x32_bf16 v[136:139], a[128:131], v[88:91], v[136:139]
  v_lshl_add_u32 v4, v2, 3, v3
  v_lshlrev_b32_e64 v4, 7, v4
  v_mfma_f32_16x16x32_bf16 v[136:139], a[132:135], v[92:95], v[136:139]
  buffer_load_dwordx4 v22, s[8:11], s65 offen offset:2048  lds
  v_mfma_f32_16x16x32_bf16 v[140:143], a[140:143], v[92:95], v[140:143]
  ds_read_b64_tr_b16 v[196:197], v42 offset:12288
  ds_read_b64_tr_b16 v[198:199], v42 offset:12800
  v_mfma_f32_16x16x32_bf16 v[140:143], a[136:139], v[88:91], v[140:143]
  ds_read_b128 v[164:167], v36 offset:2048
  v_mfma_f32_16x16x32_bf16 v[144:147], v[48:51], v[88:91], v[144:147]
  buffer_load_dwordx4 v23, s[8:11], s65 offen offset:3072  lds
  v_mfma_f32_16x16x32_bf16 v[144:147], v[52:55], v[92:95], v[144:147]
  v_lshl_add_u32 v4, v26, 3, v4
  v_and_b32 v2, 1, v1
  v_mfma_f32_16x16x32_bf16 v[148:151], v[60:63], v[92:95], v[148:151]
  v_lshrrev_b32 v3, 1, v3
  v_lshl_or_b32 v2, v2, 1, v3
  v_mfma_f32_16x16x32_bf16 v[148:151], v[56:59], v[88:91], v[148:151]
  s_waitcnt vmcnt(8) lgkmcnt(0)
  s_barrier
  v_mfma_f32_16x16x32_bf16 v[8:11], v[168:171], a[144:147], v[8:11]
  s_bfe_u32 s63, s75, 0x40010
  s_lshl_b32 s65, s63, L_z2-L_z1+7
  v_mfma_f32_16x16x32_bf16 v[8:11], v[172:175], a[148:151], v[8:11]
  ds_read_b64_tr_b16 v[64:65], v41 offset:32768
  ds_read_b64_tr_b16 v[66:67], v41 offset:33280
  v_mfma_f32_16x16x32_bf16 v[28:31], v[172:175], a[156:159], v[28:31]
  ds_read_b128 a[160:163], v33 offset:32768
  s_add_u32 m0, s66, L_z2-L_z1+0
  v_mfma_f32_16x16x32_bf16 v[28:31], v[168:171], a[152:155], v[28:31]
  buffer_load_dwordx4 v16, s[4:7], s65 offen offset:0  lds
  v_mfma_f32_16x16x32_bf16 v[96:99], v[168:171], v[152:155], v[96:99]
  ds_read_b64_tr_b16 v[68:69], v41 offset:36864
  ds_read_b64_tr_b16 v[70:71], v41 offset:37376
  v_mfma_f32_16x16x32_bf16 v[96:99], v[172:175], v[156:159], v[96:99]
  ds_read_b128 a[164:167], v34 offset:32768
  v_mfma_f32_16x16x32_bf16 v[100:103], v[172:175], v[164:167], v[100:103]
  v_lshl_add_u32 v4, v2, 5, v4
  s_add_u32 s61, s66, 98304
  v_mfma_f32_16x16x32_bf16 v[100:103], v[168:171], v[160:163], v[100:103]
  buffer_load_dwordx4 v17, s[4:7], s65 offen offset:1024  lds
  v_mfma_f32_16x16x32_bf16 v[104:107], v[176:179], a[144:147], v[104:107]
  ds_read_b64_tr_b16 v[72:73], v42 offset:32768
  ds_read_b64_tr_b16 v[74:75], v42 offset:33280
  v_mfma_f32_16x16x32_bf16 v[104:107], v[180:183], a[148:151], v[104:107]
  ds_read_b128 a[168:171], v33 offset:34816
  v_mfma_f32_16x16x32_bf16 v[108:111], v[180:183], a[156:159], v[108:111]
  v_add_u32 v211, s61, v4
  v_xor_b32 v212, 32, v211
  v_mfma_f32_16x16x32_bf16 v[108:111], v[176:179], a[152:155], v[108:111]
  buffer_load_dwordx4 v18, s[4:7], s65 offen offset:2048  lds
  v_mfma_f32_16x16x32_bf16 v[112:115], v[176:179], v[152:155], v[112:115]
  ds_read_b64_tr_b16 v[76:77], v42 offset:36864
  ds_read_b64_tr_b16 v[78:79], v42 offset:37376
  v_mfma_f32_16x16x32_bf16 v[112:115], v[180:183], v[156:159], v[112:115]
  ds_read_b128 a[172:175], v34 offset:34816
  v_mfma_f32_16x16x32_bf16 v[116:119], v[180:183], v[164:167], v[116:119]
  buffer_load_dwordx4 v19, s[4:7], s65 offen offset:3072  lds
  v_mfma_f32_16x16x32_bf16 v[116:119], v[176:179], v[160:163], v[116:119]
  s_mul_i32 s65, s63, s56
  s_add_u32 m0, s66, s51
  v_mfma_f32_16x16x32_bf16 v[120:123], a[144:147], v[184:187], v[120:123]
  ds_read_b64_tr_b16 v[80:81], v41 offset:40960
  ds_read_b64_tr_b16 v[82:83], v41 offset:41472
  v_mfma_f32_16x16x32_bf16 v[120:123], a[148:151], v[188:191], v[120:123]
  ds_read_b128 v[48:51], v35 offset:32768
  v_mfma_f32_16x16x32_bf16 v[124:127], a[156:159], v[188:191], v[124:127]
  buffer_load_dwordx4 v20, s[8:11], s65 offen offset:0  lds
  v_mfma_f32_16x16x32_bf16 v[124:127], a[152:155], v[184:187], v[124:127]
  ds_read_b64_tr_b16 v[84:85], v41 offset:45056
  ds_read_b64_tr_b16 v[86:87], v41 offset:45568
  v_mfma_f32_16x16x32_bf16 v[128:131], v[152:155], v[184:187], v[128:131]
  ds_read_b128 v[52:55], v36 offset:32768
  v_mfma_f32_16x16x32_bf16 v[128:131], v[156:159], v[188:191], v[128:131]
  buffer_load_dwordx4 v21, s[8:11], s65 offen offset:1024  lds
  v_mfma_f32_16x16x32_bf16 v[132:135], v[164:167], v[188:191], v[132:135]
  ds_read_b64_tr_b16 v[88:89], v42 offset:40960
  ds_read_b64_tr_b16 v[90:91], v42 offset:41472
  v_mfma_f32_16x16x32_bf16 v[132:135], v[160:163], v[184:187], v[132:135]
  ds_read_b128 v[56:59], v35 offset:34816
  v_mfma_f32_16x16x32_bf16 v[136:139], a[144:147], v[192:195], v[136:139]
  v_xor_b32_e64 v213, 64, v211
  v_xor_b32 v214, 96, v211
  v_mfma_f32_16x16x32_bf16 v[136:139], a[148:151], v[196:199], v[136:139]
  buffer_load_dwordx4 v22, s[8:11], s65 offen offset:2048  lds
  v_mfma_f32_16x16x32_bf16 v[140:143], a[156:159], v[196:199], v[140:143]
  ds_read_b64_tr_b16 v[92:93], v42 offset:45056
  ds_read_b64_tr_b16 v[94:95], v42 offset:45568
  v_mfma_f32_16x16x32_bf16 v[140:143], a[152:155], v[192:195], v[140:143]
  ds_read_b128 v[60:63], v36 offset:34816
  v_mfma_f32_16x16x32_bf16 v[144:147], v[152:155], v[192:195], v[144:147]
  buffer_load_dwordx4 v23, s[8:11], s65 offen offset:3072  lds
  v_mfma_f32_16x16x32_bf16 v[144:147], v[156:159], v[196:199], v[144:147]
  v_lshlrev_b32 v2, 4, v15
  v_lshl_add_u32 v215, v26, 14, v2
  v_mfma_f32_16x16x32_bf16 v[148:151], v[164:167], v[196:199], v[148:151]
  s_lshl_b32 s93, s58, 18
  s_lshr_b32 s62, s64, L_z2-L_z1+8
  v_mfma_f32_16x16x32_bf16 v[148:151], v[160:163], v[192:195], v[148:151]
  s_waitcnt vmcnt(8) lgkmcnt(0)
  s_barrier
  v_mfma_f32_16x16x32_bf16 v[8:11], v[64:67], a[160:163], v[8:11]
  s_bfe_u32 s63, s75, 0x40014
  s_lshl_b32 s65, s63, L_z2-L_z1+7
  v_mfma_f32_16x16x32_bf16 v[8:11], v[68:71], a[164:167], v[8:11]
  ds_read_b64_tr_b16 v[168:169], v43 offset:0
  ds_read_b64_tr_b16 v[170:171], v43 offset:512
  v_mfma_f32_16x16x32_bf16 v[28:31], v[68:71], a[172:175], v[28:31]
  ds_read_b128 a[176:179], v37 offset:0
  s_add_u32 m0, s66, 32768
  v_mfma_f32_16x16x32_bf16 v[28:31], v[64:67], a[168:171], v[28:31]
  buffer_load_dwordx4 v16, s[4:7], s65 offen offset:0  lds
  v_mfma_f32_16x16x32_bf16 v[96:99], v[64:67], v[48:51], v[96:99]
  ds_read_b64_tr_b16 v[172:173], v43 offset:4096
  ds_read_b64_tr_b16 v[174:175], v43 offset:4608
  v_mfma_f32_16x16x32_bf16 v[96:99], v[68:71], v[52:55], v[96:99]
  ds_read_b128 a[180:183], v38 offset:0
  v_mfma_f32_16x16x32_bf16 v[100:103], v[68:71], v[60:63], v[100:103]
  s_add_u32 s93, s93, s62
  v_lshrrev_b32 v2, 2, v1
  v_mfma_f32_16x16x32_bf16 v[100:103], v[64:67], v[56:59], v[100:103]
  buffer_load_dwordx4 v17, s[4:7], s65 offen offset:1024  lds
  v_mfma_f32_16x16x32_bf16 v[104:107], v[72:75], a[160:163], v[104:107]
  ds_read_b64_tr_b16 v[176:177], v44 offset:0
  ds_read_b64_tr_b16 v[178:179], v44 offset:512
  v_mfma_f32_16x16x32_bf16 v[104:107], v[76:79], a[164:167], v[104:107]
  ds_read_b128 a[184:187], v37 offset:2048
  v_mfma_f32_16x16x32_bf16 v[108:111], v[76:79], a[172:175], v[108:111]
  v_lshlrev_b32 v2, 6, v2
  v_and_b32_e64 v3, 3, v1
  v_mfma_f32_16x16x32_bf16 v[108:111], v[72:75], a[168:171], v[108:111]
  buffer_load_dwordx4 v18, s[4:7], s65 offen offset:2048  lds
  v_mfma_f32_16x16x32_bf16 v[112:115], v[72:75], v[48:51], v[112:115]
  ds_read_b64_tr_b16 v[180:181], v44 offset:4096
  ds_read_b64_tr_b16 v[182:183], v44 offset:4608
  v_mfma_f32_16x16x32_bf16 v[112:115], v[76:79], v[52:55], v[112:115]
L_pg3:
  s_cbranch_execz L_back_prm
  ds_read_b128 a[188:191], v38 offset:2048
  v_mfma_f32_16x16x32_bf16 v[116:119], v[76:79], v[60:63], v[116:119]
  buffer_load_dwordx4 v19, s[4:7], s65 offen offset:3072  lds
  v_mfma_f32_16x16x32_bf16 v[116:119], v[72:75], v[56:59], v[116:119]
  s_mul_i32 s65, s63, 393216
  s_add_u32 m0, s66, 49152
  v_mfma_f32_16x16x32_bf16 v[120:123], a[160:163], v[80:83], v[120:123]
  ds_read_b64_tr_b16 v[184:185], v43 offset:8192
  ds_read_b64_tr_b16 v[186:187], v43 offset:8704
  v_mfma_f32_16x16x32_bf16 v[120:123], a[164:167], v[84:87], v[120:123]
  ds_read_b128 v[152:155], v39 offset:0
  v_mfma_f32_16x16x32_bf16 v[124:127], a[172:175], v[84:87], v[124:127]
  buffer_load_dwordx4 v20, s[8:11], s65 offen offset:0  lds
  v_mfma_f32_16x16x32_bf16 v[124:127], a[168:171], v[80:83], v[124:127]
  ds_read_b64_tr_b16 v[188:189], v43 offset:12288
  ds_read_b64_tr_b16 v[190:191], v43 offset:12800
  v_mfma_f32_16x16x32_bf16 v[128:131], v[48:51], v[80:83], v[128:131]
  ds_read_b128 v[156:159], v40 offset:0
  v_mfma_f32_16x16x32_bf16 v[128:131], v[52:55], v[84:87], v[128:131]
  buffer_load_dwordx4 v21, s[8:11], s65 offen offset:1024  lds
  v_mfma_f32_16x16x32_bf16 v[132:135], v[60:63], v[84:87], v[132:135]
  ds_read_b64_tr_b16 v[192:193], v44 offset:8192
  ds_read_b64_tr_b16 v[194:195], v44 offset:8704
  v_mfma_f32_16x16x32_bf16 v[132:135], v[56:59], v[80:83], v[132:135]
  ds_read_b128 v[160:163], v39 offset:2048
  v_mfma_f32_16x16x32_bf16 v[136:139], a[160:163], v[88:91], v[136:139]
  v_lshl_add_u32 v2, v3, 3, v2
  s_and_b32 s61, s59, L_z2-L_z1+1
  v_mfma_f32_16x16x32_bf16 v[136:139], a[164:167], v[92:95], v[136:139]
  buffer_load_dwordx4 v22, s[8:11], s65 offen offset:2048  lds
  v_mfma_f32_16x16x32_bf16 v[140:143], a[172:175], v[92:95], v[140:143]
  ds_read_b64_tr_b16 v[196:197], v44 offset:12288
  ds_read_b64_tr_b16 v[198:199], v44 offset:12800
  v_mfma_f32_16x16x32_bf16 v[140:143], a[168:171], v[88:91], v[140:143]
  ds_read_b128 v[164:167], v40 offset:2048
  v_mfma_f32_16x16x32_bf16 v[144:147], v[48:51], v[88:91], v[144:147]
  buffer_load_dwordx4 v23, s[8:11], s65 offen offset:3072  lds
  v_mfma_f32_16x16x32_bf16 v[144:147], v[52:55], v[92:95], v[144:147]
  s_lshl_b32 s61, s61, L_z2-L_z1+11
  s_add_u32 s62, s61, 133120
  v_mfma_f32_16x16x32_bf16 v[148:151], v[60:63], v[92:95], v[148:151]
  v_add_u32 v216, s62, v2
  s_sub_u32 s62, 135168, s61
  v_mfma_f32_16x16x32_bf16 v[148:151], v[56:59], v[88:91], v[148:151]
  s_waitcnt vmcnt(8) lgkmcnt(0)
  s_barrier
  v_mfma_f32_16x16x32_bf16 v[8:11], v[168:171], a[176:179], v[8:11]
  s_bfe_u32 s63, s75, 0x40018
  s_lshl_b32 s65, s63, 7
  v_mfma_f32_16x16x32_bf16 v[8:11], v[172:175], a[180:183], v[8:11]
  ds_read_b64_tr_b16 v[64:65], v41 offset:0
  ds_read_b64_tr_b16 v[66:67], v41 offset:512
  v_mfma_f32_16x16x32_bf16 v[28:31], v[172:175], a[188:191], v[28:31]
  ds_read_b128 a[192:195], v33 offset:0
  s_add_u32 m0, s66, 65536
  v_mfma_f32_16x16x32_bf16 v[28:31], v[168:171], a[184:187], v[28:31]
  buffer_load_dwordx4 v16, s[4:7], s65 offen offset:0  lds
  v_mfma_f32_16x16x32_bf16 v[96:99], v[168:171], v[152:155], v[96:99]
  ds_read_b64_tr_b16 v[68:69], v41 offset:4096
  ds_read_b64_tr_b16 v[70:71], v41 offset:4608
  v_mfma_f32_16x16x32_bf16 v[96:99], v[172:175], v[156:159], v[96:99]
  ds_read_b128 a[196:199], v34 offset:0
  v_mfma_f32_16x16x32_bf16 v[100:103], v[172:175], v[164:167], v[100:103]
  v_add_u32 v217, s62, v2
  v_lshlrev_b32 v218, 2, v26
  v_mfma_f32_16x16x32_bf16 v[100:103], v[168:171], v[160:163], v[100:103]
  buffer_load_dwordx4 v17, s[4:7], s65 offen offset:1024  lds
  v_mfma_f32_16x16x32_bf16 v[104:107], v[176:179], a[176:179], v[104:107]
  ds_read_b64_tr_b16 v[72:73], v42 offset:0
  ds_read_b64_tr_b16 v[74:75], v42 offset:512
  v_mfma_f32_16x16x32_bf16 v[104:107], v[180:183], a[180:183], v[104:107]
  ds_read_b128 a[200:203], v33 offset:2048
  v_mfma_f32_16x16x32_bf16 v[108:111], v[180:183], a[188:191], v[108:111]
  v_sub_u32_e64 v218, v218, v15
  s_add_u32 s61, s81, 2336
  v_mfma_f32_16x16x32_bf16 v[108:111], v[176:179], a[184:187], v[108:111]
  buffer_load_dwordx4 v18, s[4:7], s65 offen offset:2048  lds
  v_mfma_f32_16x16x32_bf16 v[112:115], v[176:179], v[152:155], v[112:115]
  ds_read_b64_tr_b16 v[76:77], v42 offset:4096
  ds_read_b64_tr_b16 v[78:79], v42 offset:4608
  v_mfma_f32_16x16x32_bf16 v[112:115], v[180:183], v[156:159], v[112:115]
  ds_read_b128 a[204:207], v34 offset:2048
  v_mfma_f32_16x16x32_bf16 v[116:119], v[180:183], v[164:167], v[116:119]
  buffer_load_dwordx4 v19, s[4:7], s65 offen offset:3072  lds
  v_mfma_f32_16x16x32_bf16 v[116:119], v[176:179], v[160:163], v[116:119]
  s_mul_i32 s65, s63, 393216
  s_add_u32 m0, s66, 81920
  v_mfma_f32_16x16x32_bf16 v[120:123], a[176:179], v[184:187], v[120:123]
  ds_read_b64_tr_b16 v[80:81], v41 offset:8192
  ds_read_b64_tr_b16 v[82:83], v41 offset:8704
  v_mfma_f32_16x16x32_bf16 v[120:123], a[180:183], v[188:191], v[120:123]
  ds_read_b128 v[48:51], v35 offset:0
  v_mfma_f32_16x16x32_bf16 v[124:127], a[188:191], v[188:191], v[124:127]
  buffer_load_dwordx4 v20, s[8:11], s65 offen offset:0  lds
  v_mfma_f32_16x16x32_bf16 v[124:127], a[184:187], v[184:187], v[124:127]
  ds_read_b64_tr_b16 v[84:85], v41 offset:12288
  ds_read_b64_tr_b16 v[86:87], v41 offset:12800
  v_mfma_f32_16x16x32_bf16 v[128:131], v[152:155], v[184:187], v[128:131]
  ds_read_b128 v[52:55], v36 offset:0
  v_mfma_f32_16x16x32_bf16 v[128:131], v[156:159], v[188:191], v[128:131]
  buffer_load_dwordx4 v21, s[8:11], s65 offen offset:1024  lds
  v_mfma_f32_16x16x32_bf16 v[132:135], v[164:167], v[188:191], v[132:135]
  ds_read_b64_tr_b16 v[88:89], v42 offset:8192
  ds_read_b64_tr_b16 v[90:91], v42 offset:8704
  v_mfma_f32_16x16x32_bf16 v[132:135], v[160:163], v[184:187], v[132:135]
  ds_read_b128 v[56:59], v35 offset:2048
  v_mfma_f32_16x16x32_bf16 v[136:139], a[176:179], v[192:195], v[136:139]
  v_lshl_add_u32 v218, v218, 2, s61
  v_lshlrev_b32_e64 v2, 3, v26
  v_mfma_f32_16x16x32_bf16 v[136:139], a[180:183], v[196:199], v[136:139]
  buffer_load_dwordx4 v22, s[8:11], s65 offen offset:2048  lds
  v_mfma_f32_16x16x32_bf16 v[140:143], a[188:191], v[196:199], v[140:143]
  ds_read_b64_tr_b16 v[92:93], v42 offset:12288
  ds_read_b64_tr_b16 v[94:95], v42 offset:12800
  v_mfma_f32_16x16x32_bf16 v[140:143], a[184:187], v[192:195], v[140:143]
  ds_read_b128 v[60:63], v36 offset:2048
  v_mfma_f32_16x16x32_bf16 v[144:147], v[152:155], v[192:195], v[144:147]
  buffer_load_dwordx4 v23, s[8:11], s65 offen offset:3072  lds
  v_mfma_f32_16x16x32_bf16 v[144:147], v[156:159], v[196:199], v[144:147]
  v_sub_u32 v2, v2, v15
  s_add_u32 s61, s81, 1228
  v_mfma_f32_16x16x32_bf16 v[148:151], v[164:167], v[196:199], v[148:151]
  v_lshl_add_u32 v2, v2, 1, s61
  v_and_b32 v3, 1, v15
  v_mfma_f32_16x16x32_bf16 v[148:151], v[160:163], v[192:195], v[148:151]
  s_waitcnt vmcnt(8) lgkmcnt(0)
  s_barrier
  v_mfma_f32_16x16x32_bf16 v[8:11], v[64:67], a[192:195], v[8:11]
  s_bfe_u32 s63, s75, 0x4001c
  s_lshl_b32 s65, s63, L_z2-L_z1+7
  v_mfma_f32_16x16x32_bf16 v[8:11], v[68:71], a[196:199], v[8:11]
  ds_read_b64_tr_b16 v[168:169], v41 offset:32768
  ds_read_b64_tr_b16 v[170:171], v41 offset:33280
  v_mfma_f32_16x16x32_bf16 v[28:31], v[68:71], a[204:207], v[28:31]
  ds_read_b128 a[208:211], v33 offset:32768
  s_add_u32 m0, s66, L_z2-L_z1+0
  v_mfma_f32_16x16x32_bf16 v[28:31], v[64:67], a[200:203], v[28:31]
  buffer_load_dwordx4 v16, s[4:7], s65 offen offset:0  lds
  v_mfma_f32_16x16x32_bf16 v[96:99], v[64:67], v[48:51], v[96:99]
  ds_read_b64_tr_b16 v[172:173], v41 offset:36864
  ds_read_b64_tr_b16 v[174:175], v41 offset:37376
  v_mfma_f32_16x16x32_bf16 v[96:99], v[68:71], v[52:55], v[96:99]
  ds_read_b128 a[212:215], v34 offset:32768
  v_mfma_f32_16x16x32_bf16 v[100:103], v[68:71], v[60:63], v[100:103]
  v_mul_u32_u24 v3, 1198, v3
  v_sub_u32_e64 v219, v2, v3
  v_mfma_f32_16x16x32_bf16 v[100:103], v[64:67], v[56:59], v[100:103]
  buffer_load_dwordx4 v17, s[4:7], s65 offen offset:1024  lds
  v_mfma_f32_16x16x32_bf16 v[104:107], v[72:75], a[192:195], v[104:107]
  ds_read_b64_tr_b16 v[176:177], v42 offset:32768
  ds_read_b64_tr_b16 v[178:179], v42 offset:33280
  v_mfma_f32_16x16x32_bf16 v[104:107], v[76:79], a[196:199], v[104:107]
  ds_read_b128 a[216:219], v33 offset:34816
  v_mfma_f32_16x16x32_bf16 v[108:111], v[76:79], a[204:207], v[108:111]
  v_add_u32 v220, 512, v219
  v_and_b32_e64 v3, 1, v15
  v_mfma_f32_16x16x32_bf16 v[108:111], v[72:75], a[200:203], v[108:111]
  buffer_load_dwordx4 v18, s[4:7], s65 offen offset:2048  lds
  v_mfma_f32_16x16x32_bf16 v[112:115], v[72:75], v[48:51], v[112:115]
  ds_read_b64_tr_b16 v[180:181], v42 offset:36864
  ds_read_b64_tr_b16 v[182:183], v42 offset:37376
  v_mfma_f32_16x16x32_bf16 v[112:115], v[76:79], v[52:55], v[112:115]
  ds_read_b128 a[220:223], v34 offset:34816
  v_mfma_f32_16x16x32_bf16 v[116:119], v[76:79], v[60:63], v[116:119]
  buffer_load_dwordx4 v19, s[4:7], s65 offen offset:3072  lds
  v_mfma_f32_16x16x32_bf16 v[116:119], v[72:75], v[56:59], v[116:119]
  s_mul_i32 s65, s63, s56
  s_add_u32 m0, s66, s51
  v_mfma_f32_16x16x32_bf16 v[120:123], a[192:195], v[80:83], v[120:123]
  ds_read_b64_tr_b16 v[184:185], v41 offset:40960
  ds_read_b64_tr_b16 v[186:187], v41 offset:41472
  v_mfma_f32_16x16x32_bf16 v[120:123], a[196:199], v[84:87], v[120:123]
  ds_read_b128 v[152:155], v35 offset:32768
  v_mfma_f32_16x16x32_bf16 v[124:127], a[204:207], v[84:87], v[124:127]
  buffer_load_dwordx4 v20, s[8:11], s65 offen offset:0  lds
  v_mfma_f32_16x16x32_bf16 v[124:127], a[200:203], v[80:83], v[124:127]
  ds_read_b64_tr_b16 v[188:189], v41 offset:45056
  ds_read_b64_tr_b16 v[190:191], v41 offset:45568
  v_mfma_f32_16x16x32_bf16 v[128:131], v[48:51], v[80:83], v[128:131]
  ds_read_b128 v[156:159], v36 offset:32768
  v_mfma_f32_16x16x32_bf16 v[128:131], v[52:55], v[84:87], v[128:131]
  buffer_load_dwordx4 v21, s[8:11], s65 offen offset:1024  lds
  v_mfma_f32_16x16x32_bf16 v[132:135], v[60:63], v[84:87], v[132:135]
  ds_read_b64_tr_b16 v[192:193], v42 offset:40960
  ds_read_b64_tr_b16 v[194:195], v42 offset:41472
  v_mfma_f32_16x16x32_bf16 v[132:135], v[56:59], v[80:83], v[132:135]
  ds_read_b128 v[160:163], v35 offset:34816
  v_mfma_f32_16x16x32_bf16 v[136:139], a[192:195], v[88:91], v[136:139]
  v_lshlrev_b32_e64 v3, 4, v3
  v_lshl_add_u32 v226, v26, 9, v3
  v_mfma_f32_16x16x32_bf16 v[136:139], a[196:199], v[92:95], v[136:139]
  buffer_load_dwordx4 v22, s[8:11], s65 offen offset:2048  lds
  v_mfma_f32_16x16x32_bf16 v[140:143], a[204:207], v[92:95], v[140:143]
  ds_read_b64_tr_b16 v[196:197], v42 offset:45056
  ds_read_b64_tr_b16 v[198:199], v42 offset:45568
  v_mfma_f32_16x16x32_bf16 v[140:143], a[200:203], v[88:91], v[140:143]
  ds_read_b128 v[164:167], v36 offset:34816
  v_mfma_f32_16x16x32_bf16 v[144:147], v[48:51], v[88:91], v[144:147]
  buffer_load_dwordx4 v23, s[8:11], s65 offen offset:3072  lds
  v_mfma_f32_16x16x32_bf16 v[144:147], v[52:55], v[92:95], v[144:147]
  v_lshl_add_u32 v227, v26, 5, v3
  v_lshl_add_u32 v3, v15, 1, v26
  v_mfma_f32_16x16x32_bf16 v[148:151], v[60:63], v[92:95], v[148:151]
  v_add_u32 v2, 2, v3
  v_lshrrev_b32 v4, 2, v2
  v_mfma_f32_16x16x32_bf16 v[148:151], v[56:59], v[88:91], v[148:151]
  s_waitcnt vmcnt(8) lgkmcnt(0)
  s_barrier
  v_mfma_f32_16x16x32_bf16 v[8:11], v[168:171], a[208:211], v[8:11]
  ds_read_b64_tr_b16 v[64:65], v43 offset:0
  s_bfe_u32 s70, s2, 0x20003
  v_mfma_f32_16x16x32_bf16 v[8:11], v[172:175], a[212:215], v[8:11]
  ds_read_b64_tr_b16 v[66:67], v43 offset:512
  s_lshl_b32 s70, s70, L_z2-L_z1+6
  v_mfma_f32_16x16x32_bf16 v[28:31], v[172:175], a[220:223], v[28:31]
  ds_read_b64_tr_b16 v[68:69], v43 offset:4096
  v_lshl_add_u32 v12, v0, 8, s70
  v_mfma_f32_16x16x32_bf16 v[28:31], v[168:171], a[216:219], v[28:31]
  ds_read_b64_tr_b16 v[70:71], v43 offset:4608
  v_mov_b32_e64 v7, 1
  v_mfma_f32_16x16x32_bf16 v[96:99], v[168:171], v[152:155], v[96:99]
  ds_read_b128 a[224:227], v37 offset:0
  buffer_atomic_add v7, v12, s[44:47], 0 offen sc1
  v_mfma_f32_16x16x32_bf16 v[96:99], v[172:175], v[156:159], v[96:99]
  ds_read_b128 a[228:231], v38 offset:0
  v_add_u32 v20, s76, v20
  v_mfma_f32_16x16x32_bf16 v[100:103], v[172:175], v[164:167], v[100:103]
  ds_read_b128 a[232:235], v37 offset:2048
  v_add_u32 v21, s76, v21
  v_mfma_f32_16x16x32_bf16 v[100:103], v[168:171], v[160:163], v[100:103]
  ds_read_b128 a[236:239], v38 offset:2048
  s_bfe_u32 s65, s74, 0x40000
  v_mfma_f32_16x16x32_bf16 v[104:107], v[176:179], a[208:211], v[104:107]
  ds_read_b128 v[48:51], v39 offset:0
  s_mul_i32 s65, s65, s56
  v_mfma_f32_16x16x32_bf16 v[104:107], v[180:183], a[212:215], v[104:107]
  ds_read_b128 v[52:55], v40 offset:0
  s_add_u32 m0, s77, s50
  v_mfma_f32_16x16x32_bf16 v[108:111], v[180:183], a[220:223], v[108:111]
  ds_read_b128 v[56:59], v39 offset:2048
  buffer_load_dwordx4 v20, s[8:11], s65 offen offset:0 lds
  v_mfma_f32_16x16x32_bf16 v[108:111], v[176:179], a[216:219], v[108:111]
  ds_read_b128 v[60:63], v40 offset:2048
  v_lshlrev_b32_e64 v2, 6, v2
  v_mfma_f32_16x16x32_bf16 v[112:115], v[176:179], v[152:155], v[112:115]
  ds_read_b64_tr_b16 v[72:73], v44 offset:0
  v_add_u32_e64 v2, s7, v2
  v_mfma_f32_16x16x32_bf16 v[112:115], v[180:183], v[156:159], v[112:115]
  ds_read_b64_tr_b16 v[74:75], v44 offset:512
  buffer_load_dwordx4 v21, s[8:11], s65 offen offset:1024 lds
  v_mfma_f32_16x16x32_bf16 v[116:119], v[180:183], v[164:167], v[116:119]
  ds_read_b64_tr_b16 v[76:77], v44 offset:4096
  v_add_u32_e64 v221, 3, v4
  v_mfma_f32_16x16x32_bf16 v[116:119], v[176:179], v[160:163], v[116:119]
  ds_read_b64_tr_b16 v[78:79], v44 offset:4608
  v_xor_b32_e64 v221, s59, v221
  v_mfma_f32_16x16x32_bf16 v[120:123], a[208:211], v[184:187], v[120:123]
  ds_read_b64_tr_b16 v[80:81], v43 offset:8192
  v_and_b32_e64 v221, 3, v221
  v_mfma_f32_16x16x32_bf16 v[120:123], a[212:215], v[188:191], v[120:123]
  ds_read_b64_tr_b16 v[82:83], v43 offset:8704
  v_lshl_add_u32 v221, v221, 4, v2
  v_mfma_f32_16x16x32_bf16 v[124:127], a[220:223], v[188:191], v[124:127]
  ds_read_b64_tr_b16 v[84:85], v43 offset:12288
  v_add_u32_e64 v222, 4, v4
  v_mfma_f32_16x16x32_bf16 v[124:127], a[216:219], v[184:187], v[124:127]
  ds_read_b64_tr_b16 v[86:87], v43 offset:12800
  v_xor_b32 v222, s59, v222
  v_mfma_f32_16x16x32_bf16 v[128:131], v[152:155], v[184:187], v[128:131]
  ds_read_b64_tr_b16 v[88:89], v44 offset:8192
  v_and_b32 v222, 3, v222
  v_mfma_f32_16x16x32_bf16 v[128:131], v[156:159], v[188:191], v[128:131]
  ds_read_b64_tr_b16 v[90:91], v44 offset:8704
  v_lshl_add_u32 v222, v222, 4, v2
  v_mfma_f32_16x16x32_bf16 v[132:135], v[164:167], v[188:191], v[132:135]
  ds_read_b64_tr_b16 v[92:93], v44 offset:12288
  v_add_u32 v223, 5, v4
  v_mfma_f32_16x16x32_bf16 v[132:135], v[160:163], v[184:187], v[132:135]
  ds_read_b64_tr_b16 v[94:95], v44 offset:12800
  v_xor_b32 v223, s59, v223
  v_mfma_f32_16x16x32_bf16 v[136:139], a[208:211], v[192:195], v[136:139]
  v_and_b32 v223, 3, v223
  v_lshl_add_u32 v223, v223, 4, v2
  v_mfma_f32_16x16x32_bf16 v[136:139], a[212:215], v[196:199], v[136:139]
  v_add_u32 v224, 6, v4
  v_xor_b32 v224, s59, v224
  v_mfma_f32_16x16x32_bf16 v[140:143], a[220:223], v[196:199], v[140:143]
  v_and_b32 v224, 3, v224
  v_lshl_add_u32 v224, v224, 4, v2
  v_mfma_f32_16x16x32_bf16 v[140:143], a[216:219], v[192:195], v[140:143]
  v_add_u32 v2, 1, v3
  v_lshrrev_b32 v4, 2, v2
  v_mfma_f32_16x16x32_bf16 v[144:147], v[152:155], v[192:195], v[144:147]
  v_lshlrev_b32 v2, 6, v2
  v_add_u32 v2, s7, v2
  v_mfma_f32_16x16x32_bf16 v[144:147], v[156:159], v[196:199], v[144:147]
  v_add_u32 v225, 3, v4
  v_xor_b32 v225, s59, v225
  v_mfma_f32_16x16x32_bf16 v[148:151], v[164:167], v[196:199], v[148:151]
  v_and_b32_e64 v225, 3, v225
  v_lshl_add_u32 v225, v225, 4, v2
  v_mfma_f32_16x16x32_bf16 v[148:151], v[160:163], v[192:195], v[148:151]
  v_lshlrev_b32_e64 v2, 4, v26
  s_waitcnt vmcnt(3) lgkmcnt(0)
  s_barrier
  v_mfma_f32_16x16x32_bf16 v[8:11], v[64:67], a[224:227], v[8:11]
  ds_read_b64_tr_b16 v[168:169], v41 offset:0
  v_add_u32_e64 v7, s77, v13
  v_mfma_f32_16x16x32_bf16 v[8:11], v[68:71], a[228:231], v[8:11]
  ds_read_b64_tr_b16 v[170:171], v41 offset:512
  s_add_u32 m0, s77, 137216
  v_mfma_f32_16x16x32_bf16 v[28:31], v[68:71], a[236:239], v[28:31]
  ds_read_b64_tr_b16 v[172:173], v41 offset:4096
  global_load_lds_dwordx4 v7, s[42:43] offset:0
  v_mfma_f32_16x16x32_bf16 v[28:31], v[64:67], a[232:235], v[28:31]
  ds_read_b64_tr_b16 v[174:175], v41 offset:4608
  v_xor_b32_e64 v228, v2, v13
  v_mfma_f32_16x16x32_bf16 v[96:99], v[64:67], v[48:51], v[96:99]
  ds_read_b128 a[240:243], v33 offset:0
  v_lshrrev_b32_e64 v2, 3, v1
  v_mfma_f32_16x16x32_bf16 v[96:99], v[68:71], v[52:55], v[96:99]
  ds_read_b128 a[244:247], v34 offset:0
  v_lshlrev_b32_e64 v3, 1, v26
  v_mfma_f32_16x16x32_bf16 v[100:103], v[68:71], v[60:63], v[100:103]
  ds_read_b128 a[248:251], v33 offset:2048
  global_load_lds_dwordx4 v7, s[42:43] offset:1024
  v_mfma_f32_16x16x32_bf16 v[100:103], v[64:67], v[56:59], v[100:103]
  ds_read_b128 a[252:255], v34 offset:2048
  s_bfe_u32 s65, s74, 0x40004
  v_mfma_f32_16x16x32_bf16 v[104:107], v[72:75], a[224:227], v[104:107]
  ds_read_b128 v[152:155], v35 offset:0
  s_mul_i32 s65, s65, 393216
  v_mfma_f32_16x16x32_bf16 v[104:107], v[76:79], a[228:231], v[104:107]
  ds_read_b128 v[156:159], v36 offset:0
  s_add_u32 m0, s77, 40960
  v_mfma_f32_16x16x32_bf16 v[108:111], v[76:79], a[236:239], v[108:111]
  ds_read_b128 v[160:163], v35 offset:2048
  buffer_load_dwordx4 v20, s[8:11], s65 offen offset:0 lds
  v_mfma_f32_16x16x32_bf16 v[108:111], v[72:75], a[232:235], v[108:111]
  ds_read_b128 v[164:167], v36 offset:2048
  v_and_b32_e64 v4, 7, v1
  v_mfma_f32_16x16x32_bf16 v[112:115], v[72:75], v[48:51], v[112:115]
  ds_read_b64_tr_b16 v[176:177], v42 offset:0
  v_xor_b32_e64 v3, v3, v4
  v_mfma_f32_16x16x32_bf16 v[112:115], v[76:79], v[52:55], v[112:115]
  ds_read_b64_tr_b16 v[178:179], v42 offset:512
  v_lshlrev_b32_e64 v3, 4, v3
  v_mfma_f32_16x16x32_bf16 v[116:119], v[76:79], v[60:63], v[116:119]
  ds_read_b64_tr_b16 v[180:181], v42 offset:4096
  buffer_load_dwordx4 v21, s[8:11], s65 offen offset:1024 lds
  v_mfma_f32_16x16x32_bf16 v[116:119], v[72:75], v[56:59], v[116:119]
  ds_read_b64_tr_b16 v[182:183], v42 offset:4608
  s_bfe_u32 s65, s74, 0x40008
  v_mfma_f32_16x16x32_bf16 v[120:123], a[224:227], v[80:83], v[120:123]
  ds_read_b64_tr_b16 v[184:185], v41 offset:8192
  s_mul_i32 s65, s65, 393216
  v_mfma_f32_16x16x32_bf16 v[120:123], a[228:231], v[84:87], v[120:123]
  ds_read_b64_tr_b16 v[186:187], v41 offset:8704
  s_add_u32 m0, s77, 49152
  v_mfma_f32_16x16x32_bf16 v[124:127], a[236:239], v[84:87], v[124:127]
  ds_read_b64_tr_b16 v[188:189], v41 offset:12288
  buffer_load_dwordx4 v20, s[8:11], s65 offen offset:0 lds
  v_mfma_f32_16x16x32_bf16 v[124:127], a[232:235], v[80:83], v[124:127]
  ds_read_b64_tr_b16 v[190:191], v41 offset:12800
  s_lshl_b32 s61, s69, L_z2-L_z1+7
  v_mfma_f32_16x16x32_bf16 v[128:131], v[48:51], v[80:83], v[128:131]
  ds_read_b64_tr_b16 v[192:193], v42 offset:8192
  v_lshl_add_u32 v2, v2, 11, s61
  v_mfma_f32_16x16x32_bf16 v[128:131], v[52:55], v[84:87], v[128:131]
  ds_read_b64_tr_b16 v[194:195], v42 offset:8704
  v_add_u32_e64 v229, v2, v3
  v_mfma_f32_16x16x32_bf16 v[132:135], v[60:63], v[84:87], v[132:135]
  ds_read_b64_tr_b16 v[196:197], v42 offset:12288
  buffer_load_dwordx4 v21, s[8:11], s65 offen offset:1024 lds
  v_mfma_f32_16x16x32_bf16 v[132:135], v[56:59], v[80:83], v[132:135]
  ds_read_b64_tr_b16 v[198:199], v42 offset:12800
  s_bfe_u32 s65, s74, 0x4000c
  v_mfma_f32_16x16x32_bf16 v[136:139], a[224:227], v[88:91], v[136:139]
  s_mul_i32 s65, s65, s56
  s_add_u32 m0, s77, 57344
  v_mfma_f32_16x16x32_bf16 v[136:139], a[228:231], v[92:95], v[136:139]
  s_add_u32 s83, s59, s71
  v_add_u32 v230, 15360, v229
  v_mfma_f32_16x16x32_bf16 v[140:143], a[236:239], v[92:95], v[140:143]
  buffer_load_dwordx4 v20, s[8:11], s65 offen offset:0 lds
  v_add_u32 v231, 30720, v229
  v_mfma_f32_16x16x32_bf16 v[140:143], a[232:235], v[88:91], v[140:143]
  v_add_u32 v232, 46080, v229
  v_mfma_f32_16x16x32_bf16 v[144:147], v[48:51], v[88:91], v[144:147]
  v_mfma_f32_16x16x32_bf16 v[144:147], v[52:55], v[92:95], v[144:147]
  v_mfma_f32_16x16x32_bf16 v[148:151], v[60:63], v[92:95], v[148:151]
  buffer_load_dwordx4 v21, s[8:11], s65 offen offset:1024 lds
  v_mfma_f32_16x16x32_bf16 v[148:151], v[56:59], v[88:91], v[148:151]
  s_waitcnt lgkmcnt(0)
  s_barrier
  v_mfma_f32_16x16x32_bf16 v[120:123], a[240:243], v[184:187], v[120:123]
  ds_read_b64_tr_b16 v[16:17], v216 offset:0
  s_lshl_b32 s65, s73, 7
  v_mfma_f32_16x16x32_bf16 v[120:123], a[244:247], v[188:191], v[120:123]
  ds_read_b64_tr_b16 v[18:19], v216 offset:1024
  s_add_u32 s65, s65, s64
  v_mfma_f32_16x16x32_bf16 v[124:127], a[252:255], v[188:191], v[124:127]
  ds_read_b64_tr_b16 v[36:37], v216 offset:32
  s_add_u32 m0, s66, 98304
  v_mfma_f32_16x16x32_bf16 v[124:127], a[248:251], v[184:187], v[124:127]
  ds_read_b64_tr_b16 v[38:39], v216 offset:1056
  buffer_load_dwordx4 v24, s[16:19], s65 offen offset:0 nt lds
  v_mfma_f32_16x16x32_bf16 v[128:131], v[152:155], v[184:187], v[128:131]
  ds_read_b64_tr_b16 v[40:41], v217 offset:0
  v_mfma_f32_16x16x32_bf16 v[128:131], v[156:159], v[188:191], v[128:131]
  ds_read_b64_tr_b16 v[42:43], v217 offset:1024
  buffer_load_dwordx4 v25, s[16:19], s65 offen offset:1024 nt lds
  v_mfma_f32_16x16x32_bf16 v[132:135], v[164:167], v[188:191], v[132:135]
  ds_read_b64_tr_b16 v[48:49], v217 offset:32
  s_add_u32 s65, s65, 30720
  v_mfma_f32_16x16x32_bf16 v[132:135], v[160:163], v[184:187], v[132:135]
  ds_read_b64_tr_b16 v[50:51], v217 offset:1056
  buffer_load_dwordx4 v24, s[16:19], s65 offen offset:2048 nt lds
  v_mfma_f32_16x16x32_bf16 v[136:139], a[240:243], v[192:195], v[136:139]
  v_mfma_f32_16x16x32_bf16 v[136:139], a[244:247], v[196:199], v[136:139]
  buffer_load_dwordx4 v25, s[16:19], s65 offen offset:3072 nt lds
  s_lshl2_add_u32 s65, s68, s59
  v_mfma_f32_16x16x32_bf16 v[140:143], a[252:255], v[196:199], v[140:143]
  s_lshl_b32 s65, s65, 15
  s_lshl_b32 s63, s69, 7
  v_mfma_f32_16x16x32_bf16 v[140:143], a[248:251], v[192:195], v[140:143]
  s_add_u32 s65, s65, s63
  v_lshlrev_b32_e64 v7, 11, v15
  v_mfma_f32_16x16x32_bf16 v[144:147], v[152:155], v[192:195], v[144:147]
  buffer_load_dword v6, v7, s[12:15], s65 offen
  v_mfma_f32_16x16x32_bf16 v[144:147], v[156:159], v[196:199], v[144:147]
  v_mfma_f32_16x16x32_bf16 v[148:151], v[164:167], v[196:199], v[148:151]
  v_mfma_f32_16x16x32_bf16 v[148:151], v[160:163], v[192:195], v[148:151]
  v_mfma_f32_16x16x32_bf16 v[8:11], v[168:171], a[240:243], v[8:11]
  v_cvt_pk_bf16_f32 v120, v120, v121
  v_cvt_pk_bf16_f32 v121, v122, v123
  v_mfma_f32_16x16x32_bf16 v[8:11], v[172:175], a[244:247], v[8:11]
  v_cvt_pk_bf16_f32 v122, v124, v125
  v_cvt_pk_bf16_f32 v123, v126, v127
  v_mfma_f32_16x16x32_bf16 v[104:107], v[176:179], a[240:243], v[104:107]
  ds_write_b128 v27, v[120:123] offset:0
  v_mfma_f32_16x16x32_bf16 v[104:107], v[180:183], a[244:247], v[104:107]
  v_cvt_pk_bf16_f32 v136, v136, v137
  v_cvt_pk_bf16_f32 v137, v138, v139
  v_mfma_f32_16x16x32_bf16 v[28:31], v[172:175], a[252:255], v[28:31]
  v_cvt_pk_bf16_f32 v138, v140, v141
  v_cvt_pk_bf16_f32 v139, v142, v143
  v_mfma_f32_16x16x32_bf16 v[28:31], v[168:171], a[248:251], v[28:31]
  ds_write_b128 v27, v[136:139] offset:1024
  v_mfma_f32_16x16x32_bf16 v[108:111], v[180:183], a[252:255], v[108:111]
  v_cvt_pk_bf16_f32 v128, v128, v129
  v_cvt_pk_bf16_f32 v129, v130, v131
  v_mfma_f32_16x16x32_bf16 v[108:111], v[176:179], a[248:251], v[108:111]
  v_cvt_pk_bf16_f32 v130, v132, v133
  v_cvt_pk_bf16_f32 v131, v134, v135
  v_mfma_f32_16x16x32_bf16 v[96:99], v[168:171], v[152:155], v[96:99]
  ds_write_b128 v27, v[128:131] offset:2048
  v_mfma_f32_16x16x32_bf16 v[96:99], v[172:175], v[156:159], v[96:99]
  v_cvt_pk_bf16_f32 v144, v144, v145
  v_cvt_pk_bf16_f32 v145, v146, v147
  v_mfma_f32_16x16x32_bf16 v[112:115], v[176:179], v[152:155], v[112:115]
  v_cvt_pk_bf16_f32 v146, v148, v149
  v_cvt_pk_bf16_f32 v147, v150, v151
  v_mfma_f32_16x16x32_bf16 v[112:115], v[180:183], v[156:159], v[112:115]
  ds_write_b128 v27, v[144:147] offset:3072
  v_mfma_f32_16x16x32_bf16 v[100:103], v[172:175], v[164:167], v[100:103]
  v_cvt_pk_bf16_f32 v52, v8, v9
  v_cvt_pk_bf16_f32 v53, v10, v11
  v_mfma_f32_16x16x32_bf16 v[100:103], v[168:171], v[160:163], v[100:103]
  v_cvt_pk_bf16_f32 v54, v104, v105
  v_cvt_pk_bf16_f32 v55, v106, v107
  v_mfma_f32_16x16x32_bf16 v[116:119], v[180:183], v[164:167], v[116:119]
  v_cvt_pk_bf16_f32 v56, v28, v29
  v_cvt_pk_bf16_f32 v57, v30, v31
  v_mfma_f32_16x16x32_bf16 v[116:119], v[176:179], v[160:163], v[116:119]
  v_cvt_pk_bf16_f32 v58, v108, v109
  v_cvt_pk_bf16_f32 v59, v110, v111
  s_waitcnt lgkmcnt(4)
  v_mfma_f32_16x16x32_bf16 v[8:11], v[16:19], v[52:55], 0
  s_nop 0
  v_cvt_pk_bf16_f32 v60, v96, v97
  v_cvt_pk_bf16_f32 v61, v98, v99
  v_mfma_f32_16x16x32_bf16 v[104:107], v[36:39], v[52:55], 0
  v_cvt_pk_bf16_f32 v62, v112, v113
  v_cvt_pk_bf16_f32 v63, v114, v115
  v_mfma_f32_16x16x32_bf16 v[28:31], v[16:19], v[56:59], 0
  v_cvt_pk_bf16_f32 v64, v100, v101
  v_cvt_pk_bf16_f32 v65, v102, v103
  v_mfma_f32_16x16x32_bf16 v[108:111], v[36:39], v[56:59], 0
  v_cvt_pk_bf16_f32 v66, v116, v117
  v_cvt_pk_bf16_f32 v67, v118, v119
  v_mfma_f32_16x16x32_bf16 v[96:99], v[16:19], v[60:63], 0
  v_max3_f32 v68, v8, v9, v10
  v_min3_f32 v72, v8, v9, v10
  v_mfma_f32_16x16x32_bf16 v[112:115], v[36:39], v[60:63], 0
  v_max3_f32 v69, v28, v29, v30
  v_min3_f32 v73, v28, v29, v30
  v_mfma_f32_16x16x32_bf16 v[100:103], v[16:19], v[64:67], 0
  v_max3_f32 v68, v68, v11, v104
  v_min3_f32 v72, v72, v11, v104
  v_mfma_f32_16x16x32_bf16 v[116:119], v[36:39], v[64:67], 0
  v_max3_f32 v70, v96, v97, v98
  v_min3_f32 v74, v96, v97, v98
  v_max3_f32 v69, v69, v31, v108
  v_min3_f32 v73, v73, v31, v108
  v_max3_f32 v70, v70, v99, v112
  v_max3_f32 v71, v100, v101, v102
  v_min3_f32 v75, v100, v101, v102
  v_min3_f32 v74, v74, v99, v112
  v_max3_f32 v71, v71, v103, v116
  v_min3_f32 v75, v75, v103, v116
  v_max3_f32 v68, v68, v105, v106
  v_min3_f32 v72, v72, v105, v106
  v_max3_f32 v69, v69, v109, v110
  v_min3_f32 v73, v73, v109, v110
  v_max3_f32 v70, v70, v113, v114
  v_min3_f32 v74, v74, v113, v114
  v_max3_f32 v71, v71, v117, v118
  v_min3_f32 v75, v75, v117, v118
  v_max_f32 v68, v68, v107
  v_min_f32 v72, v72, v107
  v_max_f32 v69, v69, v111
  v_min_f32 v73, v73, v111
  v_max_f32 v70, v70, v115
  v_min_f32 v74, v74, v115
  v_max_f32 v71, v71, v119
  v_min_f32 v75, v75, v119
  v_permlane16_swap_b32 v68, v69
  v_permlane16_swap_b32 v70, v71
  v_permlane16_swap_b32 v72, v73
  v_permlane16_swap_b32 v74, v75
  v_max_f32 v68, v68, v69
  v_max_f32 v70, v70, v71
  v_min_f32 v72, v72, v73
  v_min_f32 v74, v74, v75
  v_permlane32_swap_b32 v68, v70
  v_max_f32 v68, v68, v70
  v_permlane32_swap_b32 v72, v74
  v_min_f32 v72, v72, v74
  v_mul_f32 v69, s84, v68
  v_mul_f32 v73, s84, v72
  v_min_f32 v72, v69, v73
  v_mov_b32 v74, v72
  v_max_f32 v68, v69, v73
  v_mov_b32 v70, v68
  v_permlane32_swap_b32 v72, v74
  v_mov_b32 v73, v72
  v_mov_b32 v75, v74
  v_permlane32_swap_b32 v68, v70
  v_permlane16_swap_b32 v72, v73
L_pg4:
  s_cbranch_execz L_back_prm
  v_permlane16_swap_b32_e64 v74, v75
  v_pk_fma_f32 v[76:77], v[8:9], s[84:85], v[72:73] op_sel:[0,0,0] op_sel_hi:[1,1,0] neg_lo:[1,0,0] neg_hi:[1,0,0]
  v_pk_fma_f32 v[78:79], v[10:11], s[84:85], v[72:73] op_sel:[0,0,0] op_sel_hi:[1,1,0] neg_lo:[1,0,0] neg_hi:[1,0,0]
  v_pk_fma_f32 v[84:85], v[28:29], s[84:85], v[72:73] op_sel:[0,0,1] op_sel_hi:[1,1,1] neg_lo:[1,0,0] neg_hi:[1,0,0]
  v_pk_fma_f32 v[86:87], v[30:31], s[84:85], v[72:73] op_sel:[0,0,1] op_sel_hi:[1,1,1] neg_lo:[1,0,0] neg_hi:[1,0,0]
  v_pk_fma_f32 v[92:93], v[96:97], s[84:85], v[74:75] op_sel:[0,0,0] op_sel_hi:[1,1,0] neg_lo:[1,0,0] neg_hi:[1,0,0]
  v_pk_fma_f32 v[94:95], v[98:99], s[84:85], v[74:75] op_sel:[0,0,0] op_sel_hi:[1,1,0] neg_lo:[1,0,0] neg_hi:[1,0,0]
  v_pk_fma_f32 v[172:173], v[100:101], s[84:85], v[74:75] op_sel:[0,0,1] op_sel_hi:[1,1,1] neg_lo:[1,0,0] neg_hi:[1,0,0]
  v_pk_fma_f32 v[174:175], v[102:103], s[84:85], v[74:75] op_sel:[0,0,1] op_sel_hi:[1,1,1] neg_lo:[1,0,0] neg_hi:[1,0,0]
  v_mov_b32 v69, v68
  v_mov_b32 v71, v70
  v_exp_f32 v76, v76
  v_exp_f32 v77, v77
  v_exp_f32 v78, v78
  v_exp_f32 v79, v79
  v_pk_fma_f32 v[80:81], v[104:105], s[84:85], v[72:73] op_sel:[0,0,0] op_sel_hi:[1,1,0] neg_lo:[1,0,0] neg_hi:[1,0,0]
  v_exp_f32 v84, v84
  v_exp_f32 v85, v85
  v_exp_f32 v86, v86
  v_exp_f32 v87, v87
  v_pk_fma_f32 v[88:89], v[108:109], s[84:85], v[72:73] op_sel:[0,0,1] op_sel_hi:[1,1,1] neg_lo:[1,0,0] neg_hi:[1,0,0]
  v_exp_f32 v92, v92
  v_exp_f32 v93, v93
  v_exp_f32 v94, v94
  v_exp_f32 v95, v95
  v_pk_fma_f32 v[168:169], v[112:113], s[84:85], v[74:75] op_sel:[0,0,0] op_sel_hi:[1,1,0] neg_lo:[1,0,0] neg_hi:[1,0,0]
  v_exp_f32 v172, v172
  v_exp_f32 v173, v173
  v_exp_f32 v174, v174
  v_exp_f32 v175, v175
  v_pk_fma_f32 v[176:177], v[116:117], s[84:85], v[74:75] op_sel:[0,0,1] op_sel_hi:[1,1,1] neg_lo:[1,0,0] neg_hi:[1,0,0]
  v_exp_f32 v80, v80
  v_exp_f32 v81, v81
  v_pk_fma_f32 v[82:83], v[106:107], s[84:85], v[72:73] op_sel:[0,0,0] op_sel_hi:[1,1,0] neg_lo:[1,0,0] neg_hi:[1,0,0]
  v_exp_f32 v88, v88
  v_exp_f32 v89, v89
  v_pk_fma_f32 v[90:91], v[110:111], s[84:85], v[72:73] op_sel:[0,0,1] op_sel_hi:[1,1,1] neg_lo:[1,0,0] neg_hi:[1,0,0]
  v_exp_f32 v168, v168
  v_exp_f32 v169, v169
  v_pk_fma_f32 v[170:171], v[114:115], s[84:85], v[74:75] op_sel:[0,0,0] op_sel_hi:[1,1,0] neg_lo:[1,0,0] neg_hi:[1,0,0]
  v_exp_f32 v176, v176
  v_exp_f32 v177, v177
  v_pk_fma_f32 v[178:179], v[118:119], s[84:85], v[74:75] op_sel:[0,0,1] op_sel_hi:[1,1,1] neg_lo:[1,0,0] neg_hi:[1,0,0]
  v_exp_f32 v82, v82
  v_exp_f32 v83, v83
  v_exp_f32 v90, v90
  v_exp_f32 v91, v91
  v_exp_f32 v170, v170
  v_exp_f32 v171, v171
  v_exp_f32 v178, v178
  v_exp_f32 v179, v179
  v_permlane16_swap_b32 v68, v69
  v_permlane16_swap_b32 v70, v71
  v_pk_add_f32 v[34:35], v[76:77], v[78:79]
  v_pk_add_f32 v[72:73], v[84:85], v[86:87]
  v_pk_add_f32 v[74:75], v[92:93], v[94:95]
  v_pk_add_f32 v[180:181], v[172:173], v[174:175]
  v_pk_add_f32 v[34:35], v[34:35], v[80:81]
  v_pk_add_f32 v[72:73], v[72:73], v[88:89]
  v_pk_add_f32 v[74:75], v[74:75], v[168:169]
  v_pk_add_f32 v[180:181], v[180:181], v[176:177]
  v_pk_fma_f32 v[8:9], v[8:9], s[84:85], v[68:69] op_sel:[0,0,0] op_sel_hi:[1,1,0] neg_lo:[0,0,1] neg_hi:[0,0,1]
  v_pk_fma_f32 v[10:11], v[10:11], s[84:85], v[68:69] op_sel:[0,0,0] op_sel_hi:[1,1,0] neg_lo:[0,0,1] neg_hi:[0,0,1]
  v_pk_fma_f32 v[104:105], v[104:105], s[84:85], v[68:69] op_sel:[0,0,0] op_sel_hi:[1,1,0] neg_lo:[0,0,1] neg_hi:[0,0,1]
  v_pk_fma_f32 v[106:107], v[106:107], s[84:85], v[68:69] op_sel:[0,0,0] op_sel_hi:[1,1,0] neg_lo:[0,0,1] neg_hi:[0,0,1]
  v_pk_fma_f32 v[28:29], v[28:29], s[84:85], v[68:69] op_sel:[0,0,1] op_sel_hi:[1,1,1] neg_lo:[0,0,1] neg_hi:[0,0,1]
  v_pk_fma_f32 v[30:31], v[30:31], s[84:85], v[68:69] op_sel:[0,0,1] op_sel_hi:[1,1,1] neg_lo:[0,0,1] neg_hi:[0,0,1]
  v_pk_fma_f32 v[108:109], v[108:109], s[84:85], v[68:69] op_sel:[0,0,1] op_sel_hi:[1,1,1] neg_lo:[0,0,1] neg_hi:[0,0,1]
  v_pk_fma_f32 v[110:111], v[110:111], s[84:85], v[68:69] op_sel:[0,0,1] op_sel_hi:[1,1,1] neg_lo:[0,0,1] neg_hi:[0,0,1]
  v_pk_fma_f32 v[96:97], v[96:97], s[84:85], v[70:71] op_sel:[0,0,0] op_sel_hi:[1,1,0] neg_lo:[0,0,1] neg_hi:[0,0,1]
  v_pk_fma_f32 v[98:99], v[98:99], s[84:85], v[70:71] op_sel:[0,0,0] op_sel_hi:[1,1,0] neg_lo:[0,0,1] neg_hi:[0,0,1]
  v_pk_fma_f32 v[112:113], v[112:113], s[84:85], v[70:71] op_sel:[0,0,0] op_sel_hi:[1,1,0] neg_lo:[0,0,1] neg_hi:[0,0,1]
  v_pk_fma_f32 v[114:115], v[114:115], s[84:85], v[70:71] op_sel:[0,0,0] op_sel_hi:[1,1,0] neg_lo:[0,0,1] neg_hi:[0,0,1]
  v_pk_fma_f32 v[100:101], v[100:101], s[84:85], v[70:71] op_sel:[0,0,1] op_sel_hi:[1,1,1] neg_lo:[0,0,1] neg_hi:[0,0,1]
  v_pk_fma_f32 v[102:103], v[102:103], s[84:85], v[70:71] op_sel:[0,0,1] op_sel_hi:[1,1,1] neg_lo:[0,0,1] neg_hi:[0,0,1]
  v_pk_fma_f32 v[116:117], v[116:117], s[84:85], v[70:71] op_sel:[0,0,1] op_sel_hi:[1,1,1] neg_lo:[0,0,1] neg_hi:[0,0,1]
  v_pk_fma_f32 v[118:119], v[118:119], s[84:85], v[70:71] op_sel:[0,0,1] op_sel_hi:[1,1,1] neg_lo:[0,0,1] neg_hi:[0,0,1]
  v_pk_add_f32 v[34:35], v[34:35], v[82:83]
  v_pk_add_f32 v[72:73], v[72:73], v[90:91]
  v_pk_add_f32 v[74:75], v[74:75], v[170:171]
  v_pk_add_f32 v[180:181], v[180:181], v[178:179]
  v_add_f32 v68, v34, v35
  v_add_f32 v69, v72, v73
  v_add_f32 v70, v74, v75
  v_add_f32 v71, v180, v181
  v_permlane16_swap_b32 v68, v69
  v_add_f32 v68, v68, v69
  v_permlane16_swap_b32 v70, v71
  v_add_f32 v70, v70, v71
  v_xor_b32 v27, 8192, v27
  s_nop 0
  v_permlane32_swap_b32 v68, v70
  v_add_f32 v68, v68, v70
  v_rcp_f32 v68, v68
  s_nop 0
  v_mov_b32 v70, v68
  s_nop 1
  v_permlane32_swap_b32 v68, v70
  v_mov_b32 v69, v68
  v_mov_b32 v71, v70
  s_nop 0
  v_permlane16_swap_b32 v68, v69
  v_pk_mul_f32 v[76:77], v[76:77], v[68:69] op_sel:[0,0] op_sel_hi:[1,0]
  v_pk_mul_f32 v[78:79], v[78:79], v[68:69] op_sel:[0,0] op_sel_hi:[1,0]
  v_pk_mul_f32 v[80:81], v[80:81], v[68:69] op_sel:[0,0] op_sel_hi:[1,0]
  v_pk_mul_f32 v[82:83], v[82:83], v[68:69] op_sel:[0,0] op_sel_hi:[1,0]
  v_cvt_pk_bf16_f32 v52, v76, v77
  v_cvt_pk_bf16_f32 v53, v78, v79
  v_cvt_pk_bf16_f32 v54, v80, v81
  v_cvt_pk_bf16_f32 v55, v82, v83
  ds_write_b128 v32, v[52:55] offset:4096
  v_pk_mul_f32 v[84:85], v[84:85], v[68:69] op_sel:[0,1] op_sel_hi:[1,1]
  v_pk_mul_f32 v[86:87], v[86:87], v[68:69] op_sel:[0,1] op_sel_hi:[1,1]
  v_pk_mul_f32 v[88:89], v[88:89], v[68:69] op_sel:[0,1] op_sel_hi:[1,1]
  v_pk_mul_f32 v[90:91], v[90:91], v[68:69] op_sel:[0,1] op_sel_hi:[1,1]
  v_cvt_pk_bf16_f32 v56, v84, v85
  v_cvt_pk_bf16_f32 v57, v86, v87
  v_cvt_pk_bf16_f32 v58, v88, v89
  v_cvt_pk_bf16_f32 v59, v90, v91
  ds_write_b128 v32, v[56:59] offset:5120
  v_permlane16_swap_b32_e64 v70, v71
  v_pk_mul_f32 v[92:93], v[92:93], v[70:71] op_sel:[0,0] op_sel_hi:[1,0]
  v_pk_mul_f32 v[94:95], v[94:95], v[70:71] op_sel:[0,0] op_sel_hi:[1,0]
  v_pk_mul_f32 v[168:169], v[168:169], v[70:71] op_sel:[0,0] op_sel_hi:[1,0]
  v_pk_mul_f32 v[170:171], v[170:171], v[70:71] op_sel:[0,0] op_sel_hi:[1,0]
  v_cvt_pk_bf16_f32 v60, v92, v93
  v_cvt_pk_bf16_f32 v61, v94, v95
  v_cvt_pk_bf16_f32 v62, v168, v169
  v_cvt_pk_bf16_f32 v63, v170, v171
  ds_write_b128 v32, v[60:63] offset:6144
  v_pk_mul_f32 v[172:173], v[172:173], v[70:71] op_sel:[0,1] op_sel_hi:[1,1]
  v_pk_mul_f32 v[174:175], v[174:175], v[70:71] op_sel:[0,1] op_sel_hi:[1,1]
  v_pk_mul_f32 v[176:177], v[176:177], v[70:71] op_sel:[0,1] op_sel_hi:[1,1]
  v_pk_mul_f32 v[178:179], v[178:179], v[70:71] op_sel:[0,1] op_sel_hi:[1,1]
  v_cvt_pk_bf16_f32 v64, v172, v173
  v_cvt_pk_bf16_f32 v65, v174, v175
  v_cvt_pk_bf16_f32 v66, v176, v177
  v_cvt_pk_bf16_f32 v67, v178, v179
  ds_write_b128 v32, v[64:67] offset:7168
  v_mov_b32 v68, 0x3f803f80
  v_mov_b32 v69, v68
  v_mov_b32 v70, v68
  v_mov_b32 v71, v68
  v_exp_f32 v8, v8
  v_exp_f32 v9, v9
  v_exp_f32 v10, v10
  v_exp_f32 v11, v11
  v_exp_f32 v104, v104
  v_exp_f32_e64 v105, v105
  s_waitcnt vmcnt(5) lgkmcnt(0)
  s_barrier
  ds_read_b128 v[152:155], v27 offset:0
  ds_read_b64_tr_b16 v[188:189], v46 offset:0
  ds_read_b64_tr_b16 v[190:191], v46 offset:1024
  ds_read_b64_tr_b16 v[192:193], v46 offset:8
  ds_read_b64_tr_b16 v[194:195], v46 offset:1032
  ds_read_b128 v[156:159], v27 offset:1024
  ds_read_b128 v[160:163], v27 offset:2048
  ds_read_b64_tr_b16 v[196:197], v46 offset:2048
  ds_read_b64_tr_b16 v[198:199], v46 offset:3072
  ds_read_b64_tr_b16 v[236:237], v46 offset:2056
  ds_read_b64_tr_b16 v[238:239], v46 offset:3080
  ds_read_b128 v[164:167], v27 offset:3072
  v_exp_f32 v28, v28
  v_exp_f32 v29, v29
  v_exp_f32 v30, v30
  v_exp_f32 v31, v31
  v_exp_f32 v96, v96
  v_exp_f32 v97, v97
  v_exp_f32 v98, v98
  v_exp_f32 v99, v99
  v_exp_f32 v100, v100
  s_waitcnt lgkmcnt(9)
  v_mfma_f32_16x16x32_bf16 v[124:127], v[188:191], v[152:155], 0
  v_exp_f32 v101, v101
  s_waitcnt lgkmcnt(7)
  v_mfma_f32_16x16x32_bf16 v[140:143], v[192:195], v[152:155], 0
  v_and_b32 v12, 3, v1
  v_exp_f32 v102, v102
  s_waitcnt lgkmcnt(6)
  v_mfma_f32_16x16x32_bf16 v[132:135], v[188:191], v[156:159], 0
  v_exp_f32 v103, v103
  v_mfma_f32_16x16x32_bf16 v[148:151], v[192:195], v[156:159], 0
  v_lshlrev_b32 v12, 6, v12
  v_exp_f32 v108, v108
  v_mfma_f32_16x16x32_bf16 v[180:183], v[188:191], v[68:71], 0
  v_exp_f32_e64 v109, v109
  v_mfma_f32_16x16x32_bf16 v[184:187], v[192:195], v[68:71], 0
  global_load_dword v12, v12, s[44:45] sc1
  v_exp_f32 v112, v112
  s_waitcnt lgkmcnt(3)
  v_mfma_f32_16x16x32_bf16 v[124:127], v[196:199], v[160:163], v[124:127]
  v_exp_f32 v113, v113
  s_waitcnt lgkmcnt(1)
  v_mfma_f32_16x16x32_bf16 v[140:143], v[236:239], v[160:163], v[140:143]
  s_bfe_u32 s65, s74, 0x40010
  v_exp_f32 v116, v116
  s_waitcnt lgkmcnt(0)
  v_mfma_f32_16x16x32_bf16 v[132:135], v[196:199], v[164:167], v[132:135]
  v_exp_f32_e64 v117, v117
  v_mfma_f32_16x16x32_bf16 v[148:151], v[236:239], v[164:167], v[148:151]
  s_mul_i32 s65, s65, 393216
  v_exp_f32_e64 v106, v106
  v_mfma_f32_16x16x32_bf16 v[180:183], v[196:199], v[68:71], v[180:183]
  v_exp_f32_e64 v107, v107
  v_mfma_f32_16x16x32_bf16 v[184:187], v[236:239], v[68:71], v[184:187]
  s_add_u32 m0, s77, 65536
  v_exp_f32 v110, v110
  v_exp_f32 v111, v111
  v_exp_f32 v114, v114
  v_exp_f32 v115, v115
  v_exp_f32 v118, v118
  v_exp_f32 v119, v119
  v_pk_add_f32 v[34:35], v[8:9], v[10:11]
  v_pk_add_f32 v[216:217], v[28:29], v[30:31]
  v_pk_add_f32 v[234:235], v[96:97], v[98:99]
  v_pk_add_f32 v[244:245], v[100:101], v[102:103]
  v_pk_add_f32 v[34:35], v[34:35], v[104:105]
  v_pk_add_f32 v[216:217], v[216:217], v[108:109]
  v_pk_add_f32 v[234:235], v[234:235], v[112:113]
  v_pk_add_f32 v[244:245], v[244:245], v[116:117]
  v_pk_add_f32 v[34:35], v[34:35], v[106:107]
  v_pk_add_f32 v[216:217], v[216:217], v[110:111]
  v_pk_add_f32 v[234:235], v[234:235], v[114:115]
  v_pk_add_f32 v[244:245], v[244:245], v[118:119]
  v_add_f32 v240, v34, v35
  v_add_f32 v241, v216, v217
  v_add_f32 v242, v234, v235
  v_add_f32 v243, v244, v245
  v_permlane16_swap_b32 v240, v241
  v_add_f32 v240, v240, v241
  v_permlane16_swap_b32 v242, v243
  v_add_f32 v242, v242, v243
  s_nop 1
  v_permlane32_swap_b32 v240, v242
  v_add_f32 v240, v240, v242
  v_rcp_f32 v240, v240
  s_nop 0
  v_mov_b32 v242, v240
  s_nop 1
  v_permlane32_swap_b32 v240, v242
  v_mov_b32 v241, v240
  v_mov_b32_e64 v243, v242
  s_nop 0
  v_permlane16_swap_b32_e64 v240, v241
  v_pk_mul_f32 v[8:9], v[8:9], v[240:241] op_sel:[0,0] op_sel_hi:[1,0]
  v_pk_mul_f32 v[10:11], v[10:11], v[240:241] op_sel:[0,0] op_sel_hi:[1,0]
  v_pk_mul_f32 v[104:105], v[104:105], v[240:241] op_sel:[0,0] op_sel_hi:[1,0]
  v_pk_mul_f32 v[106:107], v[106:107], v[240:241] op_sel:[0,0] op_sel_hi:[1,0]
  v_cvt_pk_bf16_f32 v52, v8, v9
  v_cvt_pk_bf16_f32 v53, v10, v11
  v_cvt_pk_bf16_f32 v54, v104, v105
  v_cvt_pk_bf16_f32 v55, v106, v107
  ds_write_b128 v32, v[52:55] offset:0
  v_pk_mul_f32 v[28:29], v[28:29], v[240:241] op_sel:[0,1] op_sel_hi:[1,1]
  v_pk_mul_f32 v[30:31], v[30:31], v[240:241] op_sel:[0,1] op_sel_hi:[1,1]
  v_pk_mul_f32 v[108:109], v[108:109], v[240:241] op_sel:[0,1] op_sel_hi:[1,1]
  v_pk_mul_f32 v[110:111], v[110:111], v[240:241] op_sel:[0,1] op_sel_hi:[1,1]
  v_cvt_pk_bf16_f32 v56, v28, v29
  v_cvt_pk_bf16_f32 v57, v30, v31
  v_cvt_pk_bf16_f32 v58, v108, v109
  v_cvt_pk_bf16_f32 v59, v110, v111
  ds_write_b128 v32, v[56:59] offset:1024
  ds_read_b64_tr_b16 v[188:189], v45 offset:0
  ds_read_b64_tr_b16 v[190:191], v45 offset:1024
  ds_read_b64_tr_b16 v[192:193], v45 offset:8
  ds_read_b64_tr_b16 v[194:195], v45 offset:1032
  v_permlane16_swap_b32_e64 v242, v243
  v_pk_mul_f32 v[96:97], v[96:97], v[242:243] op_sel:[0,0] op_sel_hi:[1,0]
  v_pk_mul_f32 v[98:99], v[98:99], v[242:243] op_sel:[0,0] op_sel_hi:[1,0]
  v_pk_mul_f32 v[112:113], v[112:113], v[242:243] op_sel:[0,0] op_sel_hi:[1,0]
  v_pk_mul_f32 v[114:115], v[114:115], v[242:243] op_sel:[0,0] op_sel_hi:[1,0]
  v_cvt_pk_bf16_f32 v60, v96, v97
  v_cvt_pk_bf16_f32 v61, v98, v99
  v_cvt_pk_bf16_f32 v62, v112, v113
  v_cvt_pk_bf16_f32 v63, v114, v115
  ds_write_b128 v32, v[60:63] offset:2048
  v_pk_mul_f32 v[100:101], v[100:101], v[242:243] op_sel:[0,1] op_sel_hi:[1,1]
  v_pk_mul_f32 v[102:103], v[102:103], v[242:243] op_sel:[0,1] op_sel_hi:[1,1]
  v_pk_mul_f32 v[116:117], v[116:117], v[242:243] op_sel:[0,1] op_sel_hi:[1,1]
  v_pk_mul_f32 v[118:119], v[118:119], v[242:243] op_sel:[0,1] op_sel_hi:[1,1]
  v_cvt_pk_bf16_f32 v64, v100, v101
  v_cvt_pk_bf16_f32 v65, v102, v103
  s_waitcnt lgkmcnt(3)
  v_mfma_f32_16x16x32_bf16 v[124:127], v[188:191], v[120:123], v[124:127]
  ds_read_b64_tr_b16 v[72:73], v203 offset:32768
  v_cvt_pk_bf16_f32 v66, v116, v117
  v_cvt_pk_bf16_f32 v67, v118, v119
  s_waitcnt lgkmcnt(2)
  v_mfma_f32_16x16x32_bf16 v[140:143], v[192:195], v[120:123], v[140:143]
  buffer_load_dwordx4 v20, s[8:11], s65 offen offset:0 lds
  ds_read_b64_tr_b16 v[74:75], v203 offset:33280
  ds_write_b128 v32, v[64:67] offset:3072
  v_mfma_f32_16x16x32_bf16 v[132:135], v[188:191], v[136:139], v[132:135]
  ds_read_b64_tr_b16 v[76:77], v203 offset:36864
  ds_read_b64_tr_b16 v[196:197], v45 offset:2048
  ds_read_b64_tr_b16 v[198:199], v45 offset:3072
  v_mfma_f32_16x16x32_bf16 v[148:151], v[192:195], v[136:139], v[148:151]
  buffer_load_dwordx4 v21, s[8:11], s65 offen offset:1024 lds
  ds_read_b64_tr_b16 v[78:79], v203 offset:37376
  ds_read_b64_tr_b16 v[236:237], v45 offset:2056
  ds_read_b64_tr_b16 v[238:239], v45 offset:3080
  v_mfma_f32_16x16x32_bf16 v[180:183], v[188:191], v[68:71], v[180:183]
  s_bfe_u32 s65, s74, 0x40014
  s_mul_i32 s65, s65, 393216
  ds_read_b64_tr_b16 v[80:81], v204 offset:32768
  v_mfma_f32_16x16x32_bf16 v[184:187], v[192:195], v[68:71], v[184:187]
  s_add_u32 m0, s77, 73728
  ds_read_b64_tr_b16 v[82:83], v204 offset:33280
  s_waitcnt lgkmcnt(5)
  v_mfma_f32_16x16x32_bf16 v[124:127], v[196:199], v[128:131], v[124:127]
  buffer_load_dwordx4 v20, s[8:11], s65 offen offset:0 lds
  ds_read_b64_tr_b16 v[84:85], v204 offset:36864
  s_waitcnt lgkmcnt(3)
  v_mfma_f32_16x16x32_bf16 v[140:143], v[236:239], v[128:131], v[140:143]
  buffer_load_dwordx4 v21, s[8:11], s65 offen offset:1024 lds
  ds_read_b64_tr_b16 v[86:87], v204 offset:37376
  v_mfma_f32_16x16x32_bf16 v[132:135], v[196:199], v[144:147], v[132:135]
  ds_read_b64_tr_b16 v[88:89], v205 offset:32768
  v_mfma_f32_16x16x32_bf16 v[148:151], v[236:239], v[144:147], v[148:151]
  ds_read_b64_tr_b16 v[90:91], v205 offset:33280
  v_mfma_f32_16x16x32_bf16 v[180:183], v[196:199], v[68:71], v[180:183]
  ds_read_b64_tr_b16 v[92:93], v205 offset:36864
  v_mfma_f32_16x16x32_bf16 v[184:187], v[236:239], v[68:71], v[184:187]
  ds_read_b64_tr_b16 v[94:95], v205 offset:37376
  v_cvt_pk_bf16_f32 v152, v124, v125
  v_cvt_pk_bf16_f32 v153, v126, v127
  v_cvt_pk_bf16_f32 v154, v140, v141
  v_cvt_pk_bf16_f32 v155, v142, v143
  buffer_store_dwordx4 v[152:155], v201, s[24:27], s87 offen sc1
  v_cvt_pk_bf16_f32 v156, v132, v133
  v_cvt_pk_bf16_f32 v157, v134, v135
  v_cvt_pk_bf16_f32 v158, v148, v149
  v_cvt_pk_bf16_f32 v159, v150, v151
  buffer_store_dwordx4 v[156:159], v201, s[24:27], s88 offen sc1
  v_cvt_pk_bf16_f32 v176, v180, v181
  v_cvt_pk_bf16_f32 v177, v182, v183
  v_cvt_pk_bf16_f32 v178, v184, v185
  v_cvt_pk_bf16_f32 v179, v186, v187
  s_barrier
  s_waitcnt lgkmcnt(4)
  v_mfma_f32_16x16x32_bf16 v[8:11], v[72:75], a[0:3], 0
  ds_read_b64_tr_b16 v[96:97], v203 offset:40960
  ds_read_b64_tr_b16 v[168:169], v206 offset:32768
  v_mfma_f32_16x16x32_bf16 v[8:11], v[76:79], a[4:7], v[8:11]
  ds_read_b64_tr_b16 v[98:99], v203 offset:41472
  ds_read_b64_tr_b16 v[170:171], v206 offset:33280
  v_mfma_f32_16x16x32_bf16 v[28:31], v[76:79], a[12:15], 0
  ds_read_b64_tr_b16 v[100:101], v203 offset:45056
  ds_read_b64_tr_b16 v[172:173], v206 offset:36864
  v_mfma_f32_16x16x32_bf16 v[28:31], v[72:75], a[8:11], v[28:31]
  ds_read_b64_tr_b16 v[102:103], v203 offset:45568
  ds_read_b64_tr_b16 v[174:175], v206 offset:37376
  v_mfma_f32_16x16x32_bf16 v[52:55], v[80:83], a[8:11], 0
  ds_read_b64_tr_b16 v[104:105], v204 offset:40960
  s_bfe_u32 s65, s74, 0x40018
  v_mfma_f32_16x16x32_bf16 v[52:55], v[84:87], a[12:15], v[52:55]
  ds_read_b64_tr_b16 v[106:107], v204 offset:41472
  s_mul_i32 s65, s65, 393216
  v_mfma_f32_16x16x32_bf16 v[32:35], v[84:87], a[4:7], 0
  ds_read_b64_tr_b16 v[108:109], v204 offset:45056
  s_add_u32 m0, s77, 81920
  v_mfma_f32_16x16x32_bf16 v[32:35], v[80:83], a[0:3], v[32:35]
  ds_read_b64_tr_b16 v[110:111], v204 offset:45568
  buffer_load_dwordx4 v20, s[8:11], s65 offen offset:0 lds
  s_waitcnt lgkmcnt(4)
  v_mfma_f32_16x16x32_bf16 v[56:59], v[88:91], a[0:3], 0
  ds_read_b64_tr_b16 v[112:113], v205 offset:40960
  s_waitcnt vmcnt(9)
  v_mfma_f32_16x16x32_bf16 v[56:59], v[92:95], a[4:7], v[56:59]
  ds_read_b64_tr_b16 v[114:115], v205 offset:41472
  ds_read_b64_tr_b16 v[128:129], v211 offset:0
  v_mfma_f32_16x16x32_bf16 v[60:63], v[92:95], a[12:15], 0
  ds_read_b64_tr_b16 v[116:117], v205 offset:45056
  ds_read_b64_tr_b16 v[130:131], v211 offset:512
  v_mfma_f32_16x16x32_bf16 v[60:63], v[88:91], a[8:11], v[60:63]
  ds_read_b64_tr_b16 v[118:119], v205 offset:45568
  buffer_load_dwordx4 v21, s[8:11], s65 offen offset:1024 lds
  v_mfma_f32_16x16x32_bf16 v[68:71], v[168:171], a[8:11], 0
  ds_read_b64_tr_b16 v[120:121], v206 offset:40960
  s_bfe_u32 s65, s74, 0x4001c
  v_mfma_f32_16x16x32_bf16 v[68:71], v[172:175], a[12:15], v[68:71]
  ds_read_b64_tr_b16 v[122:123], v206 offset:41472
  s_mul_i32 s65, s65, s56
  v_mfma_f32_16x16x32_bf16 v[64:67], v[172:175], a[4:7], 0
  ds_read_b64_tr_b16 v[124:125], v206 offset:45056
  s_add_u32 m0, s77, 90112
  v_mfma_f32_16x16x32_bf16 v[64:67], v[168:171], a[0:3], v[64:67]
  ds_read_b64_tr_b16 v[126:127], v206 offset:45568
  buffer_load_dwordx4 v20, s[8:11], s65 offen offset:0 lds
  s_waitcnt lgkmcnt(10)
  v_mfma_f32_16x16x32_bf16 v[8:11], v[96:99], a[16:19], v[8:11]
  ds_read_b64_tr_b16 v[72:73], v203 offset:49152
  ds_read_b64_tr_b16 v[132:133], v212 offset:0
  v_mfma_f32_16x16x32_bf16 v[8:11], v[100:103], a[20:23], v[8:11]
  ds_read_b64_tr_b16 v[74:75], v203 offset:49664
  ds_read_b64_tr_b16 v[134:135], v212 offset:512
  v_mfma_f32_16x16x32_bf16 v[28:31], v[100:103], a[28:31], v[28:31]
  ds_read_b64_tr_b16 v[76:77], v203 offset:53248
  ds_read_b64_tr_b16 v[136:137], v213 offset:0
  v_mfma_f32_16x16x32_bf16 v[28:31], v[96:99], a[24:27], v[28:31]
  ds_read_b64_tr_b16 v[78:79], v203 offset:53760
  buffer_load_dwordx4 v21, s[8:11], s65 offen offset:1024 lds
  v_mfma_f32_16x16x32_bf16 v[52:55], v[104:107], a[24:27], v[52:55]
  ds_read_b64_tr_b16 v[80:81], v204 offset:49152
  ds_read_b64_tr_b16 v[138:139], v213 offset:512
  v_mfma_f32_16x16x32_bf16 v[52:55], v[108:111], a[28:31], v[52:55]
  ds_read_b64_tr_b16 v[82:83], v204 offset:49664
  ds_read_b64_tr_b16 v[140:141], v214 offset:0
  v_mfma_f32_16x16x32_bf16 v[32:35], v[108:111], a[20:23], v[32:35]
  ds_read_b64_tr_b16 v[84:85], v204 offset:53248
  ds_read_b64_tr_b16 v[142:143], v214 offset:512
  v_mfma_f32_16x16x32_bf16 v[32:35], v[104:107], a[16:19], v[32:35]
  ds_read_b64_tr_b16 v[86:87], v204 offset:53760
  v_mov_b32 v2, s81
  s_waitcnt lgkmcnt(14)
  v_mfma_f32_16x16x32_bf16 v[56:59], v[112:115], a[16:19], v[56:59]
  ds_read_b64_tr_b16 v[88:89], v205 offset:49152
  s_bfe_u32 s65, s75, 0x40000
  v_mfma_f32_16x16x32_bf16 v[56:59], v[116:119], a[20:23], v[56:59]
  ds_read_b64_tr_b16 v[90:91], v205 offset:49664
  s_mul_i32 s65, s65, 393216
  v_mfma_f32_16x16x32_bf16 v[60:63], v[116:119], a[28:31], v[60:63]
  ds_read_b64_tr_b16 v[92:93], v205 offset:53248
  s_add_u32 m0, s77, L_z2-L_z1+0
  v_mfma_f32_16x16x32_bf16 v[60:63], v[112:115], a[24:27], v[60:63]
  ds_read_b64_tr_b16 v[94:95], v205 offset:53760
  buffer_load_dwordx4 v20, s[8:11], s65 offen offset:0 lds
  v_mfma_f32_16x16x32_bf16 v[68:71], v[120:123], a[24:27], v[68:71]
  ds_read_b64_tr_b16 v[168:169], v206 offset:49152
  v_mov_b32_e64 v4, 0
  v_mfma_f32_16x16x32_bf16 v[68:71], v[124:127], a[28:31], v[68:71]
  ds_read_b64_tr_b16 v[170:171], v206 offset:49664
  ds_read_u16 v46, v2 offset:2658
  v_mfma_f32_16x16x32_bf16 v[64:67], v[124:127], a[20:23], v[64:67]
  ds_read_b64_tr_b16 v[172:173], v206 offset:53248
  v_lshlrev_b32 v3, 3, v0
  v_mfma_f32_16x16x32_bf16 v[64:67], v[120:123], a[16:19], v[64:67]
  ds_read_b64_tr_b16 v[174:175], v206 offset:53760
  buffer_load_dwordx4 v21, s[8:11], s65 offen offset:1024 lds
  s_waitcnt lgkmcnt(9)
  v_mfma_f32_16x16x32_bf16 v[8:11], v[72:75], a[32:35], v[8:11]
  ds_read_b64_tr_b16 v[96:97], v203 offset:57344
  s_waitcnt vmcnt(12)
  v_cmp_gt_u32 vcc, 64, v12
  v_mfma_f32_16x16x32_bf16 v[8:11], v[76:79], a[36:39], v[8:11]
  ds_read_b64_tr_b16 v[98:99], v203 offset:57856
  s_cbranch_vccnz L_ci_retry
L_ci_ok:
  v_mfma_f32_16x16x32_bf16 v[28:31], v[76:79], a[44:47], v[28:31]
  ds_read_b64_tr_b16 v[100:101], v203 offset:61440
  s_waitcnt vmcnt(6)
  v_mfma_f32_16x16x32_bf16 v[28:31], v[72:75], a[40:43], v[28:31]
  ds_read_b64_tr_b16 v[102:103], v203 offset:61952
  buffer_store_dwordx4 v[176:179], v202, s[24:27], s86 offen sc1
  v_mfma_f32_16x16x32_bf16 v[52:55], v[80:83], a[40:43], v[52:55]
  ds_read_b64_tr_b16 v[104:105], v204 offset:57344
  v_add_u32_e64 v3, s7, v3
  v_mfma_f32_16x16x32_bf16 v[52:55], v[84:87], a[44:47], v[52:55]
  ds_read_b64_tr_b16 v[106:107], v204 offset:57856
  ds_write2_b32 v3, v4, v4 offset0:0 offset1:1
  v_mfma_f32_16x16x32_bf16 v[32:35], v[84:87], a[36:39], v[32:35]
  ds_read_b64_tr_b16 v[108:109], v204 offset:61440
  v_add_u32 v180, s81, v13
  v_mfma_f32_16x16x32_bf16 v[32:35], v[80:83], a[32:35], v[32:35]
  ds_read_b64_tr_b16 v[110:111], v204 offset:61952
  buffer_store_dwordx4 v[128:131], v215, s[24:27], s93 offen sc1
  s_waitcnt lgkmcnt(9)
  v_mfma_f32_16x16x32_bf16 v[56:59], v[88:91], a[32:35], v[56:59]
  ds_read_b64_tr_b16 v[112:113], v205 offset:57344
  s_add_u32 s93, s93, 65536
  v_mfma_f32_16x16x32_bf16 v[56:59], v[92:95], a[36:39], v[56:59]
  ds_read_b64_tr_b16 v[114:115], v205 offset:57856
  s_lshl_b32 s61, s59, L_z2-L_z1+7
  v_mfma_f32_16x16x32_bf16 v[60:63], v[92:95], a[44:47], v[60:63]
  ds_read_b64_tr_b16 v[116:117], v205 offset:61440
  s_add_u32 s62, s61, 162560
  v_mfma_f32_16x16x32_bf16 v[60:63], v[88:91], a[40:43], v[60:63]
  ds_read_b64_tr_b16 v[118:119], v205 offset:61952
  buffer_store_dwordx4 v[132:135], v215, s[24:27], s93 offen sc1
  v_mfma_f32_16x16x32_bf16 v[68:71], v[168:171], a[40:43], v[68:71]
  ds_read_b64_tr_b16 v[120:121], v206 offset:57344
  s_bfe_u32 s65, s75, 0x40004
  v_mfma_f32_16x16x32_bf16 v[68:71], v[172:175], a[44:47], v[68:71]
  ds_read_b64_tr_b16 v[122:123], v206 offset:57856
  s_mul_i32 s65, s65, 393216
  v_mfma_f32_16x16x32_bf16 v[64:67], v[172:175], a[36:39], v[64:67]
  ds_read_b64_tr_b16 v[124:125], v206 offset:61440
  s_add_u32 m0, s77, 8192
  v_mfma_f32_16x16x32_bf16 v[64:67], v[168:171], a[32:35], v[64:67]
  ds_read_b64_tr_b16 v[126:127], v206 offset:61952
  buffer_load_dwordx4 v20, s[8:11], s65 offen offset:0 lds
  s_waitcnt vmcnt(6) lgkmcnt(8)
  s_barrier
  v_mfma_f32_16x16x32_bf16 v[8:11], v[96:99], a[48:51], v[8:11]
  ds_read_b64_tr_b16 v[72:73], v207 offset:0
  s_add_u32 s93, s93, 65536
  v_mfma_f32_16x16x32_bf16 v[8:11], v[100:103], a[52:55], v[8:11]
  ds_read_b64_tr_b16 v[74:75], v207 offset:512
  v_add_u32_e64 v181, s62, v227
  v_mfma_f32_16x16x32_bf16 v[28:31], v[100:103], a[60:63], v[28:31]
  ds_read_b64_tr_b16 v[76:77], v207 offset:4096
  s_and_b32 s61, s61, 128
  v_mfma_f32_16x16x32_bf16 v[28:31], v[96:99], a[56:59], v[28:31]
  ds_read_b64_tr_b16 v[78:79], v207 offset:4608
  buffer_store_dwordx4 v[136:139], v215, s[24:27], s93 offen sc1
  v_mfma_f32_16x16x32_bf16 v[52:55], v[104:107], a[56:59], v[52:55]
  ds_read_b64_tr_b16 v[80:81], v208 offset:0
  s_add_u32 s62, s61, 162560
  v_mfma_f32_16x16x32_bf16 v[52:55], v[108:111], a[60:63], v[52:55]
  ds_read_b64_tr_b16 v[82:83], v208 offset:512
  v_add_u32_e64 v166, s62, v227
  v_mfma_f32_16x16x32_bf16 v[32:35], v[108:111], a[52:55], v[32:35]
  ds_read_b64_tr_b16 v[84:85], v208 offset:4096
  s_sub_u32 s62, 162688, s61
  v_mfma_f32_16x16x32_bf16 v[32:35], v[104:107], a[48:51], v[32:35]
  ds_read_b64_tr_b16 v[86:87], v208 offset:4608
  buffer_load_dwordx4 v21, s[8:11], s65 offen offset:1024 lds
  s_waitcnt lgkmcnt(8)
  v_mfma_f32_16x16x32_bf16 v[56:59], v[112:115], a[48:51], v[56:59]
  ds_read_b64_tr_b16 v[88:89], v209 offset:0
  s_add_u32 s93, s93, s55
  v_mfma_f32_16x16x32_bf16 v[56:59], v[116:119], a[52:55], v[56:59]
  ds_read_b64_tr_b16 v[90:91], v209 offset:512
  v_add_u32_e64 v167, s62, v227
  v_mfma_f32_16x16x32_bf16 v[60:63], v[116:119], a[60:63], v[60:63]
  ds_read_b64_tr_b16 v[92:93], v209 offset:4096
  s_mul_i32 s61, s61, L_z2-L_z1+25
  v_mfma_f32_16x16x32_bf16 v[60:63], v[112:115], a[56:59], v[60:63]
  ds_read_b64_tr_b16 v[94:95], v209 offset:4608
  buffer_store_dwordx4 v[140:143], v215, s[24:27], s93 offen sc1
  v_mfma_f32_16x16x32_bf16 v[68:71], v[120:123], a[56:59], v[68:71]
  ds_read_b64_tr_b16 v[168:169], v210 offset:0
  s_bfe_u32 s65, s75, 0x40008
  v_mfma_f32_16x16x32_bf16 v[68:71], v[124:127], a[60:63], v[68:71]
  ds_read_b64_tr_b16 v[170:171], v210 offset:512
  s_mul_i32 s65, s65, 393216
  v_mfma_f32_16x16x32_bf16 v[64:67], v[124:127], a[52:55], v[64:67]
  ds_read_b64_tr_b16 v[172:173], v210 offset:4096
  s_add_u32 m0, s77, s51
  v_mfma_f32_16x16x32_bf16 v[64:67], v[120:123], a[48:51], v[64:67]
  ds_read_b64_tr_b16 v[174:175], v210 offset:4608
  buffer_load_dwordx4 v20, s[8:11], s65 offen offset:0 lds
  s_waitcnt lgkmcnt(8)
  v_mfma_f32_16x16x32_bf16 v[8:11], v[72:75], a[64:67], v[8:11]
  ds_read_b64_tr_b16 v[96:97], v207 offset:8192
  s_add_u32 s62, s61, 149760
  v_mfma_f32_16x16x32_bf16 v[8:11], v[76:79], a[68:71], v[8:11]
  ds_read_b64_tr_b16 v[98:99], v207 offset:8704
  v_add_u32_e64 v164, s62, v13
  v_mfma_f32_16x16x32_bf16 v[28:31], v[76:79], a[76:79], v[28:31]
  ds_read_b64_tr_b16 v[100:101], v207 offset:12288
  s_sub_u32 s62, 152960, s61
  v_mfma_f32_16x16x32_bf16 v[28:31], v[72:75], a[72:75], v[28:31]
  ds_read_b64_tr_b16 v[102:103], v207 offset:12800
  buffer_load_dwordx4 v21, s[8:11], s65 offen offset:1024 lds
  v_mfma_f32_16x16x32_bf16 v[52:55], v[80:83], a[72:75], v[52:55]
  ds_read_b64_tr_b16 v[104:105], v208 offset:8192
  s_bfe_u32 s65, s75, 0x4000c
  v_mfma_f32_16x16x32_bf16 v[52:55], v[84:87], a[76:79], v[52:55]
  ds_read_b64_tr_b16 v[106:107], v208 offset:8704
  s_mul_i32 s65, s65, 393216
  v_mfma_f32_16x16x32_bf16 v[32:35], v[84:87], a[68:71], v[32:35]
  ds_read_b64_tr_b16 v[108:109], v208 offset:12288
  s_add_u32 m0, s77, 24576
  v_mfma_f32_16x16x32_bf16 v[32:35], v[80:83], a[64:67], v[32:35]
  ds_read_b64_tr_b16 v[110:111], v208 offset:12800
  buffer_load_dwordx4 v20, s[8:11], s65 offen offset:0 lds
  s_waitcnt lgkmcnt(8)
  v_mfma_f32_16x16x32_bf16 v[56:59], v[88:91], a[64:67], v[56:59]
  ds_read_b64_tr_b16 v[112:113], v209 offset:8192
  v_add_u32 v165, s62, v13
  v_mfma_f32_16x16x32_bf16 v[56:59], v[92:95], a[68:71], v[56:59]
  ds_read_b64_tr_b16 v[114:115], v209 offset:8704
  s_lshl_b32 s84, s72, 14
  v_mfma_f32_16x16x32_bf16 v[60:63], v[92:95], a[76:79], v[60:63]
  ds_read_b64_tr_b16 v[116:117], v209 offset:12288
  s_add_u32 s84, s84, s66
  v_mfma_f32_16x16x32_bf16 v[60:63], v[88:91], a[72:75], v[60:63]
  ds_read_b64_tr_b16 v[118:119], v209 offset:12800
  buffer_load_dwordx4 v21, s[8:11], s65 offen offset:1024 lds
  v_mfma_f32_16x16x32_bf16 v[68:71], v[168:171], a[72:75], v[68:71]
  ds_read_b64_tr_b16 v[120:121], v210 offset:8192
  s_bfe_u32 s65, s75, 0x40010
  v_mfma_f32_16x16x32_bf16 v[68:71], v[172:175], a[76:79], v[68:71]
  ds_read_b64_tr_b16 v[122:123], v210 offset:8704
  s_mul_i32 s65, s65, s56
  v_mfma_f32_16x16x32_bf16 v[64:67], v[172:175], a[68:71], v[64:67]
  ds_read_b64_tr_b16 v[124:125], v210 offset:12288
  s_add_u32 m0, s77, 98304
  v_mfma_f32_16x16x32_bf16 v[64:67], v[168:171], a[64:67], v[64:67]
  ds_read_b64_tr_b16 v[126:127], v210 offset:12800
  buffer_load_dwordx4 v20, s[8:11], s65 offen offset:0 lds
  s_waitcnt lgkmcnt(8)
  v_mfma_f32_16x16x32_bf16 v[8:11], v[96:99], a[80:83], v[8:11]
  ds_read_b64_tr_b16 v[72:73], v207 offset:16384
  v_mov_b32_e64 v3, 0
  v_mfma_f32_16x16x32_bf16 v[8:11], v[100:103], a[84:87], v[8:11]
  ds_read_b64_tr_b16 v[74:75], v207 offset:16896
  v_add_u32 v5, 137216, v13
  v_mfma_f32_16x16x32_bf16 v[28:31], v[100:103], a[92:95], v[28:31]
  ds_read_b64_tr_b16 v[76:77], v207 offset:20480
  ds_read_b128 a[0:3], v5 offset:0
  v_mfma_f32_16x16x32_bf16 v[28:31], v[96:99], a[88:91], v[28:31]
  ds_read_b64_tr_b16 v[78:79], v207 offset:20992
  buffer_load_dwordx4 v21, s[8:11], s65 offen offset:1024 lds
  v_mfma_f32_16x16x32_bf16 v[52:55], v[104:107], a[88:91], v[52:55]
  ds_read_b64_tr_b16 v[80:81], v208 offset:16384
  s_bfe_u32 s65, s75, 0x40014
  v_mfma_f32_16x16x32_bf16 v[52:55], v[108:111], a[92:95], v[52:55]
  ds_read_b64_tr_b16 v[82:83], v208 offset:16896
  s_mul_i32 s65, s65, s56
  v_mfma_f32_16x16x32_bf16 v[32:35], v[108:111], a[84:87], v[32:35]
  ds_read_b64_tr_b16 v[84:85], v208 offset:20480
  s_add_u32 m0, s77, 106496
  v_mfma_f32_16x16x32_bf16 v[32:35], v[104:107], a[80:83], v[32:35]
  ds_read_b64_tr_b16 v[86:87], v208 offset:20992
  buffer_load_dwordx4 v20, s[8:11], s65 offen offset:0 lds
  s_waitcnt lgkmcnt(9)
  v_mfma_f32_16x16x32_bf16 v[56:59], v[112:115], a[80:83], v[56:59]
  ds_read_b64_tr_b16 v[88:89], v209 offset:16384
  ds_read_b128 a[4:7], v5 offset:1024
  v_mfma_f32_16x16x32_bf16 v[56:59], v[116:119], a[84:87], v[56:59]
  ds_read_b64_tr_b16 v[90:91], v209 offset:16896
  ds_read_b128 a[8:11], v5 offset:2048
  v_mfma_f32_16x16x32_bf16 v[60:63], v[116:119], a[92:95], v[60:63]
  ds_read_b64_tr_b16 v[92:93], v209 offset:20480
  ds_read_b128 a[12:15], v5 offset:3072
  v_mfma_f32_16x16x32_bf16 v[60:63], v[112:115], a[88:91], v[60:63]
  ds_read_b64_tr_b16 v[94:95], v209 offset:20992
  buffer_load_dwordx4 v21, s[8:11], s65 offen offset:1024 lds
  v_mfma_f32_16x16x32_bf16 v[68:71], v[120:123], a[88:91], v[68:71]
  ds_read_b64_tr_b16 v[168:169], v210 offset:16384
  s_bfe_u32 s65, s75, 0x40018
  v_mfma_f32_16x16x32_bf16 v[68:71], v[124:127], a[92:95], v[68:71]
  ds_read_b64_tr_b16 v[170:171], v210 offset:16896
  s_mul_i32 s65, s65, 393216
  v_mfma_f32_16x16x32_bf16 v[64:67], v[124:127], a[84:87], v[64:67]
  ds_read_b64_tr_b16 v[172:173], v210 offset:20480
  s_add_u32 m0, s77, 114688
  v_mfma_f32_16x16x32_bf16 v[64:67], v[120:123], a[80:83], v[64:67]
  ds_read_b64_tr_b16 v[174:175], v210 offset:20992
  buffer_load_dwordx4 v20, s[8:11], s65 offen offset:0 lds
  s_waitcnt lgkmcnt(11)
  s_nop 0
  v_mfma_f32_16x16x32_bf16 v[8:11], v[72:75], a[96:99], v[8:11]
  ds_read_b64_tr_b16 v[96:97], v207 offset:24576
  buffer_load_dword v152, v47, s[24:27], s91 offen sc1
  v_mfma_f32_16x16x32_bf16 v[8:11], v[76:79], a[100:103], v[8:11]
  ds_read_b64_tr_b16 v[98:99], v207 offset:25088
  ds_read_b128 a[16:19], v5 offset:4096
  v_mfma_f32_16x16x32_bf16 v[28:31], v[76:79], a[108:111], v[28:31]
  ds_read_b64_tr_b16 v[100:101], v207 offset:28672
  ds_read_b128 v[184:187], v5 offset:5120
  v_mfma_f32_16x16x32_bf16 v[28:31], v[72:75], a[104:107], v[28:31]
  ds_read_b64_tr_b16 v[102:103], v207 offset:29184
  ds_read_b128 v[160:163], v5 offset:6144
  v_mfma_f32_16x16x32_bf16 v[52:55], v[80:83], a[104:107], v[52:55]
  ds_read_b64_tr_b16 v[104:105], v208 offset:24576
  buffer_load_dwordx4 v21, s[8:11], s65 offen offset:1024 lds
  v_mfma_f32_16x16x32_bf16 v[52:55], v[84:87], a[108:111], v[52:55]
  ds_read_b64_tr_b16 v[106:107], v208 offset:25088
  s_bfe_u32 s65, s75, 0x4001c
  v_mfma_f32_16x16x32_bf16 v[32:35], v[84:87], a[100:103], v[32:35]
  ds_read_b64_tr_b16 v[108:109], v208 offset:28672
  s_mul_i32 s65, s65, s56
  v_mfma_f32_16x16x32_bf16 v[32:35], v[80:83], a[96:99], v[32:35]
  ds_read_b64_tr_b16 v[110:111], v208 offset:29184
  s_add_u32 m0, s77, 122880
  s_waitcnt lgkmcnt(11)
  v_mfma_f32_16x16x32_bf16 v[56:59], v[88:91], a[96:99], v[56:59]
  ds_read_b64_tr_b16 v[112:113], v209 offset:24576
  buffer_load_dwordx4 v20, s[8:11], s65 offen offset:0 lds
  v_mfma_f32_16x16x32_bf16 v[56:59], v[92:95], a[100:103], v[56:59]
  ds_read_b64_tr_b16 v[114:115], v209 offset:25088
  v_mov_b32_e64 v153, 0
  v_mfma_f32_16x16x32_bf16 v[60:63], v[92:95], a[108:111], v[60:63]
  ds_read_b64_tr_b16 v[116:117], v209 offset:28672
  v_mov_b32 v154, 0
  v_mfma_f32_16x16x32_bf16 v[60:63], v[88:91], a[104:107], v[60:63]
  ds_read_b64_tr_b16 v[118:119], v209 offset:29184
  v_mov_b32 v155, 0
  v_mfma_f32_16x16x32_bf16 v[68:71], v[168:171], a[104:107], v[68:71]
  ds_read_b64_tr_b16 v[120:121], v210 offset:24576
  buffer_load_dwordx4 v21, s[8:11], s65 offen offset:1024 lds
  v_mfma_f32_16x16x32_bf16 v[68:71], v[172:175], a[108:111], v[68:71]
  ds_read_b64_tr_b16 v[122:123], v210 offset:25088
  v_lshl_or_b32 v46, v46, 16, v46
  v_mfma_f32_16x16x32_bf16 v[64:67], v[172:175], a[100:103], v[64:67]
  ds_read_b64_tr_b16 v[124:125], v210 offset:28672
  s_waitcnt lgkmcnt(13)
  v_and_b32 v184, v184, v46
  v_mfma_f32_16x16x32_bf16 v[64:67], v[168:171], a[96:99], v[64:67]
  ds_read_b64_tr_b16 v[126:127], v210 offset:29184
  v_and_b32_e64 v185, v185, v46
  s_waitcnt vmcnt(9) lgkmcnt(8)
  s_barrier
  v_mfma_f32_16x16x32_bf16 v[8:11], v[96:99], a[112:115], v[8:11]
  ds_read_b64_tr_b16 v[72:73], v203 offset:0
  v_and_b32_e64 v186, v186, v46
  v_mfma_f32_16x16x32_bf16 v[8:11], v[100:103], a[116:119], v[8:11]
  ds_read_b64_tr_b16 v[74:75], v203 offset:512
  v_and_b32_e64 v187, v187, v46
  v_mfma_f32_16x16x32_bf16 v[28:31], v[100:103], a[124:127], v[28:31]
  ds_read_b64_tr_b16 v[76:77], v203 offset:4096
  ds_read2_b32 a[64:65], v220 offset0:128 offset1:129
  v_mfma_f32_16x16x32_bf16 v[28:31], v[96:99], a[120:123], v[28:31]
  ds_read_b64_tr_b16 v[78:79], v203 offset:4608
  ds_read2_b32 a[66:67], v220 offset0:130 offset1:131
  v_mfma_f32_16x16x32_bf16 v[52:55], v[104:107], a[120:123], v[52:55]
  ds_read_b64_tr_b16 v[80:81], v204 offset:0
  ds_read2_b32 a[68:69], v220 offset0:112 offset1:113
  v_mfma_f32_16x16x32_bf16 v[52:55], v[108:111], a[124:127], v[52:55]
  ds_read_b64_tr_b16 v[82:83], v204 offset:512
  ds_read2_b32 a[70:71], v220 offset0:114 offset1:115
  v_mfma_f32_16x16x32_bf16 v[32:35], v[108:111], a[116:119], v[32:35]
  ds_read_b64_tr_b16 v[84:85], v204 offset:4096
  ds_read2_b32 a[72:73], v220 offset0:96 offset1:97
  v_mfma_f32_16x16x32_bf16 v[32:35], v[104:107], a[112:115], v[32:35]
  ds_read_b64_tr_b16 v[86:87], v204 offset:4608
  ds_read2_b32 a[74:75], v220 offset0:98 offset1:99
  s_waitcnt lgkmcnt(14)
  v_mfma_f32_16x16x32_bf16 v[56:59], v[112:115], a[112:115], v[56:59]
  ds_read_b64_tr_b16 v[88:89], v205 offset:0
  ds_read2_b32 a[76:77], v220 offset0:80 offset1:81
  s_nop 0
  v_mfma_f32_16x16x32_bf16 v[56:59], v[116:119], a[116:119], v[56:59]
  ds_read_b64_tr_b16 v[90:91], v205 offset:512
  ds_read2_b32 a[78:79], v220 offset0:82 offset1:83
  v_mfma_f32_16x16x32_bf16 v[60:63], v[116:119], a[124:127], v[60:63]
  ds_read_b64_tr_b16 v[92:93], v205 offset:4096
  ds_read2_b32 a[80:81], v220 offset0:64 offset1:65
  v_mfma_f32_16x16x32_bf16 v[60:63], v[112:115], a[120:123], v[60:63]
  ds_read_b64_tr_b16 v[94:95], v205 offset:4608
  ds_read2_b32 a[82:83], v220 offset0:66 offset1:67
  v_mfma_f32_16x16x32_bf16 v[68:71], v[120:123], a[120:123], v[68:71]
  ds_read_b64_tr_b16 v[168:169], v206 offset:0
  ds_read2_b32 a[84:85], v220 offset0:48 offset1:49
  v_mfma_f32_16x16x32_bf16 v[68:71], v[124:127], a[124:127], v[68:71]
  ds_read_b64_tr_b16 v[170:171], v206 offset:512
  ds_read2_b32 a[86:87], v220 offset0:50 offset1:51
  v_mfma_f32_16x16x32_bf16 v[64:67], v[124:127], a[116:119], v[64:67]
  ds_read_b64_tr_b16 v[172:173], v206 offset:4096
  ds_read2_b32 a[88:89], v220 offset0:32 offset1:33
  v_mfma_f32_16x16x32_bf16 v[64:67], v[120:123], a[112:115], v[64:67]
  ds_read_b64_tr_b16 v[174:175], v206 offset:4608
  ds_read2_b32 a[90:91], v220 offset0:34 offset1:35
  s_waitcnt lgkmcnt(15)
  s_barrier
  v_mfma_f32_16x16x32_bf16 v[8:11], v[72:75], a[128:131], v[8:11]
  ds_read_b64_tr_b16 v[96:97], v203 offset:8192
  s_waitcnt vmcnt(3)
  v_cmp_eq_u32_e64 vcc, -1, v152
  v_mfma_f32_16x16x32_bf16 v[8:11], v[76:79], a[132:135], v[8:11]
  ds_read_b64_tr_b16 v[98:99], v203 offset:8704
  s_cbranch_vccnz L_h1_retry
L_h1_ok:
  v_mfma_f32_16x16x32_bf16 v[28:31], v[76:79], a[140:143], v[28:31]
  ds_read_b64_tr_b16 v[100:101], v203 offset:12288
  buffer_load_dwordx2 v[144:145], v200, s[24:27], s92 offen offset:0 sc1
  v_mfma_f32_16x16x32_bf16 v[28:31], v[72:75], a[136:139], v[28:31]
  ds_read_b64_tr_b16 v[102:103], v203 offset:12800
  buffer_load_dwordx2 v[146:147], v200, s[24:27], s92 offen offset:512 sc1
  v_mfma_f32_16x16x32_bf16 v[52:55], v[80:83], a[136:139], v[52:55]
  ds_read_b64_tr_b16 v[104:105], v204 offset:8192
  buffer_load_dwordx2 v[148:149], v200, s[24:27], s92 offen offset:1024 sc1
  v_mfma_f32_16x16x32_bf16 v[52:55], v[84:87], a[140:143], v[52:55]
  ds_read_b64_tr_b16 v[106:107], v204 offset:8704
  buffer_load_dwordx2 v[150:151], v200, s[24:27], s92 offen offset:1536 sc1
  v_mfma_f32_16x16x32_bf16 v[32:35], v[84:87], a[132:135], v[32:35]
  ds_read_b64_tr_b16 v[108:109], v204 offset:12288
  ds_read2_b32 a[92:93], v220 offset0:16 offset1:17
  v_mfma_f32_16x16x32_bf16 v[32:35], v[80:83], a[128:131], v[32:35]
  ds_read_b64_tr_b16 v[110:111], v204 offset:12800
  ds_read2_b32 a[94:95], v220 offset0:18 offset1:19
  s_waitcnt lgkmcnt(11)
  v_mfma_f32_16x16x32_bf16 v[56:59], v[88:91], a[128:131], v[56:59]
  ds_read_b64_tr_b16 v[112:113], v205 offset:8192
  s_add_u32 s65, s83, 4
  v_mfma_f32_16x16x32_bf16 v[56:59], v[92:95], a[132:135], v[56:59]
  ds_read_b64_tr_b16 v[114:115], v205 offset:8704
  s_and_b32 s65, s65, L_z2-L_z1+15
  v_mfma_f32_16x16x32_bf16 v[60:63], v[92:95], a[140:143], v[60:63]
  ds_read_b64_tr_b16 v[116:117], v205 offset:12288
  s_lshl_b32 s65, s65, L_z2-L_z1+17
  v_mfma_f32_16x16x32_bf16 v[60:63], v[88:91], a[136:139], v[60:63]
  ds_read_b64_tr_b16 v[118:119], v205 offset:12800
  s_add_u32 m0, s82, 32768
  v_mfma_f32_16x16x32_bf16 v[68:71], v[168:171], a[136:139], v[68:71]
  ds_read_b64_tr_b16 v[120:121], v206 offset:8192
  buffer_load_dwordx4 v229, s[12:15], s65 offen offset:0 lds
  v_mfma_f32_16x16x32_bf16 v[68:71], v[172:175], a[140:143], v[68:71]
  ds_read_b64_tr_b16 v[122:123], v206 offset:8704
  v_mfma_f32_16x16x32_bf16 v[156:159], v[160:163], v[152:155], 0
  v_mfma_f32_16x16x32_bf16 v[64:67], v[172:175], a[132:135], v[64:67]
  ds_read_b64_tr_b16 v[124:125], v206 offset:12288
  s_cmp_eq_u32 s59, L_z2-L_z1+3
  s_cselect_b32 s62, 0, 268435456
  v_mfma_f32_16x16x32_bf16 v[64:67], v[168:171], a[128:131], v[64:67]
  ds_read_b64_tr_b16 v[126:127], v206 offset:12800
  v_lshlrev_b32 v47, 2, v15
  s_waitcnt lgkmcnt(9)
  v_mfma_f32_16x16x32_bf16 v[8:11], v[96:99], a[144:147], v[8:11]
  ds_read_b64_tr_b16 v[72:73], v203 offset:16384
  buffer_load_dwordx4 v230, s[12:15], s65 offen offset:1024 lds
  v_mfma_f32_16x16x32_bf16 v[8:11], v[100:103], a[148:151], v[8:11]
  ds_read_b64_tr_b16 v[74:75], v203 offset:16896
  v_and_or_b32 v47, v47, 28, s62
  v_mfma_f32_16x16x32_bf16 v[28:31], v[100:103], a[156:159], v[28:31]
  ds_read_b64_tr_b16 v[76:77], v203 offset:20480
  s_lshl2_add_u32 s61, s72, s59
  s_nop 0
  v_mfma_f32_16x16x32_bf16 v[28:31], v[96:99], a[152:155], v[28:31]
  ds_read_b64_tr_b16 v[78:79], v203 offset:20992
  v_add_f32_dpp v156, v156, v156 row_ror:4 row_mask:0xf bank_mask:0xf
  v_mfma_f32_16x16x32_bf16 v[52:55], v[104:107], a[152:155], v[52:55]
  ds_read_b64_tr_b16 v[80:81], v204 offset:16384
  buffer_load_dwordx4 v231, s[12:15], s65 offen offset:2048 lds
  v_mfma_f32_16x16x32_bf16 v[52:55], v[108:111], a[156:159], v[52:55]
  ds_read_b64_tr_b16 v[82:83], v204 offset:16896
  v_add_f32_dpp v157, v157, v157 row_ror:4 row_mask:0xf bank_mask:0xf
  v_mfma_f32_16x16x32_bf16 v[32:35], v[108:111], a[148:151], v[32:35]
  ds_read_b64_tr_b16 v[84:85], v204 offset:20480
  v_add_f32_dpp v156, v156, v156 row_ror:8 row_mask:0xf bank_mask:0xf
  v_mfma_f32_16x16x32_bf16 v[32:35], v[104:107], a[144:147], v[32:35]
  ds_read_b64_tr_b16 v[86:87], v204 offset:20992
  v_add_f32_dpp v157, v157, v157 row_ror:8 row_mask:0xf bank_mask:0xf
  s_waitcnt lgkmcnt(8)
  s_nop 0
  v_mfma_f32_16x16x32_bf16 v[56:59], v[112:115], a[144:147], v[56:59]
  ds_read_b64_tr_b16 v[88:89], v205 offset:16384
  buffer_load_dwordx4 v232, s[12:15], s65 offen offset:3072 lds
  v_mfma_f32_16x16x32_bf16 v[56:59], v[116:119], a[148:151], v[56:59]
  ds_read_b64_tr_b16 v[90:91], v205 offset:16896
  s_add_u32 s65, s65, 65536
  v_mfma_f32_16x16x32_bf16 v[60:63], v[116:119], a[156:159], v[60:63]
  ds_read_b64_tr_b16 v[92:93], v205 offset:20480
  s_add_u32 m0, m0, 4096
  v_mfma_f32_16x16x32_bf16 v[60:63], v[112:115], a[152:155], v[60:63]
  ds_read_b64_tr_b16 v[94:95], v205 offset:20992
  s_lshl_b32 s61, s61, L_z2-L_z1+7
  v_mfma_f32_16x16x32_bf16 v[68:71], v[120:123], a[152:155], v[68:71]
  ds_read_b64_tr_b16 v[168:169], v206 offset:16384
  buffer_load_dwordx4 v229, s[12:15], s65 offen offset:0 lds
  v_mfma_f32_16x16x32_bf16 v[68:71], v[124:127], a[156:159], v[68:71]
  ds_read_b64_tr_b16 v[170:171], v206 offset:16896
  s_add_u32 s92, s61, 11010048
  v_mfma_f32_16x16x32_bf16 v[64:67], v[124:127], a[148:151], v[64:67]
  ds_read_b64_tr_b16 v[172:173], v206 offset:20480
  v_and_b32 v200, 127, v200
  v_mfma_f32_16x16x32_bf16 v[64:67], v[120:123], a[144:147], v[64:67]
  ds_read_b64_tr_b16 v[174:175], v206 offset:20992
  v_cvt_pk_bf16_f32 v27, v156, v157
  s_waitcnt lgkmcnt(8)
  s_mov_b32 vcc_lo, 0x0f0f0f0f
  s_mov_b32 vcc_hi, 0x0f0f0f0f
  v_mov_b32 v157, 0x3f803f80
  v_cndmask_b32 v27, v157, v27, vcc
  s_waitcnt vmcnt(5)
  v_mfma_f32_16x16x32_bf16 v[156:159], v[160:163], v[144:147], 0
  v_mfma_f32_16x16x32_bf16 v[156:159], v[160:163], v[148:151], v[156:159]
  s_barrier
  buffer_store_dword v27, v47, s[24:27], s78 offen sc1
  v_mfma_f32_16x16x32_bf16 v[8:11], v[72:75], a[160:163], v[8:11]
  ds_read_b64_tr_b16 v[96:97], v203 offset:24576
  buffer_load_dwordx4 v230, s[12:15], s65 offen offset:1024 lds
  v_mfma_f32_16x16x32_bf16 v[8:11], v[76:79], a[164:167], v[8:11]
  ds_read_b64_tr_b16 v[98:99], v203 offset:25088
  v_mfma_f32_16x16x32_bf16 v[28:31], v[76:79], a[172:175], v[28:31]
  ds_read_b64_tr_b16 v[100:101], v203 offset:28672
  v_mfma_f32_16x16x32_bf16 v[28:31], v[72:75], a[168:171], v[28:31]
  ds_read_b64_tr_b16 v[102:103], v203 offset:29184
  v_cvt_pk_bf16_f32 v44, v156, v157
  v_mfma_f32_16x16x32_bf16 v[52:55], v[80:83], a[168:171], v[52:55]
  ds_read_b64_tr_b16 v[104:105], v204 offset:24576
  v_cvt_pk_bf16_f32 v45, v158, v159
  v_mfma_f32_16x16x32_bf16 v[52:55], v[84:87], a[172:175], v[52:55]
  ds_read_b64_tr_b16 v[106:107], v204 offset:25088
  buffer_store_dwordx2 v[44:45], v200, s[24:27], s92 offen sc1
  v_mfma_f32_16x16x32_bf16 v[32:35], v[84:87], a[164:167], v[32:35]
  ds_read_b64_tr_b16 v[108:109], v204 offset:28672
  ds_read2_b32 a[96:97], v220 offset0:0 offset1:1
  v_mfma_f32_16x16x32_bf16 v[32:35], v[80:83], a[160:163], v[32:35]
  ds_read_b64_tr_b16 v[110:111], v204 offset:29184
  ds_read2_b32 a[98:99], v220 offset0:2 offset1:3
  s_waitcnt lgkmcnt(10)
  v_mfma_f32_16x16x32_bf16 v[56:59], v[88:91], a[160:163], v[56:59]
  s_nop 0
  ds_read_b64_tr_b16 v[112:113], v205 offset:24576
  buffer_load_dwordx4 v231, s[12:15], s65 offen offset:2048 lds
  v_mfma_f32_16x16x32_bf16 v[56:59], v[92:95], a[164:167], v[56:59]
  ds_read_b64_tr_b16 v[114:115], v205 offset:25088
  ds_read2_b32 a[100:101], v219 offset0:112 offset1:113
  v_mfma_f32_16x16x32_bf16 v[60:63], v[92:95], a[172:175], v[60:63]
  ds_read_b64_tr_b16 v[116:117], v205 offset:28672
  ds_read2_b32 a[102:103], v219 offset0:114 offset1:115
  v_mfma_f32_16x16x32_bf16 v[60:63], v[88:91], a[168:171], v[60:63]
  ds_read_b64_tr_b16 v[118:119], v205 offset:29184
  ds_read2_b32 a[104:105], v219 offset0:96 offset1:97
  v_mfma_f32_16x16x32_bf16 v[68:71], v[168:171], a[168:171], v[68:71]
  ds_read_b64_tr_b16 v[120:121], v206 offset:24576
  buffer_load_dwordx4 v232, s[12:15], s65 offen offset:3072 lds
  v_mfma_f32_16x16x32_bf16 v[68:71], v[172:175], a[172:175], v[68:71]
  ds_read_b64_tr_b16 v[122:123], v206 offset:25088
  s_add_u32 s65, s83, 8
  v_mfma_f32_16x16x32_bf16 v[64:67], v[172:175], a[164:167], v[64:67]
  ds_read_b64_tr_b16 v[124:125], v206 offset:28672
  s_and_b32 s65, s65, 15
  v_mfma_f32_16x16x32_bf16 v[64:67], v[168:171], a[160:163], v[64:67]
  ds_read_b64_tr_b16 v[126:127], v206 offset:29184
  s_lshl_b32 s65, s65, L_z2-L_z1+17
  s_waitcnt lgkmcnt(12)
  s_barrier
  v_mfma_f32_16x16x32_bf16 v[8:11], v[96:99], a[176:179], v[8:11]
  ds_read_b64_tr_b16 v[72:73], v207 offset:32768
  s_add_u32 m0, s82, 65536
  v_mfma_f32_16x16x32_bf16 v[8:11], v[100:103], a[180:183], v[8:11]
  ds_read_b64_tr_b16 v[74:75], v207 offset:33280
  buffer_load_dwordx4 v229, s[12:15], s65 offen offset:0 lds
  v_mfma_f32_16x16x32_bf16 v[28:31], v[100:103], a[188:191], v[28:31]
  ds_read_b64_tr_b16 v[76:77], v207 offset:36864
  ds_read2_b32 a[106:107], v219 offset0:98 offset1:99
  v_mfma_f32_16x16x32_bf16 v[28:31], v[96:99], a[184:187], v[28:31]
  ds_read_b64_tr_b16 v[78:79], v207 offset:37376
  ds_read2_b32 a[108:109], v219 offset0:80 offset1:81
  v_mfma_f32_16x16x32_bf16 v[52:55], v[104:107], a[184:187], v[52:55]
  ds_read_b64_tr_b16 v[80:81], v208 offset:32768
  ds_read2_b32 a[110:111], v219 offset0:82 offset1:83
  v_mfma_f32_16x16x32_bf16 v[52:55], v[108:111], a[188:191], v[52:55]
  ds_read_b64_tr_b16 v[82:83], v208 offset:33280
  buffer_load_dwordx4 v230, s[12:15], s65 offen offset:1024 lds
  v_mfma_f32_16x16x32_bf16 v[32:35], v[108:111], a[180:183], v[32:35]
  ds_read_b64_tr_b16 v[84:85], v208 offset:36864
  ds_read2_b32 a[112:113], v219 offset0:64 offset1:65
  v_mfma_f32_16x16x32_bf16 v[32:35], v[104:107], a[176:179], v[32:35]
  ds_read_b64_tr_b16 v[86:87], v208 offset:37376
  ds_read2_b32 a[114:115], v219 offset0:66 offset1:67
  s_waitcnt lgkmcnt(13)
  s_nop 0
  v_mfma_f32_16x16x32_bf16 v[56:59], v[112:115], a[176:179], v[56:59]
  ds_read_b64_tr_b16 v[88:89], v209 offset:32768
  ds_read2_b32 a[116:117], v219 offset0:48 offset1:49
  v_mfma_f32_16x16x32_bf16 v[56:59], v[116:119], a[180:183], v[56:59]
  ds_read_b64_tr_b16 v[90:91], v209 offset:33280
  buffer_load_dwordx4 v231, s[12:15], s65 offen offset:2048 lds
  v_mfma_f32_16x16x32_bf16 v[60:63], v[116:119], a[188:191], v[60:63]
  ds_read_b64_tr_b16 v[92:93], v209 offset:36864
  ds_read2_b32 a[118:119], v219 offset0:50 offset1:51
  v_mfma_f32_16x16x32_bf16 v[60:63], v[112:115], a[184:187], v[60:63]
  ds_read_b64_tr_b16 v[94:95], v209 offset:37376
  ds_read2_b32 a[120:121], v219 offset0:32 offset1:33
  v_mfma_f32_16x16x32_bf16 v[68:71], v[120:123], a[184:187], v[68:71]
  ds_read_b64_tr_b16 v[168:169], v210 offset:32768
  ds_read2_b32 a[122:123], v219 offset0:34 offset1:35
  v_mfma_f32_16x16x32_bf16 v[68:71], v[124:127], a[188:191], v[68:71]
  ds_read_b64_tr_b16 v[170:171], v210 offset:33280
  buffer_load_dwordx4 v232, s[12:15], s65 offen offset:3072 lds
  v_mfma_f32_16x16x32_bf16 v[64:67], v[124:127], a[180:183], v[64:67]
  ds_read_b64_tr_b16 v[172:173], v210 offset:36864
  s_add_u32 s65, s65, s55
  v_mfma_f32_16x16x32_bf16 v[64:67], v[120:123], a[176:179], v[64:67]
  ds_read_b64_tr_b16 v[174:175], v210 offset:37376
  s_add_u32 m0, m0, s52
  s_waitcnt lgkmcnt(13)
  s_barrier
  v_mfma_f32_16x16x32_bf16 v[8:11], v[72:75], a[192:195], v[8:11]
  ds_read_b64_tr_b16 v[96:97], v207 offset:40960
  ds_read2_b32 a[124:125], v219 offset0:16 offset1:17
  v_mfma_f32_16x16x32_bf16 v[8:11], v[76:79], a[196:199], v[8:11]
  ds_read_b64_tr_b16 v[98:99], v207 offset:41472
  buffer_load_dwordx4 v229, s[12:15], s65 offen offset:0 lds
  v_mfma_f32_16x16x32_bf16 v[28:31], v[76:79], a[204:207], v[28:31]
  ds_read_b64_tr_b16 v[100:101], v207 offset:45056
  ds_read2_b32 a[126:127], v219 offset0:18 offset1:19
  v_mfma_f32_16x16x32_bf16 v[28:31], v[72:75], a[200:203], v[28:31]
  ds_read_b64_tr_b16 v[102:103], v207 offset:45568
  ds_read2_b32 a[128:129], v219 offset0:0 offset1:1
  v_mfma_f32_16x16x32_bf16 v[52:55], v[80:83], a[200:203], v[52:55]
  ds_read_b64_tr_b16 v[104:105], v208 offset:40960
  ds_read2_b32 a[130:131], v219 offset0:2 offset1:3
  v_mfma_f32_16x16x32_bf16 v[52:55], v[84:87], a[204:207], v[52:55]
  ds_read_b64_tr_b16 v[106:107], v208 offset:41472
  buffer_load_dwordx4 v230, s[12:15], s65 offen offset:1024 lds
  v_mfma_f32_16x16x32_bf16 v[32:35], v[84:87], a[196:199], v[32:35]
  ds_read_b64_tr_b16 v[108:109], v208 offset:45056
  v_mfma_f32_16x16x32_bf16 v[32:35], v[80:83], a[192:195], v[32:35]
  ds_read_b64_tr_b16 v[110:111], v208 offset:45568
  s_waitcnt lgkmcnt(12)
  v_mfma_f32_16x16x32_bf16 v[56:59], v[88:91], a[192:195], v[56:59]
  s_nop 0
  ds_read_b64_tr_b16 v[112:113], v209 offset:40960
  v_mfma_f32_16x16x32_bf16 v[56:59], v[92:95], a[196:199], v[56:59]
  ds_read_b64_tr_b16 v[114:115], v209 offset:41472
  buffer_load_dwordx4 v231, s[12:15], s65 offen offset:2048 lds
  v_mfma_f32_16x16x32_bf16 v[60:63], v[92:95], a[204:207], v[60:63]
  ds_read_b64_tr_b16 v[116:117], v209 offset:45056
  v_mfma_f32_16x16x32_bf16 v[60:63], v[88:91], a[200:203], v[60:63]
  ds_read_b64_tr_b16 v[118:119], v209 offset:45568
  v_mfma_f32_16x16x32_bf16 v[68:71], v[168:171], a[200:203], v[68:71]
  ds_read_b64_tr_b16 v[120:121], v210 offset:40960
  v_mfma_f32_16x16x32_bf16 v[68:71], v[172:175], a[204:207], v[68:71]
  ds_read_b64_tr_b16 v[122:123], v210 offset:41472
  buffer_load_dwordx4 v232, s[12:15], s65 offen offset:3072 lds
  v_mfma_f32_16x16x32_bf16 v[64:67], v[172:175], a[196:199], v[64:67]
  ds_read_b64_tr_b16 v[124:125], v210 offset:45056
  s_add_u32 s65, s83, 0
  v_mfma_f32_16x16x32_bf16 v[64:67], v[168:171], a[192:195], v[64:67]
  ds_read_b64_tr_b16 v[126:127], v210 offset:45568
  s_waitcnt lgkmcnt(8)
  v_mfma_f32_16x16x32_bf16 v[8:11], v[96:99], a[208:211], v[8:11]
  ds_read_b64_tr_b16 v[72:73], v207 offset:49152
  s_and_b32 s65, s65, 15
  v_mfma_f32_16x16x32_bf16 v[8:11], v[100:103], a[212:215], v[8:11]
  ds_read_b64_tr_b16 v[74:75], v207 offset:49664
  s_lshl_b32 s65, s65, 17
  v_mfma_f32_16x16x32_bf16 v[28:31], v[100:103], a[220:223], v[28:31]
  ds_read_b64_tr_b16 v[76:77], v207 offset:53248
  s_add_u32 m0, s82, L_z2-L_z1+0
  v_mfma_f32_16x16x32_bf16 v[28:31], v[96:99], a[216:219], v[28:31]
  ds_read_b64_tr_b16 v[78:79], v207 offset:53760
  buffer_load_dwordx4 v229, s[12:15], s65 offen offset:0 lds
  v_mfma_f32_16x16x32_bf16 v[52:55], v[104:107], a[216:219], v[52:55]
  ds_read_b64_tr_b16 v[80:81], v208 offset:49152
  v_mfma_f32_16x16x32_bf16 v[52:55], v[108:111], a[220:223], v[52:55]
  ds_read_b64_tr_b16 v[82:83], v208 offset:49664
  v_mfma_f32_16x16x32_bf16 v[32:35], v[108:111], a[212:215], v[32:35]
  ds_read_b64_tr_b16 v[84:85], v208 offset:53248
  v_mfma_f32_16x16x32_bf16 v[32:35], v[104:107], a[208:211], v[32:35]
  ds_read_b64_tr_b16 v[86:87], v208 offset:53760
  s_waitcnt lgkmcnt(8)
  v_mfma_f32_16x16x32_bf16 v[56:59], v[112:115], a[208:211], v[56:59]
  ds_read_b64_tr_b16 v[88:89], v209 offset:49152
  s_nop 0
  buffer_load_dwordx4 v230, s[12:15], s65 offen offset:1024 lds
  v_mfma_f32_16x16x32_bf16 v[56:59], v[116:119], a[212:215], v[56:59]
  ds_read_b64_tr_b16 v[90:91], v209 offset:49664
  v_mfma_f32_16x16x32_bf16 v[60:63], v[116:119], a[220:223], v[60:63]
  ds_read_b64_tr_b16 v[92:93], v209 offset:53248
  v_mfma_f32_16x16x32_bf16 v[60:63], v[112:115], a[216:219], v[60:63]
  ds_read_b64_tr_b16 v[94:95], v209 offset:53760
  v_mfma_f32_16x16x32_bf16 v[68:71], v[120:123], a[216:219], v[68:71]
  ds_read_b64_tr_b16 v[168:169], v210 offset:49152
  buffer_load_dwordx4 v231, s[12:15], s65 offen offset:2048 lds
  v_mfma_f32_16x16x32_bf16 v[68:71], v[124:127], a[220:223], v[68:71]
  ds_read_b64_tr_b16 v[170:171], v210 offset:49664
  v_mfma_f32_16x16x32_bf16 v[64:67], v[124:127], a[212:215], v[64:67]
  ds_read_b64_tr_b16 v[172:173], v210 offset:53248
  v_mfma_f32_16x16x32_bf16 v[64:67], v[120:123], a[208:211], v[64:67]
  ds_read_b64_tr_b16 v[174:175], v210 offset:53760
  s_waitcnt lgkmcnt(8)
  v_mfma_f32_16x16x32_bf16 v[8:11], v[72:75], a[224:227], v[8:11]
  ds_read_b64_tr_b16 v[96:97], v207 offset:57344
  buffer_load_dwordx4 v[128:131], v13, s[24:27], s89 offen sc1
  s_nop 0
  v_mfma_f32_16x16x32_bf16 v[8:11], v[76:79], a[228:231], v[8:11]
  ds_read_b64_tr_b16 v[98:99], v207 offset:57856
  v_mfma_f32_16x16x32_bf16 v[28:31], v[76:79], a[236:239], v[28:31]
  ds_read_b64_tr_b16 v[100:101], v207 offset:61440
  v_mfma_f32_16x16x32_bf16 v[28:31], v[72:75], a[232:235], v[28:31]
  ds_read_b64_tr_b16 v[102:103], v207 offset:61952
  v_mfma_f32_16x16x32_bf16 v[52:55], v[80:83], a[232:235], v[52:55]
  ds_read_b64_tr_b16 v[104:105], v208 offset:57344
  buffer_load_dwordx4 v[132:135], v13, s[24:27], s89 offen offset:1024 sc1
  v_mfma_f32_16x16x32_bf16 v[52:55], v[84:87], a[236:239], v[52:55]
  ds_read_b64_tr_b16 v[106:107], v208 offset:57856
  v_mfma_f32_16x16x32_bf16 v[32:35], v[84:87], a[228:231], v[32:35]
  ds_read_b64_tr_b16 v[108:109], v208 offset:61440
  v_mfma_f32_16x16x32_bf16 v[32:35], v[80:83], a[224:227], v[32:35]
  ds_read_b64_tr_b16 v[110:111], v208 offset:61952
  s_waitcnt lgkmcnt(8)
  s_nop 0
  v_mfma_f32_16x16x32_bf16 v[56:59], v[88:91], a[224:227], v[56:59]
  ds_read_b64_tr_b16 v[112:113], v209 offset:57344
  buffer_load_dwordx4 v[136:139], v226, s[24:27], s90 offen sc1
  v_mfma_f32_16x16x32_bf16 v[56:59], v[92:95], a[228:231], v[56:59]
  ds_read_b64_tr_b16 v[114:115], v209 offset:57856
  v_mfma_f32_16x16x32_bf16 v[60:63], v[92:95], a[236:239], v[60:63]
  ds_read_b64_tr_b16 v[116:117], v209 offset:61440
  v_mfma_f32_16x16x32_bf16 v[60:63], v[88:91], a[232:235], v[60:63]
  ds_read_b64_tr_b16 v[118:119], v209 offset:61952
  v_mfma_f32_16x16x32_bf16 v[68:71], v[168:171], a[232:235], v[68:71]
  ds_read_b64_tr_b16 v[120:121], v210 offset:57344
  buffer_load_dwordx4 v232, s[12:15], s65 offen offset:3072 lds
  v_mfma_f32_16x16x32_bf16 v[68:71], v[172:175], a[236:239], v[68:71]
  ds_read_b64_tr_b16 v[122:123], v210 offset:57856
  s_add_u32 s65, s65, 65536
  v_mfma_f32_16x16x32_bf16 v[64:67], v[172:175], a[228:231], v[64:67]
  ds_read_b64_tr_b16 v[124:125], v210 offset:61440
  s_add_u32 m0, m0, 4096
  v_mfma_f32_16x16x32_bf16 v[64:67], v[168:171], a[224:227], v[64:67]
  ds_read_b64_tr_b16 v[126:127], v210 offset:61952
  buffer_load_dwordx4 v229, s[12:15], s65 offen offset:0 lds
  buffer_load_dwordx4 v230, s[12:15], s65 offen offset:1024 lds
  buffer_load_dwordx4 v231, s[12:15], s65 offen offset:2048 lds
  buffer_load_dwordx4 v232, s[12:15], s65 offen offset:3072 lds
  s_waitcnt lgkmcnt(8)
  v_mfma_f32_16x16x32_bf16 v[8:11], v[96:99], a[240:243], v[8:11]
  v_mfma_f32_16x16x32_bf16 v[8:11], v[100:103], a[244:247], v[8:11]
  v_mfma_f32_16x16x32_bf16 v[28:31], v[100:103], a[252:255], v[28:31]
  v_mfma_f32_16x16x32_bf16 v[28:31], v[96:99], a[248:251], v[28:31]
  v_mfma_f32_16x16x32_bf16 v[52:55], v[104:107], a[248:251], v[52:55]
  v_mfma_f32_16x16x32_bf16 v[52:55], v[108:111], a[252:255], v[52:55]
  v_mfma_f32_16x16x32_bf16 v[32:35], v[108:111], a[244:247], v[32:35]
  v_mfma_f32_16x16x32_bf16 v[32:35], v[104:107], a[240:243], v[32:35]
  s_waitcnt lgkmcnt(6)
  v_mfma_f32_16x16x32_bf16 v[56:59], v[112:115], a[240:243], v[56:59]
  v_cvt_pk_bf16_f32 v84, v8, v9
  v_cvt_pk_bf16_f32 v85, v10, v11
  s_waitcnt lgkmcnt(4)
  v_mfma_f32_16x16x32_bf16 v[60:63], v[116:119], a[252:255], v[60:63]
  s_nop 1
  v_cvt_pk_bf16_f32 v86, v32, v33
  v_cvt_pk_bf16_f32 v87, v34, v35
  s_waitcnt lgkmcnt(2)
  v_mfma_f32_16x16x32_bf16 v[68:71], v[120:123], a[248:251], v[68:71]
  v_cvt_pk_bf16_f32 v88, v28, v29
  v_cvt_pk_bf16_f32 v89, v30, v31
  s_waitcnt lgkmcnt(0)
  v_mfma_f32_16x16x32_bf16 v[64:67], v[124:127], a[244:247], v[64:67]
  v_cvt_pk_bf16_f32 v90, v52, v53
  v_cvt_pk_bf16_f32 v91, v54, v55
  v_mfma_f32_16x16x32_bf16 v[56:59], v[116:119], a[244:247], v[56:59]
  s_lshl_b32 s88, s58, 10
  s_add_u32 s88, s88, s64
  v_mfma_f32_16x16x32_bf16 v[60:63], v[112:115], a[248:251], v[60:63]
  s_add_u32 s85, s88, 4194304
  s_add_u32 s86, s88, 4227072
  v_mfma_f32_16x16x32_bf16 v[68:71], v[124:127], a[252:255], v[68:71]
  s_add_u32 s87, s88, 4210688
  s_add_u32 s88, s88, 4243456
  v_mfma_f32_16x16x32_bf16 v[64:67], v[120:123], a[240:243], v[64:67]
  v_cvt_pk_bf16_f32 v92, v56, v57
  v_cvt_pk_bf16_f32 v93, v58, v59
  v_mfma_f32_16x16x32_bf16 v[8:11], v[16:19], v[84:87], 0
  v_cvt_pk_bf16_f32 v144, v60, v61
  v_cvt_pk_bf16_f32 v145, v62, v63
  v_mfma_f32_16x16x32_bf16 v[28:31], v[16:19], v[88:91], 0
  v_cvt_pk_bf16_f32 v146, v68, v69
  v_cvt_pk_bf16_f32 v147, v70, v71
  v_mfma_f32_16x16x32_bf16 v[32:35], v[36:39], v[84:87], 0
  v_cvt_pk_bf16_f32 v94, v64, v65
  v_cvt_pk_bf16_f32 v95, v66, v67
  v_mfma_f32_16x16x32_bf16 v[60:63], v[40:43], v[144:147], 0
  v_min3_f32 v172, v8, v9, v10
  v_max3_f32 v168, v8, v9, v10
  v_mfma_f32_16x16x32_bf16 v[56:59], v[40:43], v[92:95], 0
  v_min3_f32 v173, v28, v29, v30
  v_max3_f32 v169, v28, v29, v30
  v_mfma_f32_16x16x32_bf16 v[52:55], v[36:39], v[88:91], 0
  v_min3_f32 v172, v172, v11, v32
  v_min3_f32 v172, v172, v33, v34
  v_mfma_f32_16x16x32_bf16 v[64:67], v[48:51], v[92:95], 0
  v_min3_f32 v175, v60, v61, v62
  v_min_f32_e64 v172, v172, v35
  v_mfma_f32_16x16x32_bf16 v[68:71], v[48:51], v[144:147], 0
  v_min3_f32 v174, v56, v57, v58
  v_max3_f32 v170, v56, v57, v58
  v_min3_f32 v173, v173, v31, v52
  v_min3_f32 v173, v173, v53, v54
  v_min_f32 v173, v173, v55
  v_min3_f32 v174, v174, v59, v64
  v_min3_f32 v174, v174, v65, v66
  v_min_f32 v174, v174, v67
  v_min3_f32 v175, v175, v63, v68
  v_min3_f32 v175, v175, v69, v70
  v_min_f32 v175, v175, v71
  v_permlane16_swap_b32 v172, v173
  v_min_f32 v172, v172, v173
  v_permlane16_swap_b32 v174, v175
  v_min_f32_e64 v174, v174, v175
  v_max3_f32 v171, v60, v61, v62
  v_max3_f32 v168, v168, v11, v32
  v_permlane32_swap_b32 v172, v174
  v_min_f32 v172, v172, v174
  v_mul_f32 v172, s48, v172
  v_mov_b32 v174, v172
  v_max3_f32 v169, v169, v31, v52
  v_max3_f32 v170, v170, v59, v64
  v_permlane32_swap_b32 v172, v174
  v_mov_b32 v173, v172
  v_mov_b32_e64 v175, v174
  v_max3_f32 v171, v171, v63, v68
  v_permlane16_swap_b32 v172, v173
  s_waitcnt vmcnt(5)
  v_max3_u32 v44, v136, v137, v138
  v_max3_u32 v45, v131, v132, v133
  v_max3_u32 v44, v44, v134, v135
  v_max3_u32 v45, v45, v128, v129
  v_max3_u32 v44, v44, v130, v139
  v_max_u32 v44, v44, v45
  v_cmp_eq_u32 vcc, -1, v44
  s_nop 0
  s_cbranch_vccnz L_a2_retry
L_a2_ok:
  ds_write_b128 v180, v[128:131]
  v_pk_fma_f32 v[176:177], v[8:9], s[48:49], v[172:173] op_sel:[0,0,0] op_sel_hi:[1,1,0] neg_lo:[1,0,0] neg_hi:[1,0,0]
  v_pk_fma_f32 v[178:179], v[10:11], s[48:49], v[172:173] op_sel:[0,0,0] op_sel_hi:[1,1,0] neg_lo:[1,0,0] neg_hi:[1,0,0]
  v_pk_fma_f32 v[188:189], v[32:33], s[48:49], v[172:173] op_sel:[0,0,0] op_sel_hi:[1,1,0] neg_lo:[1,0,0] neg_hi:[1,0,0]
  v_pk_fma_f32 v[190:191], v[34:35], s[48:49], v[172:173] op_sel:[0,0,0] op_sel_hi:[1,1,0] neg_lo:[1,0,0] neg_hi:[1,0,0]
  v_pk_fma_f32 v[192:193], v[28:29], s[48:49], v[172:173] op_sel:[0,0,1] op_sel_hi:[1,1,1] neg_lo:[1,0,0] neg_hi:[1,0,0]
  v_pk_fma_f32 v[194:195], v[30:31], s[48:49], v[172:173] op_sel:[0,0,1] op_sel_hi:[1,1,1] neg_lo:[1,0,0] neg_hi:[1,0,0]
  ds_write_b128 v180, v[132:135] offset:1024
  v_pk_fma_f32 v[196:197], v[52:53], s[48:49], v[172:173] op_sel:[0,0,1] op_sel_hi:[1,1,1] neg_lo:[1,0,0] neg_hi:[1,0,0]
  v_pk_fma_f32 v[198:199], v[54:55], s[48:49], v[172:173] op_sel:[0,0,1] op_sel_hi:[1,1,1] neg_lo:[1,0,0] neg_hi:[1,0,0]
  v_permlane16_swap_b32_e64 v174, v175
  v_pk_fma_f32 v[200:201], v[56:57], s[48:49], v[174:175] op_sel:[0,0,0] op_sel_hi:[1,1,0] neg_lo:[1,0,0] neg_hi:[1,0,0]
  v_pk_fma_f32 v[202:203], v[58:59], s[48:49], v[174:175] op_sel:[0,0,0] op_sel_hi:[1,1,0] neg_lo:[1,0,0] neg_hi:[1,0,0]
  v_pk_fma_f32 v[204:205], v[64:65], s[48:49], v[174:175] op_sel:[0,0,0] op_sel_hi:[1,1,0] neg_lo:[1,0,0] neg_hi:[1,0,0]
  ds_write_b128 v181, v[136:139]
  v_pk_fma_f32 v[206:207], v[66:67], s[48:49], v[174:175] op_sel:[0,0,0] op_sel_hi:[1,1,0] neg_lo:[1,0,0] neg_hi:[1,0,0]
  v_pk_fma_f32 v[208:209], v[60:61], s[48:49], v[174:175] op_sel:[0,0,1] op_sel_hi:[1,1,1] neg_lo:[1,0,0] neg_hi:[1,0,0]
  v_pk_fma_f32 v[210:211], v[62:63], s[48:49], v[174:175] op_sel:[0,0,1] op_sel_hi:[1,1,1] neg_lo:[1,0,0] neg_hi:[1,0,0]
  v_pk_fma_f32 v[212:213], v[68:69], s[48:49], v[174:175] op_sel:[0,0,1] op_sel_hi:[1,1,1] neg_lo:[1,0,0] neg_hi:[1,0,0]
  v_pk_fma_f32 v[214:215], v[70:71], s[48:49], v[174:175] op_sel:[0,0,1] op_sel_hi:[1,1,1] neg_lo:[1,0,0] neg_hi:[1,0,0]
  v_max3_f32 v168, v168, v33, v34
  v_max3_f32 v169, v169, v53, v54
  v_max3_f32 v170, v170, v65, v66
  v_max3_f32 v171, v171, v69, v70
  v_max_f32_e64 v168, v168, v35
  s_waitcnt lgkmcnt(0)
  s_barrier
  s_add_u32 m0, s66, 133120
  ds_read_b128 a[152:155], v166 offset:0
  buffer_load_dwordx4 v228, s[24:27], s84 offen offset:0 sc1 lds
  buffer_load_dwordx4 v228, s[24:27], s84 offen offset:1024 sc1 lds
  buffer_load_dwordx4 v228, s[24:27], s84 offen offset:2048 sc1 lds
  buffer_load_dwordx4 v228, s[24:27], s84 offen offset:3072 sc1 lds
  ds_read_b128 a[164:167], v166 offset:256
  ds_read_b128 a[144:147], v164 offset:0
  ds_read_b128 a[156:159], v164 offset:6400
  ds_read_b128 a[148:151], v164 offset:1024
  ds_read_b128 a[160:163], v164 offset:7424
  ds_read_b128 a[240:243], v167 offset:0
  ds_read_b128 a[252:255], v167 offset:256
  ds_read_b128 a[232:235], v165 offset:0
  ds_read_b128 a[244:247], v165 offset:6400
  ds_read_b128 a[236:239], v165 offset:1024
  ds_read_b128 a[248:251], v165 offset:7424
  v_max_f32 v169, v169, v55
  v_max_f32 v170, v170, v67
  v_max_f32 v171, v171, v71
  v_permlane16_swap_b32 v168, v169
  v_max_f32 v168, v168, v169
  v_permlane16_swap_b32 v170, v171
  v_max_f32 v170, v170, v171
  v_exp_f32 v176, v176
  v_exp_f32 v177, v177
  v_permlane32_swap_b32 v168, v170
  v_max_f32 v168, v168, v170
  v_mul_f32 v168, s48, v168
  v_mov_b32 v170, v168
  v_exp_f32 v178, v178
  v_exp_f32 v179, v179
  v_permlane32_swap_b32 v168, v170
  v_mov_b32 v169, v168
  v_mov_b32 v171, v170
  v_exp_f32 v188, v188
  v_permlane16_swap_b32 v168, v169
  v_pk_fma_f32 v[8:9], v[8:9], s[48:49], v[168:169] op_sel:[0,0,0] op_sel_hi:[1,1,0] neg_lo:[0,0,1] neg_hi:[0,0,1]
  v_pk_fma_f32 v[10:11], v[10:11], s[48:49], v[168:169] op_sel:[0,0,0] op_sel_hi:[1,1,0] neg_lo:[0,0,1] neg_hi:[0,0,1]
  v_pk_fma_f32 v[32:33], v[32:33], s[48:49], v[168:169] op_sel:[0,0,0] op_sel_hi:[1,1,0] neg_lo:[0,0,1] neg_hi:[0,0,1]
  v_pk_fma_f32 v[34:35], v[34:35], s[48:49], v[168:169] op_sel:[0,0,0] op_sel_hi:[1,1,0] neg_lo:[0,0,1] neg_hi:[0,0,1]
  v_pk_fma_f32 v[28:29], v[28:29], s[48:49], v[168:169] op_sel:[0,0,1] op_sel_hi:[1,1,1] neg_lo:[0,0,1] neg_hi:[0,0,1]
  v_pk_fma_f32 v[30:31], v[30:31], s[48:49], v[168:169] op_sel:[0,0,1] op_sel_hi:[1,1,1] neg_lo:[0,0,1] neg_hi:[0,0,1]
  v_pk_fma_f32 v[52:53], v[52:53], s[48:49], v[168:169] op_sel:[0,0,1] op_sel_hi:[1,1,1] neg_lo:[0,0,1] neg_hi:[0,0,1]
  v_pk_fma_f32 v[54:55], v[54:55], s[48:49], v[168:169] op_sel:[0,0,1] op_sel_hi:[1,1,1] neg_lo:[0,0,1] neg_hi:[0,0,1]
  v_permlane16_swap_b32_e64 v170, v171
  v_pk_fma_f32 v[56:57], v[56:57], s[48:49], v[170:171] op_sel:[0,0,0] op_sel_hi:[1,1,0] neg_lo:[0,0,1] neg_hi:[0,0,1]
  v_pk_fma_f32 v[58:59], v[58:59], s[48:49], v[170:171] op_sel:[0,0,0] op_sel_hi:[1,1,0] neg_lo:[0,0,1] neg_hi:[0,0,1]
  v_pk_fma_f32 v[64:65], v[64:65], s[48:49], v[170:171] op_sel:[0,0,0] op_sel_hi:[1,1,0] neg_lo:[0,0,1] neg_hi:[0,0,1]
  v_pk_fma_f32 v[66:67], v[66:67], s[48:49], v[170:171] op_sel:[0,0,0] op_sel_hi:[1,1,0] neg_lo:[0,0,1] neg_hi:[0,0,1]
  v_pk_fma_f32 v[60:61], v[60:61], s[48:49], v[170:171] op_sel:[0,0,1] op_sel_hi:[1,1,1] neg_lo:[0,0,1] neg_hi:[0,0,1]
  v_pk_fma_f32 v[62:63], v[62:63], s[48:49], v[170:171] op_sel:[0,0,1] op_sel_hi:[1,1,1] neg_lo:[0,0,1] neg_hi:[0,0,1]
  v_pk_fma_f32 v[68:69], v[68:69], s[48:49], v[170:171] op_sel:[0,0,1] op_sel_hi:[1,1,1] neg_lo:[0,0,1] neg_hi:[0,0,1]
  v_pk_fma_f32 v[70:71], v[70:71], s[48:49], v[170:171] op_sel:[0,0,1] op_sel_hi:[1,1,1] neg_lo:[0,0,1] neg_hi:[0,0,1]
  v_exp_f32 v8, v8
  v_exp_f32 v9, v9
  v_exp_f32 v10, v10
  v_exp_f32 v11, v11
  v_exp_f32 v32, v32
  v_exp_f32 v33, v33
  v_exp_f32 v34, v34
  v_exp_f32 v35, v35
  v_exp_f32 v189, v189
  v_exp_f32 v190, v190
  v_exp_f32_e64 v191, v191
  v_cvt_pk_bf16_f32 v84, v8, v9
  v_cvt_pk_bf16_f32 v85, v10, v11
  v_cvt_pk_bf16_f32 v86, v32, v33
  v_cvt_pk_bf16_f32 v87, v34, v35
  v_cvt_pk_bf16_f32 v148, v176, v177
  v_cvt_pk_bf16_f32 v149, v178, v179
  s_waitcnt lgkmcnt(0)
  v_mfma_f32_16x16x32_bf16 v[96:99], a[152:155], v[84:87], 0
  v_cvt_pk_bf16_f32 v150, v188, v189
  v_cvt_pk_bf16_f32 v151, v190, v191
  v_mfma_f32_16x16x32_bf16 v[8:11], a[144:147], v[84:87], 0
  v_exp_f32 v28, v28
  v_mfma_f32_16x16x32_bf16 v[100:103], a[164:167], v[148:151], 0
  v_exp_f32 v29, v29
  v_mfma_f32_16x16x32_bf16 v[32:35], a[148:151], v[84:87], 0
  v_exp_f32 v30, v30
  v_mfma_f32_16x16x32_bf16 v[176:179], a[156:159], v[148:151], 0
  v_fmamk_f32 v96, v97, 0x358637bd, v96
  v_exp_f32 v31, v31
  v_mfma_f32_16x16x32_bf16 v[188:191], a[160:163], v[148:151], 0
  v_exp_f32 v52, v52
  v_mul_f32 v96, v96, v101
  v_fmac_f32 v96, v100, v97
  v_rcp_f32 v96, v96
  v_exp_f32 v53, v53
  v_mul_f32 v98, v101, v96
  v_mul_f32 v99, v97, v96
  v_pk_mul_f32 v[8:9], v[8:9], v[98:99] op_sel:[0,0] op_sel_hi:[1,0]
  v_pk_mul_f32 v[10:11], v[10:11], v[98:99] op_sel:[0,0] op_sel_hi:[1,0]
  v_pk_mul_f32 v[32:33], v[32:33], v[98:99] op_sel:[0,0] op_sel_hi:[1,0]
  v_pk_mul_f32 v[34:35], v[34:35], v[98:99] op_sel:[0,0] op_sel_hi:[1,0]
  v_pk_fma_f32 v[8:9], v[176:177], v[98:99], v[8:9] op_sel:[0,1,0] op_sel_hi:[1,1,1]
  v_pk_fma_f32 v[10:11], v[178:179], v[98:99], v[10:11] op_sel:[0,1,0] op_sel_hi:[1,1,1]
  v_pk_fma_f32 v[32:33], v[188:189], v[98:99], v[32:33] op_sel:[0,1,0] op_sel_hi:[1,1,1]
  v_pk_fma_f32 v[34:35], v[190:191], v[98:99], v[34:35] op_sel:[0,1,0] op_sel_hi:[1,1,1]
  v_cvt_pk_bf16_f32 v100, v8, v9
  v_cvt_pk_bf16_f32 v101, v10, v11
  v_cvt_pk_bf16_f32 v102, v32, v33
  v_cvt_pk_bf16_f32 v103, v34, v35
  buffer_store_dwordx4 v[100:103], v13, s[24:27], s85 offen sc1
  v_exp_f32 v54, v54
  v_exp_f32 v55, v55
  v_exp_f32 v192, v192
  v_exp_f32 v193, v193
  v_exp_f32 v194, v194
  v_exp_f32 v195, v195
  v_exp_f32 v196, v196
  v_exp_f32 v197, v197
  v_exp_f32 v198, v198
  v_exp_f32 v199, v199
  v_cvt_pk_bf16_f32 v88, v28, v29
  v_cvt_pk_bf16_f32 v89, v30, v31
  v_cvt_pk_bf16_f32 v90, v52, v53
  v_cvt_pk_bf16_f32 v91, v54, v55
  v_cvt_pk_bf16_f32 v152, v192, v193
  v_cvt_pk_bf16_f32 v153, v194, v195
  v_mfma_f32_16x16x32_bf16 v[104:107], a[152:155], v[88:91], 0
  v_cvt_pk_bf16_f32 v154, v196, v197
  v_cvt_pk_bf16_f32 v155, v198, v199
  v_mfma_f32_16x16x32_bf16 v[28:31], a[144:147], v[88:91], 0
  v_exp_f32 v56, v56
  v_mfma_f32_16x16x32_bf16 v[108:111], a[164:167], v[152:155], 0
  v_exp_f32 v57, v57
  v_mfma_f32_16x16x32_bf16 v[52:55], a[148:151], v[88:91], 0
  v_exp_f32 v58, v58
  v_mfma_f32_16x16x32_bf16 v[192:195], a[156:159], v[152:155], 0
  v_fmamk_f32 v104, v105, 0x358637bd, v104
  v_exp_f32 v59, v59
  v_mfma_f32_16x16x32_bf16 v[196:199], a[160:163], v[152:155], 0
  v_exp_f32 v64, v64
  v_mul_f32 v104, v104, v109
  v_fmac_f32 v104, v108, v105
  v_rcp_f32 v104, v104
  v_exp_f32 v65, v65
  v_mul_f32 v106, v109, v104
  v_mul_f32_e64 v107, v105, v104
  v_pk_mul_f32 v[28:29], v[28:29], v[106:107] op_sel:[0,0] op_sel_hi:[1,0]
  v_pk_mul_f32 v[30:31], v[30:31], v[106:107] op_sel:[0,0] op_sel_hi:[1,0]
  v_pk_mul_f32 v[52:53], v[52:53], v[106:107] op_sel:[0,0] op_sel_hi:[1,0]
  v_pk_mul_f32 v[54:55], v[54:55], v[106:107] op_sel:[0,0] op_sel_hi:[1,0]
  v_pk_fma_f32 v[28:29], v[192:193], v[106:107], v[28:29] op_sel:[0,1,0] op_sel_hi:[1,1,1]
  v_pk_fma_f32 v[30:31], v[194:195], v[106:107], v[30:31] op_sel:[0,1,0] op_sel_hi:[1,1,1]
  v_pk_fma_f32 v[52:53], v[196:197], v[106:107], v[52:53] op_sel:[0,1,0] op_sel_hi:[1,1,1]
  v_pk_fma_f32 v[54:55], v[198:199], v[106:107], v[54:55] op_sel:[0,1,0] op_sel_hi:[1,1,1]
  v_cvt_pk_bf16_f32 v108, v28, v29
  v_cvt_pk_bf16_f32 v109, v30, v31
  v_cvt_pk_bf16_f32 v110, v52, v53
  v_cvt_pk_bf16_f32 v111, v54, v55
  buffer_store_dwordx4 v[108:111], v13, s[24:27], s86 offen sc1
  v_exp_f32 v66, v66
  v_exp_f32 v67, v67
  v_exp_f32 v200, v200
  v_exp_f32 v201, v201
  v_exp_f32_e64 v202, v202
  v_exp_f32_e64 v203, v203
  v_exp_f32_e64 v204, v204
  v_exp_f32_e64 v205, v205
  v_exp_f32_e64 v206, v206
  v_exp_f32_e64 v207, v207
  v_cvt_pk_bf16_f32 v92, v56, v57
  v_cvt_pk_bf16_f32 v93, v58, v59
  v_cvt_pk_bf16_f32 v94, v64, v65
  v_cvt_pk_bf16_f32 v95, v66, v67
  v_cvt_pk_bf16_f32 v156, v200, v201
  v_cvt_pk_bf16_f32 v157, v202, v203
  v_mfma_f32_16x16x32_bf16 v[112:115], a[240:243], v[92:95], 0
  v_cvt_pk_bf16_f32 v158, v204, v205
  v_cvt_pk_bf16_f32 v159, v206, v207
  v_mfma_f32_16x16x32_bf16 v[56:59], a[232:235], v[92:95], 0
  v_exp_f32_e64 v60, v60
  v_mfma_f32_16x16x32_bf16 v[116:119], a[252:255], v[156:159], 0
  v_exp_f32 v61, v61
  v_mfma_f32_16x16x32_bf16 v[64:67], a[236:239], v[92:95], 0
  v_exp_f32 v62, v62
  v_mfma_f32_16x16x32_bf16 v[200:203], a[244:247], v[156:159], 0
  v_fmamk_f32 v112, v113, 0x358637bd, v112
  v_exp_f32 v63, v63
  v_mfma_f32_16x16x32_bf16 v[204:207], a[248:251], v[156:159], 0
  v_exp_f32 v68, v68
  v_mul_f32 v112, v112, v117
  v_fmac_f32 v112, v116, v113
  v_rcp_f32 v112, v112
  v_exp_f32 v69, v69
  v_mul_f32 v114, v117, v112
  v_mul_f32 v115, v113, v112
  v_pk_mul_f32 v[56:57], v[56:57], v[114:115] op_sel:[0,0] op_sel_hi:[1,0]
  v_pk_mul_f32 v[58:59], v[58:59], v[114:115] op_sel:[0,0] op_sel_hi:[1,0]
  v_pk_mul_f32 v[64:65], v[64:65], v[114:115] op_sel:[0,0] op_sel_hi:[1,0]
  v_pk_mul_f32 v[66:67], v[66:67], v[114:115] op_sel:[0,0] op_sel_hi:[1,0]
  v_pk_fma_f32 v[56:57], v[200:201], v[114:115], v[56:57] op_sel:[0,1,0] op_sel_hi:[1,1,1]
  v_pk_fma_f32 v[58:59], v[202:203], v[114:115], v[58:59] op_sel:[0,1,0] op_sel_hi:[1,1,1]
  v_pk_fma_f32 v[64:65], v[204:205], v[114:115], v[64:65] op_sel:[0,1,0] op_sel_hi:[1,1,1]
  v_pk_fma_f32 v[66:67], v[206:207], v[114:115], v[66:67] op_sel:[0,1,0] op_sel_hi:[1,1,1]
  v_cvt_pk_bf16_f32 v116, v56, v57
  v_cvt_pk_bf16_f32 v117, v58, v59
  v_cvt_pk_bf16_f32 v118, v64, v65
  v_cvt_pk_bf16_f32 v119, v66, v67
  buffer_store_dwordx4 v[116:119], v13, s[24:27], s87 offen sc1
  v_exp_f32 v70, v70
  v_exp_f32 v71, v71
  v_exp_f32 v208, v208
  v_exp_f32 v209, v209
  v_exp_f32 v210, v210
  v_exp_f32 v211, v211
  v_exp_f32 v212, v212
  v_exp_f32 v213, v213
  v_exp_f32 v214, v214
  v_exp_f32 v215, v215
  v_cvt_pk_bf16_f32 v144, v60, v61
  v_cvt_pk_bf16_f32 v145, v62, v63
  v_cvt_pk_bf16_f32 v146, v68, v69
  v_cvt_pk_bf16_f32 v147, v70, v71
  v_cvt_pk_bf16_f32 v160, v208, v209
  v_cvt_pk_bf16_f32 v161, v210, v211
  v_mfma_f32_16x16x32_bf16 v[120:123], a[240:243], v[144:147], 0
  v_cvt_pk_bf16_f32 v162, v212, v213
  v_cvt_pk_bf16_f32 v163, v214, v215
  v_mfma_f32_16x16x32_bf16 v[60:63], a[232:235], v[144:147], 0
  s_nop 0
  s_nop 0
  v_mfma_f32_16x16x32_bf16 v[124:127], a[252:255], v[160:163], 0
  v_mfma_f32_16x16x32_bf16 v[68:71], a[236:239], v[144:147], 0
  v_mfma_f32_16x16x32_bf16 v[208:211], a[244:247], v[160:163], 0
  v_mfma_f32_16x16x32_bf16 v[212:215], a[248:251], v[160:163], 0
  s_waitcnt vmcnt(3)
  s_barrier
  ds_read_b128 v[20:23], v222 offset:0
  ds_read_b128 v[72:75], v223 offset:256
  ds_read_b128 v[76:79], v224 offset:512
  ds_read_b128 v[80:83], v221 offset:768
  s_waitcnt vmcnt(1)
  buffer_store_dword v3, v3, s[24:27], s79 offen sc1
  v_fmamk_f32 v120, v121, 0x358637bd, v120
  v_mul_f32 v120, v120, v125
  v_fmac_f32 v120, v124, v121
  v_rcp_f32 v120, v120
  s_nop 0
  v_mul_f32 v122, v125, v120
  v_mul_f32_e64 v123, v121, v120
  v_pk_mul_f32 v[60:61], v[60:61], v[122:123] op_sel:[0,0] op_sel_hi:[1,0]
  v_pk_mul_f32 v[62:63], v[62:63], v[122:123] op_sel:[0,0] op_sel_hi:[1,0]
  v_pk_mul_f32 v[68:69], v[68:69], v[122:123] op_sel:[0,0] op_sel_hi:[1,0]
  v_pk_mul_f32 v[70:71], v[70:71], v[122:123] op_sel:[0,0] op_sel_hi:[1,0]
  v_pk_fma_f32 v[60:61], v[208:209], v[122:123], v[60:61] op_sel:[0,1,0] op_sel_hi:[1,1,1]
  v_pk_fma_f32 v[62:63], v[210:211], v[122:123], v[62:63] op_sel:[0,1,0] op_sel_hi:[1,1,1]
  v_pk_fma_f32 v[68:69], v[212:213], v[122:123], v[68:69] op_sel:[0,1,0] op_sel_hi:[1,1,1]
  v_pk_fma_f32 v[70:71], v[214:215], v[122:123], v[70:71] op_sel:[0,1,0] op_sel_hi:[1,1,1]
  v_cvt_pk_bf16_f32 v124, v60, v61
  v_cvt_pk_bf16_f32 v125, v62, v63
  v_cvt_pk_bf16_f32 v126, v68, v69
  v_cvt_pk_bf16_f32 v127, v70, v71
  buffer_store_dwordx4 v[124:127], v13, s[24:27], s88 offen sc1
  s_waitcnt lgkmcnt(3)
  v_mfma_f32_16x16x32_bf16 v[8:11], a[92:95], v[20:23], 0
  s_lshl2_add_u32 s90, s68, s59
  ds_read_b128 v[60:63], v222 offset:1024
  v_mfma_f32_16x16x32_bf16 v[16:19], a[124:127], v[20:23], 0
  s_lshl_b32 s89, s90, 11
  ds_read_b128 v[64:67], v223 offset:1280
  s_waitcnt lgkmcnt(4)
  v_mfma_f32_16x16x32_bf16 v[16:19], a[120:123], v[72:75], v[16:19]
  s_add_u32 s89, s89, 11141120
  ds_read_b128 v[68:71], v224 offset:1536
  v_mfma_f32_16x16x32_bf16 v[8:11], a[88:91], v[72:75], v[8:11]
  s_lshl_b32 s90, s90, 16
  ds_read_b128 v[84:87], v221 offset:1792
  s_waitcnt lgkmcnt(5)
  v_mfma_f32_16x16x32_bf16 v[8:11], a[84:87], v[76:79], v[8:11]
  s_add_u32 s90, s90, 4194304
  ds_read_b128 v[88:91], v225 offset:1792
  v_mfma_f32_16x16x32_bf16 v[16:19], a[116:119], v[76:79], v[16:19]
  ds_read_b128 v[92:95], v222 offset:2048
  v_lshlrev_b32 v14, 7, v15
  s_waitcnt lgkmcnt(6)
  v_mfma_f32_16x16x32_bf16 v[16:19], a[112:115], v[80:83], v[16:19]
  ds_read_b128 v[96:99], v223 offset:2304
  v_add_u32 v24, s90, v13
  v_mfma_f32_16x16x32_bf16 v[8:11], a[80:83], v[80:83], v[8:11]
  ds_read_b128 v[100:103], v224 offset:2560
  v_add_u32_e64 v25, s50, v24
  s_waitcnt lgkmcnt(7)
  v_mfma_f32_16x16x32_bf16 v[8:11], a[76:79], v[60:63], v[8:11]
  s_lshl_b32 s90, s71, 10
  ds_read_b128 v[20:23], v221 offset:2816
  v_mfma_f32_16x16x32_bf16 v[16:19], a[108:111], v[60:63], v[16:19]
  s_add_u32 s65, s83, 12
  ds_read_b128 v[72:75], v222 offset:3072
  s_waitcnt lgkmcnt(8)
  v_mfma_f32_16x16x32_bf16 v[16:19], a[104:107], v[64:67], v[16:19]
  s_and_b32 s65, s65, 15
  ds_read_b128 v[76:79], v223 offset:3328
  v_mfma_f32_16x16x32_bf16 v[8:11], a[72:75], v[64:67], v[8:11]
  s_lshl_b32 s65, s65, 17
  ds_read_b128 v[80:83], v224 offset:3584
  s_waitcnt lgkmcnt(9)
  v_mfma_f32_16x16x32_bf16 v[8:11], a[68:71], v[68:71], v[8:11]
  s_add_u32 m0, s82, 98304
  ds_read2_b32 a[24:25], v218 offset0:47 offset1:48
  v_mfma_f32_16x16x32_bf16 v[16:19], a[100:103], v[68:71], v[16:19]
  buffer_load_dwordx4 v229, s[12:15], s65 offen offset:0 lds
  ds_read2_b32 a[26:27], v218 offset0:49 offset1:50
  s_waitcnt lgkmcnt(10)
  v_mfma_f32_16x16x32_bf16 v[104:107], v[84:87], a[0:3], 0
  ds_read2_b32 a[36:37], v218 offset0:111 offset1:112
  v_mfma_f32_16x16x32_bf16 v[108:111], v[84:87], a[4:7], 0
  ds_read2_b32 a[38:39], v218 offset0:113 offset1:114
  v_mfma_f32_16x16x32_bf16 v[112:115], v[84:87], a[8:11], 0
  ds_read2_b32 a[28:29], v218 offset0:31 offset1:32
  s_waitcnt lgkmcnt(12)
  v_mfma_f32_16x16x32_bf16 v[116:119], v[88:91], a[4:7], 0
  buffer_load_dwordx4 v230, s[12:15], s65 offen offset:1024 lds
  ds_read2_b32 a[30:31], v218 offset0:33 offset1:34
  v_mfma_f32_16x16x32_bf16 v[28:31], a[128:131], v[84:87], 0
  ds_read2_b32 a[40:41], v218 offset0:95 offset1:96
  v_mfma_f32_16x16x32_bf16 v[16:19], a[96:99], v[84:87], v[16:19]
  ds_read2_b32 a[42:43], v218 offset0:97 offset1:98
  v_cvt_pk_bf16_f32 v128, v104, v108
  v_mfma_f32_16x16x32_bf16 v[8:11], a[64:67], v[84:87], v[8:11]
  ds_read2_b32 a[32:33], v218 offset0:15 offset1:16
  v_cvt_pk_bf16_f32 v129, v105, v109
  s_waitcnt lgkmcnt(13)
  s_nop 0
  v_mfma_f32_16x16x32_bf16 v[16:19], a[92:95], v[92:95], v[16:19]
  buffer_load_dwordx4 v231, s[12:15], s65 offen offset:2048 lds
  ds_read2_b32 a[34:35], v218 offset0:17 offset1:18
  v_cvt_pk_bf16_f32 v130, v106, v110
  v_mfma_f32_16x16x32_bf16 v[28:31], a[124:127], v[92:95], v[28:31]
  ds_read2_b32 a[44:45], v218 offset0:79 offset1:80
  v_cvt_pk_bf16_f32 v131, v107, v111
  v_mfma_f32_16x16x32_bf16 v[28:31], a[120:123], v[96:99], v[28:31]
  ds_read2_b32 a[46:47], v218 offset0:81 offset1:82
  v_cvt_pk_bf16_f32 v132, v112, v116
  v_mfma_f32_16x16x32_bf16 v[16:19], a[88:91], v[96:99], v[16:19]
  ds_read_b128 v[60:63], v221 offset:3840
  v_cvt_pk_bf16_f32 v133, v113, v117
  v_mfma_f32_16x16x32_bf16 v[16:19], a[84:87], v[100:103], v[16:19]
  buffer_load_dwordx4 v232, s[12:15], s65 offen offset:3072 lds
  ds_read_b128 v[64:67], v225 offset:3840
  v_cvt_pk_bf16_f32 v134, v114, v118
  v_mfma_f32_16x16x32_bf16 v[28:31], a[116:119], v[100:103], v[28:31]
  ds_read_b128 v[68:71], v222 offset:4096
  v_cvt_pk_bf16_f32 v135, v115, v119
  s_waitcnt lgkmcnt(13)
  v_mfma_f32_16x16x32_bf16 v[28:31], a[112:115], v[20:23], v[28:31]
  s_add_u32 s65, s65, s55
  ds_read_b128 v[84:87], v223 offset:4352
  v_cvt_pk_bf16_f32 v8, v8, v9
  v_mfma_f32_16x16x32_bf16 v[16:19], a[80:83], v[20:23], v[16:19]
  ds_read_b128 v[88:91], v224 offset:4608
  v_cvt_pk_bf16_f32 v9, v10, v11
  v_mfma_f32_16x16x32_bf16 v[16:19], a[76:79], v[72:75], v[16:19]
  s_add_u32 m0, m0, 4096
  ds_read_b128 v[92:95], v221 offset:4864
  v_mfma_f32_16x16x32_bf16 v[28:31], a[108:111], v[72:75], v[28:31]
  buffer_load_dwordx4 v229, s[12:15], s65 offen offset:0 lds
  ds_read_b128 v[96:99], v222 offset:5120
  v_mfma_f32_16x16x32_bf16 v[28:31], a[104:107], v[76:79], v[28:31]
  ds_read_b128 v[100:103], v223 offset:5376
  v_mfma_f32_16x16x32_bf16 v[16:19], a[72:75], v[76:79], v[16:19]
  ds_read_b128 v[20:23], v224 offset:5632
  v_mfma_f32_16x16x32_bf16 v[16:19], a[68:71], v[80:83], v[16:19]
  ds_read_b128 v[72:75], v221 offset:5888
  v_mfma_f32_16x16x32_bf16 v[28:31], a[100:103], v[80:83], v[28:31]
  buffer_load_dwordx4 v230, s[12:15], s65 offen offset:1024 lds
  ds_read_b128 v[76:79], v222 offset:6144
  v_mfma_f32_16x16x32_bf16 v[28:31], v[128:131], a[24:27], v[28:31]
  ds_read_b128 v[80:83], v223 offset:6400
  s_waitcnt lgkmcnt(14)
  v_mfma_f32_16x16x32_bf16 v[28:31], v[132:135], a[36:39], v[28:31]
  ds_read2_b32 a[48:49], v218 offset0:191 offset1:192
  v_mfma_f32_16x16x32_bf16 v[32:35], v[128:131], a[28:31], 0
  s_nop 0
  ds_read2_b32 a[50:51], v218 offset0:193 offset1:194
  v_mfma_f32_16x16x32_bf16 v[32:35], v[132:135], a[40:43], v[32:35]
  buffer_load_dwordx4 v231, s[12:15], s65 offen offset:2048 lds
  ds_read2_b32 a[52:53], v218 offset0:175 offset1:176
  v_mfma_f32_16x16x32_bf16 v[36:39], v[128:131], a[32:35], 0
  ds_read2_b32 a[54:55], v218 offset0:177 offset1:178
  s_waitcnt lgkmcnt(15)
  v_mfma_f32_16x16x32_bf16 v[36:39], v[132:135], a[44:47], v[36:39]
  ds_read2_b32 a[56:57], v218 offset0:159 offset1:160
  v_mfma_f32_16x16x32_bf16 v[140:143], v[60:63], a[0:3], 0
  ds_read2_b32 a[58:59], v218 offset0:161 offset1:162
  v_mfma_f32_16x16x32_bf16 v[144:147], v[60:63], a[4:7], 0
  buffer_load_dwordx4 v232, s[12:15], s65 offen offset:3072 lds
  ds_read2_b32 a[60:61], v218 offset0:143 offset1:144
  v_mfma_f32_16x16x32_bf16 v[148:151], v[60:63], a[8:11], 0
  ds_read2_b32 a[62:63], v218 offset0:145 offset1:146
  s_waitcnt lgkmcnt(15)
  v_mfma_f32_16x16x32_bf16 v[152:155], v[64:67], a[4:7], 0
  ds_read_b128 v[64:67], v221 offset:6912
  v_mfma_f32_16x16x32_bf16 v[32:35], a[128:131], v[60:63], v[32:35]
  v_mfma_f32_16x16x32_bf16 v[28:31], a[96:99], v[60:63], v[28:31]
  v_mfma_f32_16x16x32_bf16 v[16:19], a[64:67], v[60:63], v[16:19]
  ds_read_b128 v[60:63], v224 offset:6656
  v_cvt_pk_bf16_f32 v164, v140, v144
  v_mfma_f32_16x16x32_bf16 v[28:31], a[92:95], v[68:71], v[28:31]
  v_cvt_pk_bf16_f32 v165, v141, v145
  v_cvt_pk_bf16_f32 v166, v142, v146
  v_mfma_f32_16x16x32_bf16 v[32:35], a[124:127], v[68:71], v[32:35]
  buffer_load_dword v12, v14, s[24:27], s89 offen sc1
  ds_read_b128 v[68:71], v222 offset:7168
  v_cvt_pk_bf16_f32 v167, v143, v147
  v_mfma_f32_16x16x32_bf16 v[32:35], a[120:123], v[84:87], v[32:35]
  v_cvt_pk_bf16_f32 v10, v16, v17
  v_cvt_pk_bf16_f32 v11, v18, v19
  v_mfma_f32_16x16x32_bf16 v[28:31], a[88:91], v[84:87], v[28:31]
  ds_read_b128 v[84:87], v223 offset:7424
  buffer_store_dwordx4 v[8:11], v13, s[24:27], s84 offen offset:0 sc1
  v_mfma_f32_16x16x32_bf16 v[28:31], a[84:87], v[88:91], v[28:31]
  v_cvt_pk_bf16_f32 v168, v148, v152
  v_cvt_pk_bf16_f32 v169, v149, v153
  v_mfma_f32_16x16x32_bf16 v[32:35], a[116:119], v[88:91], v[32:35]
  ds_read_b128 v[88:91], v224 offset:7680
  v_cvt_pk_bf16_f32 v170, v150, v154
  s_waitcnt lgkmcnt(11)
  v_mfma_f32_16x16x32_bf16 v[32:35], a[112:115], v[92:95], v[32:35]
  v_lshrrev_b32 v2, 4, v1
  v_cvt_pk_bf16_f32 v171, v151, v155
  v_mfma_f32_16x16x32_bf16 v[28:31], a[80:83], v[92:95], v[28:31]
  ds_read_b128 v[92:95], v221 offset:7936
  v_bfe_u32 v4, v1, 2, 2
  v_mfma_f32_16x16x32_bf16 v[28:31], a[76:79], v[96:99], v[28:31]
  v_lshl_add_u32 v5, v2, 2, v4
  v_lshlrev_b32_e64 v5, 7, v5
  v_mfma_f32_16x16x32_bf16 v[32:35], a[108:111], v[96:99], v[32:35]
  ds_read_b128 v[96:99], v221 offset:1792
  v_bfe_u32 v2, v1, 3, 2
  v_mfma_f32_16x16x32_bf16 v[32:35], a[104:107], v[100:103], v[32:35]
  v_lshl_add_u32 v5, v2, 5, v5
  v_and_b32_e64 v2, 3, v1
  v_mfma_f32_16x16x32_bf16 v[28:31], a[72:75], v[100:103], v[28:31]
  ds_read_b128 v[100:103], v225 offset:1792
  v_lshl_add_u32 v52, v2, 3, v5
  v_mfma_f32_16x16x32_bf16 v[28:31], a[68:71], v[20:23], v[28:31]
  s_and_b32 s62, s66, s52
  v_or_b32 v52, s62, v52
  v_mfma_f32_16x16x32_bf16 v[32:35], a[100:103], v[20:23], v[32:35]
  ds_read_b128 v[20:23], v222 offset:8192
  v_xor_b32 v53, 32, v52
  v_mfma_f32_16x16x32_bf16 v[32:35], v[164:167], a[24:27], v[32:35]
  v_xor_b32 v54, 64, v52
  v_xor_b32 v55, 96, v52
  v_mfma_f32_16x16x32_bf16 v[32:35], v[168:171], a[36:39], v[32:35]
  v_add_u32 v56, s55, v52
  v_add_u32 v57, s55, v53
  v_mfma_f32_16x16x32_bf16 v[36:39], v[164:167], a[28:31], v[36:39]
  v_add_u32 v58, s55, v54
  v_add_u32 v59, s55, v55
  v_mfma_f32_16x16x32_bf16 v[36:39], v[168:171], a[40:43], v[36:39]
  v_mfma_f32_16x16x32_bf16 v[40:43], v[164:167], a[32:35], 0
  v_mfma_f32_16x16x32_bf16 v[40:43], v[168:171], a[44:47], v[40:43]
  v_mfma_f32_16x16x32_bf16 v[36:39], a[128:131], v[72:75], v[36:39]
  v_mfma_f32_16x16x32_bf16 v[32:35], a[96:99], v[72:75], v[32:35]
  v_mfma_f32_16x16x32_bf16 v[28:31], a[64:67], v[72:75], v[28:31]
  s_add_u32 s79, s79, 131072
  ds_read_b128 v[72:75], v223 offset:8448
  v_mfma_f32_16x16x32_bf16 v[32:35], a[92:95], v[76:79], v[32:35]
  s_waitcnt vmcnt(10)
  buffer_store_dword v3, v3, s[24:27], s79 offen sc1
  v_mfma_f32_16x16x32_bf16 v[36:39], a[124:127], v[76:79], v[36:39]
  ds_read_b128 v[76:79], v224 offset:8704
  v_mfma_f32_16x16x32_bf16 v[36:39], a[120:123], v[80:83], v[36:39]
  v_mfma_f32_16x16x32_bf16 v[32:35], a[88:91], v[80:83], v[32:35]
  ds_read_b128 v[80:83], v221 offset:3840
  s_waitcnt lgkmcnt(6)
  v_mfma_f32_16x16x32_bf16 v[32:35], a[84:87], v[60:63], v[32:35]
  v_cvt_pk_bf16_f32 v28, v28, v29
  v_cvt_pk_bf16_f32 v29, v30, v31
  v_mfma_f32_16x16x32_bf16 v[36:39], a[116:119], v[60:63], v[36:39]
  ds_read_b128 v[60:63], v225 offset:3840
  v_mfma_f32_16x16x32_bf16 v[36:39], a[112:115], v[64:67], v[36:39]
  v_mfma_f32_16x16x32_bf16 v[32:35], a[80:83], v[64:67], v[32:35]
  ds_read_b128 v[64:67], v221 offset:8960
  v_mfma_f32_16x16x32_bf16 v[32:35], a[76:79], v[68:71], v[32:35]
  v_mfma_f32_16x16x32_bf16 v[36:39], a[108:111], v[68:71], v[36:39]
  ds_read_b128 v[68:71], v222 offset:9216
  v_mfma_f32_16x16x32_bf16 v[36:39], a[104:107], v[84:87], v[36:39]
  v_mfma_f32_16x16x32_bf16 v[32:35], a[72:75], v[84:87], v[32:35]
  ds_read_b128 v[84:87], v221 offset:5888
  v_mfma_f32_16x16x32_bf16 v[32:35], a[68:71], v[88:91], v[32:35]
  v_mfma_f32_16x16x32_bf16 v[36:39], a[100:103], v[88:91], v[36:39]
  ds_read_b128 v[88:91], v225 offset:5888
  v_mfma_f32_16x16x32_bf16 v[40:43], a[128:131], v[92:95], v[40:43]
  v_mfma_f32_16x16x32_bf16 v[36:39], a[96:99], v[92:95], v[36:39]
  v_mfma_f32_16x16x32_bf16 v[32:35], a[64:67], v[92:95], v[32:35]
  ds_read_b128 v[92:95], v223 offset:9472
  s_waitcnt lgkmcnt(9)
  v_mfma_f32_16x16x32_bf16 v[120:123], v[96:99], a[12:15], 0
  v_mfma_f32_16x16x32_bf16 v[124:127], v[100:103], a[16:19], 0
  ds_read_b128 v[100:103], v222 offset:10240
  v_mfma_f32_16x16x32_bf16 v[36:39], v[184:187], v[96:99], v[36:39]
  ds_read_b128 v[96:99], v224 offset:9728
  s_waitcnt vmcnt(2)
  v_cmp_ne_u32 vcc, 0, v12
  v_mfma_f32_16x16x32_bf16 v[36:39], a[92:95], v[20:23], v[36:39]
  s_cbranch_vccnz L_fb_retry
L_fb_ok:
  buffer_load_dwordx4 a[144:147], v24, s[24:27], s90 offen offset:0 sc1
  v_mfma_f32_16x16x32_bf16 v[40:43], a[124:127], v[20:23], v[40:43]
  ds_read_b128 v[20:23], v223 offset:10496
  v_cvt_pk_bf16_f32 v30, v32, v33
  s_waitcnt lgkmcnt(10)
  v_mfma_f32_16x16x32_bf16 v[40:43], a[120:123], v[72:75], v[40:43]
  v_cvt_pk_bf16_f32 v31, v34, v35
  buffer_store_dwordx4 v[28:31], v13, s[24:27], s84 offen offset:1024 sc1
  s_nop 0
  v_mfma_f32_16x16x32_bf16 v[36:39], a[88:91], v[72:75], v[36:39]
  ds_read_b128 v[72:75], v221 offset:7936
  v_cvt_pk_bf16_f32 v136, v120, v124
  v_mfma_f32_16x16x32_bf16 v[36:39], a[84:87], v[76:79], v[36:39]
  buffer_load_dwordx4 a[148:151], v25, s[24:27], s90 offen offset:0 sc1
  v_cvt_pk_bf16_f32 v137, v121, v125
  v_cvt_pk_bf16_f32 v138, v122, v126
  v_mfma_f32_16x16x32_bf16 v[40:43], a[116:119], v[76:79], v[40:43]
  ds_read_b128 v[76:79], v225 offset:7936
  v_cvt_pk_bf16_f32 v139, v123, v127
  s_nop 1
  v_mfma_f32_16x16x32_bf16 v[36:39], v[136:139], a[48:51], v[36:39]
  v_mfma_f32_16x16x32_bf16 v[40:43], v[136:139], a[52:55], v[40:43]
  v_mfma_f32_16x16x32_bf16 v[44:47], v[136:139], a[56:59], 0
  buffer_load_dwordx4 a[152:155], v24, s[24:27], s90 offen offset:1024 sc1
  v_mfma_f32_16x16x32_bf16 v[48:51], v[136:139], a[60:63], 0
  s_waitcnt lgkmcnt(7)
  v_mfma_f32_16x16x32_bf16 v[156:159], v[80:83], a[12:15], 0
  v_mfma_f32_16x16x32_bf16 v[160:163], v[60:63], a[16:19], 0
  ds_read_b128 v[60:63], v221 offset:11008
  v_mfma_f32_16x16x32_bf16 v[40:43], v[184:187], v[80:83], v[40:43]
  buffer_load_dwordx4 a[156:159], v25, s[24:27], s90 offen offset:1024 sc1
  ds_read_b128 v[80:83], v224 offset:10752
  v_mfma_f32_16x16x32_bf16 v[40:43], a[112:115], v[64:67], v[40:43]
  s_add_u32 s90, s90, s54
  s_and_b32 s90, s90, s53
  v_mfma_f32_16x16x32_bf16 v[36:39], a[80:83], v[64:67], v[36:39]
  ds_read_b128 v[64:67], v222 offset:11264
  v_mfma_f32_16x16x32_bf16 v[36:39], a[76:79], v[68:71], v[36:39]
  v_mfma_f32_16x16x32_bf16 v[40:43], a[108:111], v[68:71], v[40:43]
  buffer_load_dwordx4 a[160:163], v24, s[24:27], s90 offen offset:0 sc1
  ds_read_b128 v[68:71], v223 offset:11520
  v_cvt_pk_bf16_f32 v172, v156, v160
  v_cvt_pk_bf16_f32 v173, v157, v161
  v_cvt_pk_bf16_f32 v174, v158, v162
  v_cvt_pk_bf16_f32 v175, v159, v163
  s_nop 1
  v_mfma_f32_16x16x32_bf16 v[40:43], v[172:175], a[48:51], v[40:43]
  v_mfma_f32_16x16x32_bf16 v[44:47], v[172:175], a[52:55], v[44:47]
  v_mfma_f32_16x16x32_bf16 v[48:51], v[172:175], a[56:59], v[48:51]
  v_mfma_f32_16x16x32_bf16 v[104:107], v[84:87], a[0:3], 0
  buffer_load_dwordx4 a[164:167], v25, s[24:27], s90 offen offset:0 sc1
  v_mfma_f32_16x16x32_bf16 v[108:111], v[84:87], a[4:7], 0
  v_mfma_f32_16x16x32_bf16 v[112:115], v[84:87], a[8:11], 0
  s_waitcnt lgkmcnt(5)
  v_mfma_f32_16x16x32_bf16 v[116:119], v[88:91], a[4:7], 0
  v_mfma_f32_16x16x32_bf16 v[120:123], v[84:87], a[12:15], 0
  buffer_load_dwordx4 a[168:171], v24, s[24:27], s90 offen offset:1024 sc1
  v_mfma_f32_16x16x32_bf16 v[124:127], v[88:91], a[16:19], 0
  ds_read_b128 v[88:91], v221 offset:9984
  v_mfma_f32_16x16x32_bf16 v[44:47], v[184:187], v[84:87], v[44:47]
  ds_read_b128 v[84:87], v224 offset:11776
  v_mfma_f32_16x16x32_bf16 v[40:43], a[104:107], v[92:95], v[40:43]
  v_cvt_pk_bf16_f32 v128, v104, v108
  v_cvt_pk_bf16_f32 v129, v105, v109
  v_mfma_f32_16x16x32_bf16 v[36:39], a[72:75], v[92:95], v[36:39]
  buffer_load_dwordx4 a[172:175], v25, s[24:27], s90 offen offset:1024 sc1
  ds_read_b128 v[92:95], v225 offset:9984
  v_cvt_pk_bf16_f32 v130, v106, v110
  v_mfma_f32_16x16x32_bf16 v[36:39], a[68:71], v[96:99], v[36:39]
  v_cvt_pk_bf16_f32 v131, v107, v111
  v_cvt_pk_bf16_f32 v132, v112, v116
  v_mfma_f32_16x16x32_bf16 v[40:43], a[100:103], v[96:99], v[40:43]
  s_add_u32 s90, s90, 2048
  ds_read_b128 v[96:99], v221 offset:12032
  v_cvt_pk_bf16_f32 v133, v113, v117
  v_mfma_f32_16x16x32_bf16 v[40:43], a[92:95], v[100:103], v[40:43]
  v_cvt_pk_bf16_f32 v134, v114, v118
  v_cvt_pk_bf16_f32 v135, v115, v119
  v_mfma_f32_16x16x32_bf16 v[44:47], a[124:127], v[100:103], v[44:47]
  s_and_b32 s90, s90, 16383
  ds_read_b128 v[100:103], v225 offset:12032
  v_cvt_pk_bf16_f32 v136, v120, v124
  v_mfma_f32_16x16x32_bf16 v[44:47], a[120:123], v[20:23], v[44:47]
  v_cvt_pk_bf16_f32 v137, v121, v125
  v_cvt_pk_bf16_f32 v138, v122, v126
  v_mfma_f32_16x16x32_bf16 v[40:43], a[88:91], v[20:23], v[40:43]
  buffer_load_dwordx4 a[176:179], v24, s[24:27], s90 offen offset:0 sc1
  ds_read_b128 v[20:23], v222 offset:12288
  v_cvt_pk_bf16_f32 v139, v123, v127
  v_mfma_f32_16x16x32_bf16 v[36:39], v[128:131], a[24:27], v[36:39]
  v_mfma_f32_16x16x32_bf16 v[36:39], v[132:135], a[36:39], v[36:39]
  v_mfma_f32_16x16x32_bf16 v[40:43], v[128:131], a[28:31], v[40:43]
  v_mfma_f32_16x16x32_bf16 v[40:43], v[132:135], a[40:43], v[40:43]
  buffer_load_dwordx4 a[180:183], v25, s[24:27], s90 offen offset:0 sc1
  v_mfma_f32_16x16x32_bf16 v[44:47], v[128:131], a[32:35], v[44:47]
  v_mfma_f32_16x16x32_bf16 v[44:47], v[132:135], a[44:47], v[44:47]
  v_mfma_f32_16x16x32_bf16 v[44:47], v[136:139], a[48:51], v[44:47]
  v_mfma_f32_16x16x32_bf16 v[48:51], v[136:139], a[52:55], v[48:51]
  buffer_load_dwordx4 a[184:187], v24, s[24:27], s90 offen offset:1024 sc1
  v_mfma_f32_16x16x32_bf16 v[140:143], v[72:75], a[0:3], 0
  v_mfma_f32_16x16x32_bf16 v[144:147], v[72:75], a[4:7], 0
  v_mfma_f32_16x16x32_bf16 v[148:151], v[72:75], a[8:11], 0
  s_waitcnt lgkmcnt(4)
  s_nop 0
  v_mfma_f32_16x16x32_bf16 v[152:155], v[76:79], a[4:7], 0
  buffer_load_dwordx4 a[188:191], v25, s[24:27], s90 offen offset:1024 sc1
  s_add_u32 s90, s90, 2048
  v_mfma_f32_16x16x32_bf16 v[156:159], v[72:75], a[12:15], 0
  s_and_b32 s90, s90, 16383
  v_mfma_f32_16x16x32_bf16 v[160:163], v[76:79], a[16:19], 0
  ds_read_b128 v[76:79], v224 offset:12800
  v_mfma_f32_16x16x32_bf16 v[48:51], v[184:187], v[72:75], v[48:51]
  ds_read_b128 v[72:75], v223 offset:12544
  v_mfma_f32_16x16x32_bf16 v[40:43], a[84:87], v[80:83], v[40:43]
  buffer_load_dwordx4 a[192:195], v24, s[24:27], s90 offen offset:0 sc1
  v_cvt_pk_bf16_f32 v164, v140, v144
  v_cvt_pk_bf16_f32 v165, v141, v145
  v_mfma_f32_16x16x32_bf16 v[44:47], a[116:119], v[80:83], v[44:47]
  ds_read_b128 v[80:83], v221 offset:13056
  v_cvt_pk_bf16_f32 v166, v142, v146
  v_mfma_f32_16x16x32_bf16 v[44:47], a[112:115], v[60:63], v[44:47]
  v_cvt_pk_bf16_f32 v167, v143, v147
  v_cvt_pk_bf16_f32 v168, v148, v152
  v_mfma_f32_16x16x32_bf16 v[40:43], a[80:83], v[60:63], v[40:43]
  ds_read_b128 v[60:63], v222 offset:13312
  v_cvt_pk_bf16_f32 v169, v149, v153
  v_mfma_f32_16x16x32_bf16 v[40:43], a[76:79], v[64:67], v[40:43]
  buffer_load_dwordx4 a[196:199], v25, s[24:27], s90 offen offset:0 sc1
  v_cvt_pk_bf16_f32 v170, v150, v154
  v_cvt_pk_bf16_f32 v171, v151, v155
  v_mfma_f32_16x16x32_bf16 v[44:47], a[108:111], v[64:67], v[44:47]
  ds_read_b128 v[64:67], v221 offset:14080
  v_cvt_pk_bf16_f32 v172, v156, v160
  v_mfma_f32_16x16x32_bf16 v[44:47], a[104:107], v[68:71], v[44:47]
  v_cvt_pk_bf16_f32 v173, v157, v161
  v_cvt_pk_bf16_f32 v174, v158, v162
  v_mfma_f32_16x16x32_bf16 v[40:43], a[72:75], v[68:71], v[40:43]
  ds_read_b128 v[68:71], v221 offset:16128
  v_cvt_pk_bf16_f32 v175, v159, v163
  v_mfma_f32_16x16x32_bf16 v[40:43], a[68:71], v[84:87], v[40:43]
  buffer_load_dwordx4 a[200:203], v24, s[24:27], s90 offen offset:1024 sc1
  v_mfma_f32_16x16x32_bf16 v[44:47], a[100:103], v[84:87], v[44:47]
  ds_read_b128 v[84:87], v223 offset:13568
  v_mfma_f32_16x16x32_bf16 v[40:43], v[164:167], a[24:27], v[40:43]
  v_mfma_f32_16x16x32_bf16 v[40:43], v[168:171], a[36:39], v[40:43]
  v_mfma_f32_16x16x32_bf16 v[44:47], v[164:167], a[28:31], v[44:47]
  buffer_load_dwordx4 a[204:207], v25, s[24:27], s90 offen offset:1024 sc1
  s_add_u32 s90, s90, 2048
  v_mfma_f32_16x16x32_bf16 v[44:47], v[168:171], a[40:43], v[44:47]
  s_and_b32 s90, s90, s53
  v_mfma_f32_16x16x32_bf16 v[48:51], v[164:167], a[32:35], v[48:51]
  v_mfma_f32_16x16x32_bf16 v[48:51], v[168:171], a[44:47], v[48:51]
  v_mfma_f32_16x16x32_bf16 v[48:51], v[172:175], a[48:51], v[48:51]
  buffer_load_dwordx4 a[208:211], v24, s[24:27], s90 offen offset:0 sc1
  v_mfma_f32_16x16x32_bf16 v[104:107], v[88:91], a[0:3], 0
  v_mfma_f32_16x16x32_bf16 v[108:111], v[88:91], a[4:7], 0
  v_mfma_f32_16x16x32_bf16 v[112:115], v[88:91], a[8:11], 0
  s_waitcnt lgkmcnt(5)
  v_mfma_f32_16x16x32_bf16 v[116:119], v[92:95], a[4:7], 0
  buffer_load_dwordx4 a[212:215], v25, s[24:27], s90 offen offset:0 sc1
  ds_read_b128 v[92:95], v222 offset:14336
  v_mfma_f32_16x16x32_bf16 v[44:47], a[128:131], v[88:91], v[44:47]
  v_mfma_f32_16x16x32_bf16 v[40:43], a[96:99], v[88:91], v[40:43]
  v_mfma_f32_16x16x32_bf16 v[36:39], a[64:67], v[88:91], v[36:39]
  ds_read_b128 v[88:91], v224 offset:13824
  v_cvt_pk_bf16_f32 v128, v104, v108
  v_cvt_pk_bf16_f32 v129, v105, v109
  v_cvt_pk_bf16_f32 v130, v106, v110
  v_cvt_pk_bf16_f32 v131, v107, v111
  v_cvt_pk_bf16_f32 v132, v112, v116
  v_cvt_pk_bf16_f32 v133, v113, v117
  v_mfma_f32_16x16x32_bf16 v[44:47], v[128:131], a[24:27], v[44:47]
  buffer_load_dwordx4 a[216:219], v24, s[24:27], s90 offen offset:1024 sc1
  v_cvt_pk_bf16_f32 v134, v114, v118
  v_cvt_pk_bf16_f32 v135, v115, v119
  s_nop 1
  v_mfma_f32_16x16x32_bf16 v[44:47], v[132:135], a[36:39], v[44:47]
  v_mfma_f32_16x16x32_bf16 v[48:51], v[128:131], a[28:31], v[48:51]
  s_nop 0
  v_mfma_f32_16x16x32_bf16 v[48:51], v[132:135], a[40:43], v[48:51]
  v_mfma_f32_16x16x32_bf16 v[140:143], v[96:99], a[0:3], 0
  buffer_load_dwordx4 a[220:223], v25, s[24:27], s90 offen offset:1024 sc1
  s_add_u32 s90, s90, 2048
  v_mfma_f32_16x16x32_bf16 v[144:147], v[96:99], a[4:7], 0
  s_and_b32 s90, s90, 16383
  v_mfma_f32_16x16x32_bf16 v[148:151], v[96:99], a[8:11], 0
  v_mfma_f32_16x16x32_bf16 v[152:155], v[100:103], a[4:7], 0
  ds_read_b128 v[100:103], v224 offset:14848
  v_mfma_f32_16x16x32_bf16 v[48:51], a[128:131], v[96:99], v[48:51]
  buffer_load_dwordx4 a[224:227], v24, s[24:27], s90 offen offset:0 sc1
  v_mfma_f32_16x16x32_bf16 v[44:47], a[96:99], v[96:99], v[44:47]
  v_mfma_f32_16x16x32_bf16 v[40:43], a[64:67], v[96:99], v[40:43]
  ds_read_b128 v[96:99], v223 offset:14592
  v_mfma_f32_16x16x32_bf16 v[44:47], a[92:95], v[20:23], v[44:47]
  v_cvt_pk_bf16_f32 v164, v140, v144
  v_cvt_pk_bf16_f32 v165, v141, v145
  v_mfma_f32_16x16x32_bf16 v[48:51], a[124:127], v[20:23], v[48:51]
  buffer_load_dwordx4 a[228:231], v25, s[24:27], s90 offen offset:0 sc1
  s_barrier
  s_nop 0
  ds_read_b128 v[20:23], v221 offset:15104
  v_cvt_pk_bf16_f32 v166, v142, v146
  v_mfma_f32_16x16x32_bf16 v[48:51], a[120:123], v[72:75], v[48:51]
  ds_read_b64_tr_b16 v[176:177], v52 offset:0
  v_cvt_pk_bf16_f32 v167, v143, v147
  v_cvt_pk_bf16_f32 v168, v148, v152
  v_mfma_f32_16x16x32_bf16 v[44:47], a[88:91], v[72:75], v[44:47]
  ds_read_b64_tr_b16 v[178:179], v52 offset:2048
  ds_read_b128 v[72:75], v222 offset:15360
  v_cvt_pk_bf16_f32 v169, v149, v153
  v_mfma_f32_16x16x32_bf16 v[44:47], a[84:87], v[76:79], v[44:47]
  ds_read_b64_tr_b16 v[180:181], v52 offset:8192
  v_cvt_pk_bf16_f32 v170, v150, v154
  v_cvt_pk_bf16_f32 v171, v151, v155
  v_mfma_f32_16x16x32_bf16 v[48:51], a[116:119], v[76:79], v[48:51]
  buffer_load_dwordx4 a[232:235], v24, s[24:27], s90 offen offset:1024 sc1
  ds_read_b64_tr_b16 v[182:183], v52 offset:10240
  ds_read_b128 v[76:79], v223 offset:15616
  s_waitcnt lgkmcnt(9)
  v_mfma_f32_16x16x32_bf16 v[48:51], a[112:115], v[80:83], v[48:51]
  s_nop 0
  ds_read_b64_tr_b16 v[188:189], v53 offset:0
  v_mfma_f32_16x16x32_bf16 v[44:47], a[80:83], v[80:83], v[44:47]
  ds_read_b64_tr_b16 v[190:191], v53 offset:2048
  ds_read_b128 v[80:83], v224 offset:15872
  v_mfma_f32_16x16x32_bf16 v[44:47], a[76:79], v[60:63], v[44:47]
  ds_read_b64_tr_b16 v[192:193], v53 offset:8192
  v_mfma_f32_16x16x32_bf16 v[48:51], a[108:111], v[60:63], v[48:51]
  s_add_u32 s89, s89, 131072
  buffer_load_dword v12, v14, s[24:27], s89 offen sc1
  ds_read_b64_tr_b16 v[194:195], v53 offset:10240
  v_mfma_f32_16x16x32_bf16 v[48:51], v[164:167], a[24:27], v[48:51]
  ds_read_b64_tr_b16 v[196:197], v54 offset:0
  v_mfma_f32_16x16x32_bf16 v[48:51], v[168:171], a[36:39], v[48:51]
  ds_read_b64_tr_b16 v[198:199], v54 offset:2048
  v_mfma_f32_16x16x32_bf16 v[48:51], a[96:99], v[64:67], v[48:51]
  ds_read_b64_tr_b16 v[200:201], v54 offset:8192
  v_mfma_f32_16x16x32_bf16 v[44:47], a[64:67], v[64:67], v[44:47]
  buffer_load_dwordx4 a[236:239], v25, s[24:27], s90 offen offset:1024 sc1
  s_add_u32 s90, s90, 2048
  ds_read_b64_tr_b16 v[202:203], v54 offset:10240
  v_mfma_f32_16x16x32_bf16 v[48:51], a[64:67], v[68:71], v[48:51]
  s_and_b32 s90, s90, 16383
  ds_read_b64_tr_b16 v[204:205], v55 offset:0
  v_mfma_f32_16x16x32_bf16 v[48:51], a[104:107], v[84:87], v[48:51]
  ds_read_b64_tr_b16 v[206:207], v55 offset:2048
  ds_read_b64_tr_b16 v[208:209], v55 offset:8192
  v_mfma_f32_16x16x32_bf16 v[44:47], a[72:75], v[84:87], v[44:47]
  ds_read_b64_tr_b16 v[210:211], v55 offset:10240
  v_mfma_f32_16x16x32_bf16 v[44:47], a[68:71], v[88:91], v[44:47]
  buffer_load_dwordx4 a[240:243], v24, s[24:27], s90 offen offset:0 sc1
  v_mfma_f32_16x16x32_bf16 v[48:51], a[100:103], v[88:91], v[48:51]
  v_mfma_f32_16x16x32_bf16 v[48:51], a[92:95], v[92:95], v[48:51]
  s_waitcnt lgkmcnt(15)
  v_mfma_f32_16x16x32_bf16 v[48:51], a[88:91], v[96:99], v[48:51]
  v_mfma_f32_16x16x32_bf16 v[48:51], a[84:87], v[100:103], v[48:51]
  buffer_load_dwordx4 a[244:247], v25, s[24:27], s90 offen offset:0 sc1
  s_nop 0
  v_mfma_f32_16x16x32_bf16 v[48:51], a[80:83], v[20:23], v[48:51]
  v_mfma_f32_16x16x32_bf16 v[48:51], a[76:79], v[72:75], v[48:51]
  s_waitcnt lgkmcnt(13)
  v_mfma_f32_16x16x32_bf16 v[48:51], a[72:75], v[76:79], v[48:51]
  s_waitcnt lgkmcnt(10)
  v_mfma_f32_16x16x32_bf16 v[48:51], a[68:71], v[80:83], v[48:51]
  buffer_load_dwordx4 a[248:251], v24, s[24:27], s90 offen offset:1024 sc1
  v_cvt_pk_bf16_f32 v36, v36, v37
  v_cvt_pk_bf16_f32 v37, v38, v39
  v_cvt_pk_bf16_f32 v38, v40, v41
  v_cvt_pk_bf16_f32 v39, v42, v43
  buffer_store_dwordx4 v[36:39], v13, s[24:27], s84 offen offset:2048 sc1
  v_cvt_pk_bf16_f32 v44, v44, v45
  v_cvt_pk_bf16_f32 v45, v46, v47
  v_cvt_pk_bf16_f32 v46, v48, v49
  v_cvt_pk_bf16_f32 v47, v50, v51
  buffer_store_dwordx4 v[44:47], v13, s[24:27], s84 offen offset:3072 sc1
  s_waitcnt vmcnt(26) lgkmcnt(8)
  v_mfma_f32_16x16x32_bf16 v[20:23], v[176:179], a[144:147], 0
  ds_read_b64_tr_b16 v[88:89], v52 offset:16384
  s_lshl2_add_u32 s85, s58, s59
  v_mfma_f32_16x16x32_bf16 v[20:23], v[180:183], a[152:155], v[20:23]
  ds_read_b64_tr_b16 v[90:91], v52 offset:18432
  s_lshl_b32 s86, s85, 16
  v_mfma_f32_16x16x32_bf16 v[60:63], v[180:183], a[156:159], 0
  ds_read_b64_tr_b16 v[92:93], v52 offset:24576
  s_lshl_b32 s85, s85, 11
  v_mfma_f32_16x16x32_bf16 v[60:63], v[176:179], a[148:151], v[60:63]
  ds_read_b64_tr_b16 v[94:95], v52 offset:26624
  s_add_u32 s85, s85, 11403264
  v_mfma_f32_16x16x32_bf16 v[68:71], v[188:191], a[148:151], 0
  ds_read_b64_tr_b16 v[96:97], v53 offset:16384
  v_lshlrev_b32 v120, 7, v15
  v_mfma_f32_16x16x32_bf16 v[68:71], v[192:195], a[156:159], v[68:71]
  ds_read_b64_tr_b16 v[98:99], v53 offset:18432
  v_lshlrev_b32 v5, 1, v26
  v_mfma_f32_16x16x32_bf16 v[64:67], v[192:195], a[152:155], 0
  ds_read_b64_tr_b16 v[100:101], v53 offset:24576
  v_xor_b32_e64 v5, v5, v15
  v_mfma_f32_16x16x32_bf16 v[64:67], v[188:191], a[144:147], v[64:67]
  ds_read_b64_tr_b16 v[102:103], v53 offset:26624
  s_waitcnt lgkmcnt(8)
  v_mfma_f32_16x16x32_bf16 v[72:75], v[196:199], a[144:147], 0
  ds_read_b64_tr_b16 v[104:105], v54 offset:16384
  v_lshlrev_b32 v5, 4, v5
  v_mfma_f32_16x16x32_bf16 v[72:75], v[200:203], a[152:155], v[72:75]
  ds_read_b64_tr_b16 v[106:107], v54 offset:18432
  v_lshl_add_u32 v121, v26, 12, v5
  v_mfma_f32_16x16x32_bf16 v[76:79], v[200:203], a[156:159], 0
  ds_read_b64_tr_b16 v[108:109], v54 offset:24576
  v_xor_b32 v122, 128, v121
  v_mfma_f32_16x16x32_bf16 v[76:79], v[196:199], a[148:151], v[76:79]
  ds_read_b64_tr_b16 v[110:111], v54 offset:26624
  s_lshl_b32 s62, s57, 8
  v_mfma_f32_16x16x32_bf16 v[84:87], v[204:207], a[148:151], 0
  ds_read_b64_tr_b16 v[112:113], v55 offset:16384
  s_add_u32 s86, s86, s62
  v_mfma_f32_16x16x32_bf16 v[84:87], v[208:211], a[156:159], v[84:87]
  ds_read_b64_tr_b16 v[114:115], v55 offset:18432
  v_bfe_u32 v5, v1, 2, 2
  v_mfma_f32_16x16x32_bf16 v[80:83], v[208:211], a[152:155], 0
  ds_read_b64_tr_b16 v[116:117], v55 offset:24576
  v_lshl_add_u32 v4, v26, 3, v5
  v_mfma_f32_16x16x32_bf16 v[80:83], v[204:207], a[144:147], v[80:83]
  ds_read_b64_tr_b16 v[118:119], v55 offset:26624
  s_waitcnt vmcnt(22) lgkmcnt(8)
  s_nop 0
  v_mfma_f32_16x16x32_bf16 v[20:23], v[88:91], a[160:163], v[20:23]
  ds_read_b64_tr_b16 v[176:177], v52 offset:32768
  buffer_load_dwordx4 a[252:255], v25, s[24:27], s90 offen offset:1024 sc1
  v_mfma_f32_16x16x32_bf16 v[20:23], v[92:95], a[168:171], v[20:23]
  ds_read_b64_tr_b16 v[178:179], v52 offset:34816
  s_add_u32 s90, s90, 2048
  v_mfma_f32_16x16x32_bf16 v[60:63], v[92:95], a[172:175], v[60:63]
  ds_read_b64_tr_b16 v[180:181], v52 offset:40960
  s_and_b32 s90, s90, 16383
  v_mfma_f32_16x16x32_bf16 v[60:63], v[88:91], a[164:167], v[60:63]
  ds_read_b64_tr_b16 v[182:183], v52 offset:43008
  v_lshlrev_b32_e64 v4, 8, v4
  v_mfma_f32_16x16x32_bf16 v[68:71], v[96:99], a[164:167], v[68:71]
  ds_read_b64_tr_b16 v[188:189], v53 offset:32768
  buffer_load_dwordx4 a[0:3], v24, s[24:27], s90 offen offset:0 sc1
  v_mfma_f32_16x16x32_bf16 v[68:71], v[100:103], a[172:175], v[68:71]
  ds_read_b64_tr_b16 v[190:191], v53 offset:34816
  v_bfe_u32 v5, v1, 2, 3
  v_mfma_f32_16x16x32_bf16 v[64:67], v[100:103], a[168:171], v[64:67]
  ds_read_b64_tr_b16 v[192:193], v53 offset:40960
  s_lshl_b32 s62, s59, 1
  v_mfma_f32_16x16x32_bf16 v[64:67], v[96:99], a[160:163], v[64:67]
  ds_read_b64_tr_b16 v[194:195], v53 offset:43008
  s_waitcnt lgkmcnt(8)
  v_mfma_f32_16x16x32_bf16 v[72:75], v[104:107], a[160:163], v[72:75]
  ds_read_b64_tr_b16 v[196:197], v54 offset:32768
  buffer_load_dwordx4 a[4:7], v25, s[24:27], s90 offen offset:0 sc1
  v_mfma_f32_16x16x32_bf16 v[72:75], v[108:111], a[168:171], v[72:75]
  ds_read_b64_tr_b16 v[198:199], v54 offset:34816
  v_xor_b32_e64 v5, s62, v5
  v_mfma_f32_16x16x32_bf16 v[76:79], v[108:111], a[172:175], v[76:79]
  ds_read_b64_tr_b16 v[200:201], v54 offset:40960
  v_lshl_add_u32 v4, v5, 5, v4
  v_mfma_f32_16x16x32_bf16 v[76:79], v[104:107], a[164:167], v[76:79]
  ds_read_b64_tr_b16 v[202:203], v54 offset:43008
  v_and_b32_e64 v5, 3, v1
  v_mfma_f32_16x16x32_bf16 v[84:87], v[112:115], a[164:167], v[84:87]
  ds_read_b64_tr_b16 v[204:205], v55 offset:32768
  buffer_load_dwordx4 a[8:11], v24, s[24:27], s90 offen offset:1024 sc1
  v_mfma_f32_16x16x32_bf16 v[84:87], v[116:119], a[172:175], v[84:87]
  ds_read_b64_tr_b16 v[206:207], v55 offset:34816
  v_lshl_add_u32 v4, v5, 3, v4
  v_mfma_f32_16x16x32_bf16 v[80:83], v[116:119], a[168:171], v[80:83]
  ds_read_b64_tr_b16 v[208:209], v55 offset:40960
  v_add_u32_e64 v123, s7, v4
  v_mfma_f32_16x16x32_bf16 v[80:83], v[112:115], a[160:163], v[80:83]
  ds_read_b64_tr_b16 v[210:211], v55 offset:43008
  s_waitcnt vmcnt(22) lgkmcnt(8)
  v_mfma_f32_16x16x32_bf16 v[20:23], v[176:179], a[176:179], v[20:23]
  ds_read_b64_tr_b16 v[88:89], v52 offset:49152
  buffer_load_dwordx4 a[12:15], v25, s[24:27], s90 offen offset:1024 sc1
  v_mfma_f32_16x16x32_bf16 v[20:23], v[180:183], a[184:187], v[20:23]
  ds_read_b64_tr_b16 v[90:91], v52 offset:51200
  s_waitcnt vmcnt(11)
  v_cmp_ne_u32 vcc, 0, v12
  v_mfma_f32_16x16x32_bf16 v[60:63], v[180:183], a[188:191], v[60:63]
  ds_read_b64_tr_b16 v[92:93], v52 offset:57344
  s_cbranch_vccnz L_fc_retry
L_fc_ok:
  v_mfma_f32_16x16x32_bf16 v[60:63], v[176:179], a[180:183], v[60:63]
  ds_read_b64_tr_b16 v[94:95], v52 offset:59392
  v_add_u32 v24, s51, v24
  v_mfma_f32_16x16x32_bf16 v[68:71], v[188:191], a[180:183], v[68:71]
  ds_read_b64_tr_b16 v[96:97], v53 offset:49152
  v_add_u32 v25, s51, v25
  v_mfma_f32_16x16x32_bf16 v[68:71], v[192:195], a[188:191], v[68:71]
  ds_read_b64_tr_b16 v[98:99], v53 offset:51200
  s_add_u32 s90, s90, 2048
  v_mfma_f32_16x16x32_bf16 v[64:67], v[192:195], a[184:187], v[64:67]
  ds_read_b64_tr_b16 v[100:101], v53 offset:57344
  s_and_b32 s90, s90, s53
  v_mfma_f32_16x16x32_bf16 v[64:67], v[188:191], a[176:179], v[64:67]
  ds_read_b64_tr_b16 v[102:103], v53 offset:59392
  s_barrier
  s_waitcnt lgkmcnt(8)
  v_mfma_f32_16x16x32_bf16 v[72:75], v[196:199], a[176:179], v[72:75]
  ds_read_b64_tr_b16 v[104:105], v54 offset:49152
  s_waitcnt vmcnt(5)
  v_mfma_f32_16x16x32_bf16 v[72:75], v[200:203], a[184:187], v[72:75]
  ds_read_b64_tr_b16 v[106:107], v54 offset:51200
  buffer_store_dword v3, v3, s[24:27], s80 offen sc1
  v_mfma_f32_16x16x32_bf16 v[76:79], v[200:203], a[188:191], v[76:79]
  ds_read_b64_tr_b16 v[108:109], v54 offset:57344
  v_xor_b32 v124, 32, v123
  v_mfma_f32_16x16x32_bf16 v[76:79], v[196:199], a[180:183], v[76:79]
  ds_read_b64_tr_b16 v[110:111], v54 offset:59392
  v_and_b32 v4, 7, v15
  v_mfma_f32_16x16x32_bf16 v[84:87], v[204:207], a[180:183], v[84:87]
  ds_read_b64_tr_b16 v[112:113], v55 offset:49152
  v_lshl_add_u32 v2, v15, 7, s66
  v_mfma_f32_16x16x32_bf16 v[84:87], v[208:211], a[188:191], v[84:87]
  ds_read_b64_tr_b16 v[114:115], v55 offset:51200
  buffer_load_dwordx4 a[16:19], v24, s[24:27], s90 offen offset:0 sc1
  v_mfma_f32_16x16x32_bf16 v[80:83], v[208:211], a[184:187], v[80:83]
  ds_read_b64_tr_b16 v[116:117], v55 offset:57344
  v_xor_b32_e64 v5, v4, v26
  v_mfma_f32_16x16x32_bf16 v[80:83], v[204:207], a[176:179], v[80:83]
  ds_read_b64_tr_b16 v[118:119], v55 offset:59392
  s_waitcnt lgkmcnt(8)
  v_mfma_f32_16x16x32_bf16 v[20:23], v[88:91], a[192:195], v[20:23]
  ds_read_b64_tr_b16 v[176:177], v56 offset:0
  v_xor_b32 v52, s52, v52
  v_mfma_f32_16x16x32_bf16 v[20:23], v[92:95], a[200:203], v[20:23]
  ds_read_b64_tr_b16 v[178:179], v56 offset:2048
  buffer_load_dwordx4 a[20:23], v25, s[24:27], s90 offen offset:0 sc1
  v_mfma_f32_16x16x32_bf16 v[60:63], v[92:95], a[204:207], v[60:63]
  ds_read_b64_tr_b16 v[180:181], v56 offset:8192
  v_xor_b32_e64 v53, s52, v53
  v_mfma_f32_16x16x32_bf16 v[60:63], v[88:91], a[196:199], v[60:63]
  ds_read_b64_tr_b16 v[182:183], v56 offset:10240
  v_xor_b32 v54, s52, v54
  v_mfma_f32_16x16x32_bf16 v[68:71], v[96:99], a[196:199], v[68:71]
  ds_read_b64_tr_b16 v[188:189], v57 offset:0
  v_xor_b32 v55, s52, v55
  v_mfma_f32_16x16x32_bf16 v[68:71], v[100:103], a[204:207], v[68:71]
  ds_read_b64_tr_b16 v[190:191], v57 offset:2048
  buffer_load_dwordx4 a[24:27], v24, s[24:27], s90 offen offset:1024 sc1
  v_mfma_f32_16x16x32_bf16 v[64:67], v[100:103], a[200:203], v[64:67]
  ds_read_b64_tr_b16 v[192:193], v57 offset:8192
  v_lshl_add_u32 v127, v5, 4, v2
  v_mfma_f32_16x16x32_bf16 v[64:67], v[96:99], a[192:195], v[64:67]
  ds_read_b64_tr_b16 v[194:195], v57 offset:10240
  s_waitcnt lgkmcnt(8)
  v_mfma_f32_16x16x32_bf16 v[72:75], v[104:107], a[192:195], v[72:75]
  ds_read_b64_tr_b16 v[196:197], v58 offset:0
  v_add_u32 v127, s7, v127
  v_mfma_f32_16x16x32_bf16 v[72:75], v[108:111], a[200:203], v[72:75]
  ds_read_b64_tr_b16 v[198:199], v58 offset:2048
  buffer_load_dwordx4 a[28:31], v25, s[24:27], s90 offen offset:1024 sc1
  v_mfma_f32_16x16x32_bf16 v[76:79], v[108:111], a[204:207], v[76:79]
  ds_read_b64_tr_b16 v[200:201], v58 offset:8192
  s_add_u32 s90, s90, 2048
  v_mfma_f32_16x16x32_bf16 v[76:79], v[104:107], a[196:199], v[76:79]
  ds_read_b64_tr_b16 v[202:203], v58 offset:10240
  s_and_b32 s90, s90, 16383
  v_mfma_f32_16x16x32_bf16 v[84:87], v[112:115], a[196:199], v[84:87]
  ds_read_b64_tr_b16 v[204:205], v59 offset:0
  v_xor_b32_e64 v128, 64, v127
  v_mfma_f32_16x16x32_bf16 v[84:87], v[116:119], a[204:207], v[84:87]
  ds_read_b64_tr_b16 v[206:207], v59 offset:2048
  buffer_load_dwordx4 a[32:35], v24, s[24:27], s90 offen offset:0 sc1
  v_mfma_f32_16x16x32_bf16 v[80:83], v[116:119], a[200:203], v[80:83]
  ds_read_b64_tr_b16 v[208:209], v59 offset:8192
  v_lshlrev_b32 v4, 1, v4
  v_mfma_f32_16x16x32_bf16 v[80:83], v[112:115], a[192:195], v[80:83]
  ds_read_b64_tr_b16 v[210:211], v59 offset:10240
  s_waitcnt lgkmcnt(8)
  v_mfma_f32_16x16x32_bf16 v[20:23], v[176:179], a[208:211], v[20:23]
  ds_read_b64_tr_b16 v[88:89], v56 offset:16384
  v_xor_b32_e64 v5, v4, v26
  v_mfma_f32_16x16x32_bf16 v[20:23], v[180:183], a[216:219], v[20:23]
  ds_read_b64_tr_b16 v[90:91], v56 offset:18432
  buffer_load_dwordx4 a[36:39], v25, s[24:27], s90 offen offset:0 sc1
  v_mfma_f32_16x16x32_bf16 v[60:63], v[180:183], a[220:223], v[60:63]
  ds_read_b64_tr_b16 v[92:93], v56 offset:24576
  v_lshl_add_u32 v129, v5, 3, v2
  v_mfma_f32_16x16x32_bf16 v[60:63], v[176:179], a[212:215], v[60:63]
  ds_read_b64_tr_b16 v[94:95], v56 offset:26624
  v_add_u32_e64 v133, s66, v13
  v_mfma_f32_16x16x32_bf16 v[68:71], v[188:191], a[212:215], v[68:71]
  ds_read_b64_tr_b16 v[96:97], v57 offset:16384
  v_add_u32_e64 v134, s7, v133
  v_mfma_f32_16x16x32_bf16 v[68:71], v[192:195], a[220:223], v[68:71]
  ds_read_b64_tr_b16 v[98:99], v57 offset:18432
  buffer_load_dwordx4 a[40:43], v24, s[24:27], s90 offen offset:1024 sc1
  v_mfma_f32_16x16x32_bf16 v[64:67], v[192:195], a[216:219], v[64:67]
  ds_read_b64_tr_b16 v[100:101], v57 offset:24576
  v_xor_b32_e64 v130, 32, v129
  v_mfma_f32_16x16x32_bf16 v[64:67], v[188:191], a[208:211], v[64:67]
  ds_read_b64_tr_b16 v[102:103], v57 offset:26624
  s_waitcnt lgkmcnt(8)
  v_mfma_f32_16x16x32_bf16 v[72:75], v[196:199], a[208:211], v[72:75]
  ds_read_b64_tr_b16 v[104:105], v58 offset:16384
  v_xor_b32 v131, 64, v129
  v_mfma_f32_16x16x32_bf16 v[72:75], v[200:203], a[216:219], v[72:75]
  ds_read_b64_tr_b16 v[106:107], v58 offset:18432
  buffer_load_dwordx4 a[44:47], v25, s[24:27], s90 offen offset:1024 sc1
  v_mfma_f32_16x16x32_bf16 v[76:79], v[200:203], a[220:223], v[76:79]
  ds_read_b64_tr_b16 v[108:109], v58 offset:24576
  s_add_u32 s90, s90, 2048
  v_mfma_f32_16x16x32_bf16 v[76:79], v[196:199], a[212:215], v[76:79]
  ds_read_b64_tr_b16 v[110:111], v58 offset:26624
  s_and_b32 s90, s90, 16383
  v_mfma_f32_16x16x32_bf16 v[84:87], v[204:207], a[212:215], v[84:87]
  ds_read_b64_tr_b16 v[112:113], v59 offset:16384
  v_xor_b32 v132, 96, v129
  v_mfma_f32_16x16x32_bf16 v[84:87], v[208:211], a[220:223], v[84:87]
  ds_read_b64_tr_b16 v[114:115], v59 offset:18432
  buffer_load_dwordx4 a[48:51], v24, s[24:27], s90 offen offset:0 sc1
  v_mfma_f32_16x16x32_bf16 v[80:83], v[208:211], a[216:219], v[80:83]
  ds_read_b64_tr_b16 v[116:117], v59 offset:24576
  v_lshrrev_b32_e64 v2, 3, v1
  v_mfma_f32_16x16x32_bf16 v[80:83], v[204:207], a[208:211], v[80:83]
  ds_read_b64_tr_b16 v[118:119], v59 offset:26624
  s_waitcnt lgkmcnt(8)
  v_mfma_f32_16x16x32_bf16 v[20:23], v[88:91], a[224:227], v[20:23]
  ds_read_b64_tr_b16 v[176:177], v56 offset:32768
  v_and_b32 v4, 7, v1
  v_mfma_f32_16x16x32_bf16 v[20:23], v[92:95], a[232:235], v[20:23]
  ds_read_b64_tr_b16 v[178:179], v56 offset:34816
  buffer_load_dwordx4 a[52:55], v25, s[24:27], s90 offen offset:0 sc1
  v_mfma_f32_16x16x32_bf16 v[60:63], v[92:95], a[236:239], v[60:63]
  ds_read_b64_tr_b16 v[180:181], v56 offset:40960
  v_xor_b32_e64 v4, v4, v2
  v_mfma_f32_16x16x32_bf16 v[60:63], v[88:91], a[228:231], v[60:63]
  ds_read_b64_tr_b16 v[182:183], v56 offset:43008
  v_lshlrev_b32_e64 v4, 4, v4
  v_mfma_f32_16x16x32_bf16 v[68:71], v[96:99], a[228:231], v[68:71]
  ds_read_b64_tr_b16 v[188:189], v57 offset:32768
  v_lshl_add_u32 v126, v2, 12, v4
  v_mfma_f32_16x16x32_bf16 v[68:71], v[100:103], a[236:239], v[68:71]
  ds_read_b64_tr_b16 v[190:191], v57 offset:34816
  buffer_load_dwordx4 a[56:59], v24, s[24:27], s90 offen offset:1024 sc1
  v_mfma_f32_16x16x32_bf16 v[64:67], v[100:103], a[232:235], v[64:67]
  ds_read_b64_tr_b16 v[192:193], v57 offset:40960
  v_lshrrev_b32 v5, 5, v1
  v_mfma_f32_16x16x32_bf16 v[64:67], v[96:99], a[224:227], v[64:67]
  ds_read_b64_tr_b16 v[194:195], v57 offset:43008
  s_waitcnt lgkmcnt(8)
  v_mfma_f32_16x16x32_bf16 v[72:75], v[104:107], a[224:227], v[72:75]
  ds_read_b64_tr_b16 v[196:197], v58 offset:32768
  v_mul_u32_u24 v5, 1032192, v5
  v_mfma_f32_16x16x32_bf16 v[72:75], v[108:111], a[232:235], v[72:75]
  ds_read_b64_tr_b16 v[198:199], v58 offset:34816
  buffer_load_dwordx4 a[60:63], v25, s[24:27], s90 offen offset:1024 sc1
  v_mfma_f32_16x16x32_bf16 v[76:79], v[108:111], a[236:239], v[76:79]
  ds_read_b64_tr_b16 v[200:201], v58 offset:40960
  s_add_u32 s90, s90, 2048
  v_mfma_f32_16x16x32_bf16 v[76:79], v[104:107], a[228:231], v[76:79]
  ds_read_b64_tr_b16 v[202:203], v58 offset:43008
  s_and_b32 s90, s90, 16383
  v_mfma_f32_16x16x32_bf16 v[84:87], v[112:115], a[228:231], v[84:87]
  ds_read_b64_tr_b16 v[204:205], v59 offset:32768
  v_add_u32_e64 v125, v126, v5
  v_mfma_f32_16x16x32_bf16 v[84:87], v[116:119], a[236:239], v[84:87]
  ds_read_b64_tr_b16 v[206:207], v59 offset:34816
  buffer_load_dwordx4 a[64:67], v24, s[24:27], s90 offen offset:0 sc1
  v_mfma_f32_16x16x32_bf16 v[80:83], v[116:119], a[232:235], v[80:83]
  ds_read_b64_tr_b16 v[208:209], v59 offset:40960
  s_lshr_b32 s61, s57, 2
  v_mfma_f32_16x16x32_bf16 v[80:83], v[112:115], a[224:227], v[80:83]
  ds_read_b64_tr_b16 v[210:211], v59 offset:43008
  s_waitcnt vmcnt(18) lgkmcnt(8)
  v_mfma_f32_16x16x32_bf16 v[20:23], v[176:179], a[240:243], v[20:23]
  ds_read_b64_tr_b16 v[88:89], v56 offset:49152
  buffer_load_dword v27, v120, s[24:27], s85 offen sc1
  v_mfma_f32_16x16x32_bf16 v[20:23], v[180:183], a[248:251], v[20:23]
  ds_read_b64_tr_b16 v[90:91], v56 offset:51200
  s_lshl3_add_u32 s61, s61, s59
  v_mfma_f32_16x16x32_bf16 v[60:63], v[180:183], a[252:255], v[60:63]
  ds_read_b64_tr_b16 v[92:93], v56 offset:57344
  s_and_b32 s62, s57, 3
  v_mfma_f32_16x16x32_bf16 v[60:63], v[176:179], a[244:247], v[60:63]
  ds_read_b64_tr_b16 v[94:95], v56 offset:59392
  s_lshl4_add_u32 s61, s61, s62
  v_mfma_f32_16x16x32_bf16 v[68:71], v[188:191], a[244:247], v[68:71]
  ds_read_b64_tr_b16 v[96:97], v57 offset:49152
  buffer_load_dwordx4 a[68:71], v25, s[24:27], s90 offen offset:0 sc1
  v_mfma_f32_16x16x32_bf16 v[68:71], v[192:195], a[252:255], v[68:71]
  ds_read_b64_tr_b16 v[98:99], v57 offset:51200
  s_lshl_b32 s61, s61, 7
  v_mfma_f32_16x16x32_bf16 v[64:67], v[192:195], a[248:251], v[64:67]
  ds_read_b64_tr_b16 v[100:101], v57 offset:57344
  s_add_u32 s61, s61, s73
  v_mfma_f32_16x16x32_bf16 v[64:67], v[188:191], a[240:243], v[64:67]
  ds_read_b64_tr_b16 v[102:103], v57 offset:59392
  s_waitcnt lgkmcnt(8)
  v_mfma_f32_16x16x32_bf16 v[72:75], v[196:199], a[240:243], v[72:75]
  ds_read_b64_tr_b16 v[104:105], v58 offset:49152
  buffer_load_dwordx4 a[72:75], v24, s[24:27], s90 offen offset:1024 sc1
  v_mfma_f32_16x16x32_bf16 v[72:75], v[200:203], a[248:251], v[72:75]
  ds_read_b64_tr_b16 v[106:107], v58 offset:51200
  s_lshl_b32 s61, s61, L_z2-L_z1+7
  v_mfma_f32_16x16x32_bf16 v[76:79], v[200:203], a[252:255], v[76:79]
  ds_read_b64_tr_b16 v[108:109], v58 offset:57344
  s_add_u32 s87, s61, s54
  v_mfma_f32_16x16x32_bf16 v[76:79], v[196:199], a[244:247], v[76:79]
  ds_read_b64_tr_b16 v[110:111], v58 offset:59392
  s_lshl2_add_u32 s61, s68, s59
  v_mfma_f32_16x16x32_bf16 v[84:87], v[204:207], a[244:247], v[84:87]
  ds_read_b64_tr_b16 v[112:113], v59 offset:49152
  buffer_load_dwordx4 a[76:79], v25, s[24:27], s90 offen offset:1024 sc1
  v_mfma_f32_16x16x32_bf16 v[84:87], v[208:211], a[252:255], v[84:87]
  ds_read_b64_tr_b16 v[114:115], v59 offset:51200
  s_add_u32 s90, s90, s54
  v_mfma_f32_16x16x32_bf16 v[80:83], v[208:211], a[248:251], v[80:83]
  ds_read_b64_tr_b16 v[116:117], v59 offset:57344
  s_and_b32 s90, s90, s53
  v_mfma_f32_16x16x32_bf16 v[80:83], v[204:207], a[240:243], v[80:83]
  ds_read_b64_tr_b16 v[118:119], v59 offset:59392
  s_waitcnt vmcnt(18) lgkmcnt(8)
  v_mfma_f32_16x16x32_bf16 v[20:23], v[88:91], a[0:3], v[20:23]
  ds_read_b64_tr_b16 v[176:177], v52 offset:0
  buffer_load_dwordx4 a[80:83], v24, s[24:27], s90 offen offset:0 sc1
  v_mfma_f32_16x16x32_bf16 v[20:23], v[92:95], a[8:11], v[20:23]
  ds_read_b64_tr_b16 v[178:179], v52 offset:2048
  v_xor_b32 v56, s52, v56
  v_mfma_f32_16x16x32_bf16 v[60:63], v[92:95], a[12:15], v[60:63]
  ds_read_b64_tr_b16 v[180:181], v52 offset:8192
  v_xor_b32 v57, s52, v57
  v_mfma_f32_16x16x32_bf16 v[60:63], v[88:91], a[4:7], v[60:63]
  ds_read_b64_tr_b16 v[182:183], v52 offset:10240
  v_xor_b32 v58, s52, v58
  v_mfma_f32_16x16x32_bf16 v[68:71], v[96:99], a[4:7], v[68:71]
  ds_read_b64_tr_b16 v[188:189], v53 offset:0
  buffer_load_dwordx4 a[84:87], v25, s[24:27], s90 offen offset:0 sc1
  v_mfma_f32_16x16x32_bf16 v[68:71], v[100:103], a[12:15], v[68:71]
  ds_read_b64_tr_b16 v[190:191], v53 offset:2048
  v_xor_b32_e64 v59, s52, v59
  v_mfma_f32_16x16x32_bf16 v[64:67], v[100:103], a[8:11], v[64:67]
  ds_read_b64_tr_b16 v[192:193], v53 offset:8192
  s_lshl_b32 s61, s61, 17
  v_mfma_f32_16x16x32_bf16 v[64:67], v[96:99], a[0:3], v[64:67]
  ds_read_b64_tr_b16 v[194:195], v53 offset:10240
  s_waitcnt lgkmcnt(8)
  v_mfma_f32_16x16x32_bf16 v[72:75], v[104:107], a[0:3], v[72:75]
  ds_read_b64_tr_b16 v[196:197], v54 offset:0
  buffer_load_dwordx4 a[88:91], v24, s[24:27], s90 offen offset:1024 sc1
  v_mfma_f32_16x16x32_bf16 v[72:75], v[108:111], a[8:11], v[72:75]
  ds_read_b64_tr_b16 v[198:199], v54 offset:2048
  s_lshl_b32 s62, s69, 7
  v_mfma_f32_16x16x32_bf16 v[76:79], v[108:111], a[12:15], v[76:79]
  ds_read_b64_tr_b16 v[200:201], v54 offset:8192
  s_add_u32 s61, s61, s62
  v_mfma_f32_16x16x32_bf16 v[76:79], v[104:107], a[4:7], v[76:79]
  ds_read_b64_tr_b16 v[202:203], v54 offset:10240
  v_mfma_f32_16x16x32_bf16 v[84:87], v[112:115], a[4:7], v[84:87]
  ds_read_b64_tr_b16 v[204:205], v55 offset:0
  buffer_load_dwordx4 a[92:95], v25, s[24:27], s90 offen offset:1024 sc1
  v_mfma_f32_16x16x32_bf16 v[84:87], v[116:119], a[12:15], v[84:87]
  ds_read_b64_tr_b16 v[206:207], v55 offset:2048
  s_add_u32 s90, s90, 2048
  v_mfma_f32_16x16x32_bf16 v[80:83], v[116:119], a[8:11], v[80:83]
  ds_read_b64_tr_b16 v[208:209], v55 offset:8192
  s_and_b32 s90, s90, s53
  v_mfma_f32_16x16x32_bf16 v[80:83], v[112:115], a[0:3], v[80:83]
  ds_read_b64_tr_b16 v[210:211], v55 offset:10240
  s_waitcnt vmcnt(17) lgkmcnt(8)
  v_mfma_f32_16x16x32_bf16 v[20:23], v[176:179], a[16:19], v[20:23]
  ds_read_b64_tr_b16 v[88:89], v52 offset:16384
  s_waitcnt vmcnt(7)
  v_cmp_ne_u32 vcc, 0, v27
  v_mfma_f32_16x16x32_bf16 v[20:23], v[180:183], a[24:27], v[20:23]
  ds_read_b64_tr_b16 v[90:91], v52 offset:18432
  s_cbranch_vccnz L_fy_retry
L_fy_ok:
  v_mfma_f32_16x16x32_bf16 v[60:63], v[180:183], a[28:31], v[60:63]
  ds_read_b64_tr_b16 v[92:93], v52 offset:24576
  s_add_u32 m0, s66, s7
  v_mfma_f32_16x16x32_bf16 v[60:63], v[176:179], a[20:23], v[60:63]
  ds_read_b64_tr_b16 v[94:95], v52 offset:26624
  buffer_load_dwordx4 v121, s[24:27], s86 offen offset:0 sc1 lds
  v_mfma_f32_16x16x32_bf16 v[68:71], v[188:191], a[20:23], v[68:71]
  ds_read_b64_tr_b16 v[96:97], v53 offset:16384
  s_add_u32 s86, s86, 15360
  v_mfma_f32_16x16x32_bf16 v[68:71], v[192:195], a[28:31], v[68:71]
  ds_read_b64_tr_b16 v[98:99], v53 offset:18432
  v_mfma_f32_16x16x32_bf16 v[64:67], v[192:195], a[24:27], v[64:67]
  ds_read_b64_tr_b16 v[100:101], v53 offset:24576
  v_mfma_f32_16x16x32_bf16 v[64:67], v[188:191], a[16:19], v[64:67]
  ds_read_b64_tr_b16 v[102:103], v53 offset:26624
  s_waitcnt lgkmcnt(8)
  v_mfma_f32_16x16x32_bf16 v[72:75], v[196:199], a[16:19], v[72:75]
  ds_read_b64_tr_b16 v[104:105], v54 offset:16384
  buffer_load_dwordx4 v121, s[24:27], s86 offen offset:1024 sc1 lds
  s_nop 0
  v_mfma_f32_16x16x32_bf16 v[72:75], v[200:203], a[24:27], v[72:75]
  ds_read_b64_tr_b16 v[106:107], v54 offset:18432
  s_add_u32 s86, s86, 15360
  v_mfma_f32_16x16x32_bf16 v[76:79], v[200:203], a[28:31], v[76:79]
  ds_read_b64_tr_b16 v[108:109], v54 offset:24576
  v_mfma_f32_16x16x32_bf16 v[76:79], v[196:199], a[20:23], v[76:79]
  ds_read_b64_tr_b16 v[110:111], v54 offset:26624
  v_mfma_f32_16x16x32_bf16 v[84:87], v[204:207], a[20:23], v[84:87]
  ds_read_b64_tr_b16 v[112:113], v55 offset:16384
  buffer_load_dwordx4 v122, s[24:27], s86 offen offset:2048 sc1 lds
  v_mfma_f32_16x16x32_bf16 v[84:87], v[208:211], a[28:31], v[84:87]
  ds_read_b64_tr_b16 v[114:115], v55 offset:18432
  s_add_u32 s86, s86, 15360
  v_mfma_f32_16x16x32_bf16 v[80:83], v[208:211], a[24:27], v[80:83]
  ds_read_b64_tr_b16 v[116:117], v55 offset:24576
  v_mfma_f32_16x16x32_bf16 v[80:83], v[204:207], a[16:19], v[80:83]
  ds_read_b64_tr_b16 v[118:119], v55 offset:26624
  s_waitcnt lgkmcnt(8)
  s_nop 0
  v_mfma_f32_16x16x32_bf16 v[20:23], v[88:91], a[32:35], v[20:23]
  ds_read_b64_tr_b16 v[176:177], v52 offset:32768
  buffer_load_dwordx4 v122, s[24:27], s86 offen offset:3072 sc1 lds
  v_mfma_f32_16x16x32_bf16 v[20:23], v[92:95], a[40:43], v[20:23]
  ds_read_b64_tr_b16 v[178:179], v52 offset:34816
  v_mfma_f32_16x16x32_bf16 v[60:63], v[92:95], a[44:47], v[60:63]
  ds_read_b64_tr_b16 v[180:181], v52 offset:40960
  v_mfma_f32_16x16x32_bf16 v[60:63], v[88:91], a[36:39], v[60:63]
  ds_read_b64_tr_b16 v[182:183], v52 offset:43008
  v_mfma_f32_16x16x32_bf16 v[68:71], v[96:99], a[36:39], v[68:71]
  ds_read_b64_tr_b16 v[188:189], v53 offset:32768
  buffer_load_dwordx4 a[96:99], v24, s[24:27], s90 offen offset:0 sc1
  v_mfma_f32_16x16x32_bf16 v[68:71], v[100:103], a[44:47], v[68:71]
  ds_read_b64_tr_b16 v[190:191], v53 offset:34816
  v_mfma_f32_16x16x32_bf16 v[64:67], v[100:103], a[40:43], v[64:67]
  ds_read_b64_tr_b16 v[192:193], v53 offset:40960
  v_mfma_f32_16x16x32_bf16 v[64:67], v[96:99], a[32:35], v[64:67]
  ds_read_b64_tr_b16 v[194:195], v53 offset:43008
  s_waitcnt lgkmcnt(8)
  v_mfma_f32_16x16x32_bf16 v[72:75], v[104:107], a[32:35], v[72:75]
  ds_read_b64_tr_b16 v[196:197], v54 offset:32768
  buffer_load_dwordx4 a[100:103], v25, s[24:27], s90 offen offset:0 sc1
  v_mfma_f32_16x16x32_bf16 v[72:75], v[108:111], a[40:43], v[72:75]
  ds_read_b64_tr_b16 v[198:199], v54 offset:34816
  v_mfma_f32_16x16x32_bf16 v[76:79], v[108:111], a[44:47], v[76:79]
  ds_read_b64_tr_b16 v[200:201], v54 offset:40960
  v_mfma_f32_16x16x32_bf16 v[76:79], v[104:107], a[36:39], v[76:79]
  ds_read_b64_tr_b16 v[202:203], v54 offset:43008
  v_mfma_f32_16x16x32_bf16 v[84:87], v[112:115], a[36:39], v[84:87]
  ds_read_b64_tr_b16 v[204:205], v55 offset:32768
  buffer_load_dwordx4 a[104:107], v24, s[24:27], s90 offen offset:1024 sc1
  v_mfma_f32_16x16x32_bf16 v[84:87], v[116:119], a[44:47], v[84:87]
  ds_read_b64_tr_b16 v[206:207], v55 offset:34816
  v_mfma_f32_16x16x32_bf16 v[80:83], v[116:119], a[40:43], v[80:83]
  ds_read_b64_tr_b16 v[208:209], v55 offset:40960
  v_mfma_f32_16x16x32_bf16 v[80:83], v[112:115], a[32:35], v[80:83]
  ds_read_b64_tr_b16 v[210:211], v55 offset:43008
  s_waitcnt lgkmcnt(8)
  v_mfma_f32_16x16x32_bf16 v[20:23], v[176:179], a[48:51], v[20:23]
  ds_read_b64_tr_b16 v[88:89], v52 offset:49152
  buffer_load_dwordx4 a[108:111], v25, s[24:27], s90 offen offset:1024 sc1
  v_mfma_f32_16x16x32_bf16 v[20:23], v[180:183], a[56:59], v[20:23]
  ds_read_b64_tr_b16 v[90:91], v52 offset:51200
  s_add_u32 s90, s90, s54
  v_mfma_f32_16x16x32_bf16 v[60:63], v[180:183], a[60:63], v[60:63]
  ds_read_b64_tr_b16 v[92:93], v52 offset:57344
  s_and_b32 s90, s90, s53
  v_mfma_f32_16x16x32_bf16 v[60:63], v[176:179], a[52:55], v[60:63]
  ds_read_b64_tr_b16 v[94:95], v52 offset:59392
  v_mfma_f32_16x16x32_bf16 v[68:71], v[188:191], a[52:55], v[68:71]
  ds_read_b64_tr_b16 v[96:97], v53 offset:49152
  buffer_load_dwordx4 a[112:115], v24, s[24:27], s90 offen offset:0 sc1
  v_mfma_f32_16x16x32_bf16 v[68:71], v[192:195], a[60:63], v[68:71]
  ds_read_b64_tr_b16 v[98:99], v53 offset:51200
  v_mfma_f32_16x16x32_bf16 v[64:67], v[192:195], a[56:59], v[64:67]
  ds_read_b64_tr_b16 v[100:101], v53 offset:57344
  v_mfma_f32_16x16x32_bf16 v[64:67], v[188:191], a[48:51], v[64:67]
  ds_read_b64_tr_b16 v[102:103], v53 offset:59392
  s_waitcnt lgkmcnt(8)
  v_mfma_f32_16x16x32_bf16 v[72:75], v[196:199], a[48:51], v[72:75]
  s_nop 0
  ds_read_b64_tr_b16 v[104:105], v54 offset:49152
  buffer_load_dwordx4 a[116:119], v25, s[24:27], s90 offen offset:0 sc1
  v_mfma_f32_16x16x32_bf16 v[72:75], v[200:203], a[56:59], v[72:75]
  ds_read_b64_tr_b16 v[106:107], v54 offset:51200
  v_mfma_f32_16x16x32_bf16 v[76:79], v[200:203], a[60:63], v[76:79]
  ds_read_b64_tr_b16 v[108:109], v54 offset:57344
  v_mfma_f32_16x16x32_bf16 v[76:79], v[196:199], a[52:55], v[76:79]
  ds_read_b64_tr_b16 v[110:111], v54 offset:59392
  v_mfma_f32_16x16x32_bf16 v[84:87], v[204:207], a[52:55], v[84:87]
  ds_read_b64_tr_b16 v[112:113], v55 offset:49152
  buffer_load_dwordx4 a[120:123], v24, s[24:27], s90 offen offset:1024 sc1
  v_mfma_f32_16x16x32_bf16 v[84:87], v[208:211], a[60:63], v[84:87]
  ds_read_b64_tr_b16 v[114:115], v55 offset:51200
  v_mfma_f32_16x16x32_bf16 v[80:83], v[208:211], a[56:59], v[80:83]
  ds_read_b64_tr_b16 v[116:117], v55 offset:57344
  v_mfma_f32_16x16x32_bf16 v[80:83], v[204:207], a[48:51], v[80:83]
  ds_read_b64_tr_b16 v[118:119], v55 offset:59392
  s_waitcnt vmcnt(15) lgkmcnt(8)
  v_mfma_f32_16x16x32_bf16 v[20:23], v[88:91], a[64:67], v[20:23]
  ds_read_b64_tr_b16 v[176:177], v56 offset:0
  buffer_load_dwordx4 a[124:127], v25, s[24:27], s90 offen offset:1024 sc1
  v_mfma_f32_16x16x32_bf16 v[20:23], v[92:95], a[72:75], v[20:23]
  ds_read_b64_tr_b16 v[178:179], v56 offset:2048
  s_add_u32 s90, s90, s54
  v_mfma_f32_16x16x32_bf16 v[60:63], v[92:95], a[76:79], v[60:63]
  ds_read_b64_tr_b16 v[180:181], v56 offset:8192
  s_and_b32 s90, s90, 16383
  v_mfma_f32_16x16x32_bf16 v[60:63], v[88:91], a[68:71], v[60:63]
  ds_read_b64_tr_b16 v[182:183], v56 offset:10240
  v_mfma_f32_16x16x32_bf16 v[68:71], v[96:99], a[68:71], v[68:71]
  ds_read_b64_tr_b16 v[188:189], v57 offset:0
  buffer_load_dwordx4 a[128:131], v24, s[24:27], s90 offen offset:0 sc1
  v_mfma_f32_16x16x32_bf16 v[68:71], v[100:103], a[76:79], v[68:71]
  ds_read_b64_tr_b16 v[190:191], v57 offset:2048
  v_mfma_f32_16x16x32_bf16 v[64:67], v[100:103], a[72:75], v[64:67]
  ds_read_b64_tr_b16 v[192:193], v57 offset:8192
  v_mfma_f32_16x16x32_bf16 v[64:67], v[96:99], a[64:67], v[64:67]
  ds_read_b64_tr_b16 v[194:195], v57 offset:10240
  s_waitcnt vmcnt(9) lgkmcnt(8)
  s_barrier
  v_mfma_f32_16x16x32_bf16 v[72:75], v[104:107], a[64:67], v[72:75]
  ds_read_b64_tr_b16 v[196:197], v58 offset:0
  buffer_load_dwordx4 a[132:135], v25, s[24:27], s90 offen offset:0 sc1
  v_mfma_f32_16x16x32_bf16 v[72:75], v[108:111], a[72:75], v[72:75]
  ds_read_b64_tr_b16 v[198:199], v58 offset:2048
  ds_read_b64_tr_b16 v[136:137], v123 offset:0
  v_mfma_f32_16x16x32_bf16 v[76:79], v[108:111], a[76:79], v[76:79]
  ds_read_b64_tr_b16 v[200:201], v58 offset:8192
  ds_read_b64_tr_b16 v[138:139], v123 offset:1024
  v_mfma_f32_16x16x32_bf16 v[76:79], v[104:107], a[68:71], v[76:79]
  ds_read_b64_tr_b16 v[202:203], v58 offset:10240
  ds_read_b64_tr_b16 v[140:141], v123 offset:8192
  v_mfma_f32_16x16x32_bf16 v[84:87], v[112:115], a[68:71], v[84:87]
  ds_read_b64_tr_b16 v[204:205], v59 offset:0
  buffer_load_dwordx4 a[136:139], v24, s[24:27], s90 offen offset:1024 sc1
  v_mfma_f32_16x16x32_bf16 v[84:87], v[116:119], a[76:79], v[84:87]
  ds_read_b64_tr_b16 v[206:207], v59 offset:2048
  ds_read_b64_tr_b16 v[142:143], v123 offset:9216
  v_mfma_f32_16x16x32_bf16 v[80:83], v[116:119], a[72:75], v[80:83]
  ds_read_b64_tr_b16 v[208:209], v59 offset:8192
  ds_read_b64_tr_b16 v[144:145], v124 offset:0
  v_mfma_f32_16x16x32_bf16 v[80:83], v[112:115], a[64:67], v[80:83]
  ds_read_b64_tr_b16 v[210:211], v59 offset:10240
  ds_read_b64_tr_b16 v[146:147], v124 offset:1024
  ds_read_b64_tr_b16 v[148:149], v124 offset:8192
  ds_read_b64_tr_b16 v[150:151], v124 offset:9216
  s_waitcnt lgkmcnt(0)
  s_barrier
  v_mfma_f32_16x16x32_bf16 v[20:23], v[176:179], a[80:83], v[20:23]
  ds_read_b64_tr_b16 v[88:89], v56 offset:16384
  buffer_load_dwordx4 a[140:143], v25, s[24:27], s90 offen offset:1024 sc1
  v_mfma_f32_16x16x32_bf16 v[20:23], v[180:183], a[88:91], v[20:23]
  ds_read_b64_tr_b16 v[90:91], v56 offset:18432
  ds_write_b128 v127, v[136:139] offset:0
  v_mfma_f32_16x16x32_bf16 v[60:63], v[180:183], a[92:95], v[60:63]
  ds_read_b64_tr_b16 v[92:93], v56 offset:24576
  ds_write_b128 v128, v[140:143] offset:0
  v_mfma_f32_16x16x32_bf16 v[60:63], v[176:179], a[84:87], v[60:63]
  ds_read_b64_tr_b16 v[94:95], v56 offset:26624
  ds_write_b128 v127, v[144:147] offset:2048
  v_mfma_f32_16x16x32_bf16 v[68:71], v[188:191], a[84:87], v[68:71]
  ds_read_b64_tr_b16 v[96:97], v57 offset:16384
  ds_write_b128 v128, v[148:151] offset:2048
  v_mfma_f32_16x16x32_bf16 v[68:71], v[192:195], a[92:95], v[68:71]
  ds_read_b64_tr_b16 v[98:99], v57 offset:18432
  ds_read_b128 v[136:139], v134 offset:0
  v_mfma_f32_16x16x32_bf16 v[64:67], v[192:195], a[88:91], v[64:67]
  ds_read_b64_tr_b16 v[100:101], v57 offset:24576
  ds_read_b128 v[140:143], v134 offset:1024
  v_mfma_f32_16x16x32_bf16 v[64:67], v[188:191], a[80:83], v[64:67]
  ds_read_b64_tr_b16 v[102:103], v57 offset:26624
  ds_read_b128 v[144:147], v134 offset:2048
  ds_read_b128 v[148:151], v134 offset:3072
  v_mfma_f32_16x16x32_bf16 v[72:75], v[196:199], a[80:83], v[72:75]
  ds_read_b64_tr_b16 v[104:105], v58 offset:16384
  s_waitcnt lgkmcnt(6)
  buffer_store_dwordx4 v[136:139], v125, s[20:23], s87 offen sc1
  v_mfma_f32_16x16x32_bf16 v[72:75], v[200:203], a[88:91], v[72:75]
  ds_read_b64_tr_b16 v[106:107], v58 offset:18432
  s_add_u32 s87, s87, s55
  v_mfma_f32_16x16x32_bf16 v[76:79], v[200:203], a[92:95], v[76:79]
  ds_read_b64_tr_b16 v[108:109], v58 offset:24576
  v_mfma_f32_16x16x32_bf16 v[76:79], v[196:199], a[84:87], v[76:79]
  ds_read_b64_tr_b16 v[110:111], v58 offset:26624
  v_mfma_f32_16x16x32_bf16 v[84:87], v[204:207], a[84:87], v[84:87]
  ds_read_b64_tr_b16 v[112:113], v59 offset:16384
  v_mfma_f32_16x16x32_bf16 v[84:87], v[208:211], a[92:95], v[84:87]
  ds_read_b64_tr_b16 v[114:115], v59 offset:18432
  v_mfma_f32_16x16x32_bf16 v[80:83], v[208:211], a[88:91], v[80:83]
  ds_read_b64_tr_b16 v[116:117], v59 offset:24576
  v_mfma_f32_16x16x32_bf16 v[80:83], v[204:207], a[80:83], v[80:83]
  ds_read_b64_tr_b16 v[118:119], v59 offset:26624
  s_waitcnt vmcnt(9) lgkmcnt(10)
  v_mfma_f32_16x16x32_bf16 v[20:23], v[88:91], a[96:99], v[20:23]
  ds_read_b64_tr_b16 v[176:177], v56 offset:32768
  buffer_store_dwordx4 v[140:143], v125, s[20:23], s87 offen sc1
  v_mfma_f32_16x16x32_bf16 v[20:23], v[92:95], a[104:107], v[20:23]
  ds_read_b64_tr_b16 v[178:179], v56 offset:34816
  s_add_u32 s87, s87, 65536
  v_mfma_f32_16x16x32_bf16 v[60:63], v[92:95], a[108:111], v[60:63]
  ds_read_b64_tr_b16 v[180:181], v56 offset:40960
  v_mfma_f32_16x16x32_bf16 v[60:63], v[88:91], a[100:103], v[60:63]
  ds_read_b64_tr_b16 v[182:183], v56 offset:43008
  v_mfma_f32_16x16x32_bf16 v[68:71], v[96:99], a[100:103], v[68:71]
  ds_read_b64_tr_b16 v[188:189], v57 offset:32768
  v_mfma_f32_16x16x32_bf16 v[68:71], v[100:103], a[108:111], v[68:71]
  ds_read_b64_tr_b16 v[190:191], v57 offset:34816
  v_mfma_f32_16x16x32_bf16 v[64:67], v[100:103], a[104:107], v[64:67]
  ds_read_b64_tr_b16 v[192:193], v57 offset:40960
  v_mfma_f32_16x16x32_bf16 v[64:67], v[96:99], a[96:99], v[64:67]
  ds_read_b64_tr_b16 v[194:195], v57 offset:43008
  s_waitcnt lgkmcnt(8)
  v_mfma_f32_16x16x32_bf16 v[72:75], v[104:107], a[96:99], v[72:75]
  ds_read_b64_tr_b16 v[196:197], v58 offset:32768
  buffer_store_dwordx4 v[144:147], v125, s[20:23], s87 offen sc1
  v_mfma_f32_16x16x32_bf16 v[72:75], v[108:111], a[104:107], v[72:75]
  ds_read_b64_tr_b16 v[198:199], v58 offset:34816
  s_add_u32 s87, s87, s55
  v_mfma_f32_16x16x32_bf16 v[76:79], v[108:111], a[108:111], v[76:79]
  ds_read_b64_tr_b16 v[200:201], v58 offset:40960
  v_mfma_f32_16x16x32_bf16 v[76:79], v[104:107], a[100:103], v[76:79]
  ds_read_b64_tr_b16 v[202:203], v58 offset:43008
  v_mfma_f32_16x16x32_bf16 v[84:87], v[112:115], a[100:103], v[84:87]
  ds_read_b64_tr_b16 v[204:205], v59 offset:32768
  v_mfma_f32_16x16x32_bf16 v[84:87], v[116:119], a[108:111], v[84:87]
  ds_read_b64_tr_b16 v[206:207], v59 offset:34816
  v_mfma_f32_16x16x32_bf16 v[80:83], v[116:119], a[104:107], v[80:83]
  ds_read_b64_tr_b16 v[208:209], v59 offset:40960
  v_mfma_f32_16x16x32_bf16 v[80:83], v[112:115], a[96:99], v[80:83]
  ds_read_b64_tr_b16 v[210:211], v59 offset:43008
  s_waitcnt vmcnt(7) lgkmcnt(8)
  v_mfma_f32_16x16x32_bf16 v[20:23], v[176:179], a[112:115], v[20:23]
  ds_read_b64_tr_b16 v[88:89], v56 offset:49152
  buffer_store_dwordx4 v[148:151], v125, s[20:23], s87 offen sc1
  v_mfma_f32_16x16x32_bf16 v[20:23], v[180:183], a[120:123], v[20:23]
  ds_read_b64_tr_b16 v[90:91], v56 offset:51200
  v_mfma_f32_16x16x32_bf16 v[60:63], v[180:183], a[124:127], v[60:63]
  ds_read_b64_tr_b16 v[92:93], v56 offset:57344
  v_mfma_f32_16x16x32_bf16 v[60:63], v[176:179], a[116:119], v[60:63]
  ds_read_b64_tr_b16 v[94:95], v56 offset:59392
  v_mfma_f32_16x16x32_bf16 v[68:71], v[188:191], a[116:119], v[68:71]
  ds_read_b64_tr_b16 v[96:97], v57 offset:49152
  v_mfma_f32_16x16x32_bf16 v[68:71], v[192:195], a[124:127], v[68:71]
  ds_read_b64_tr_b16 v[98:99], v57 offset:51200
  v_mfma_f32_16x16x32_bf16 v[64:67], v[192:195], a[120:123], v[64:67]
  ds_read_b64_tr_b16 v[100:101], v57 offset:57344
  v_mfma_f32_16x16x32_bf16 v[64:67], v[188:191], a[112:115], v[64:67]
  ds_read_b64_tr_b16 v[102:103], v57 offset:59392
  s_waitcnt lgkmcnt(8)
  v_mfma_f32_16x16x32_bf16 v[72:75], v[196:199], a[112:115], v[72:75]
  ds_read_b64_tr_b16 v[104:105], v58 offset:49152
  v_mfma_f32_16x16x32_bf16 v[72:75], v[200:203], a[120:123], v[72:75]
  ds_read_b64_tr_b16 v[106:107], v58 offset:51200
  v_mfma_f32_16x16x32_bf16 v[76:79], v[200:203], a[124:127], v[76:79]
  ds_read_b64_tr_b16 v[108:109], v58 offset:57344
  v_mfma_f32_16x16x32_bf16 v[76:79], v[196:199], a[116:119], v[76:79]
  ds_read_b64_tr_b16 v[110:111], v58 offset:59392
  v_mfma_f32_16x16x32_bf16 v[84:87], v[204:207], a[116:119], v[84:87]
  ds_read_b64_tr_b16 v[112:113], v59 offset:49152
  v_mfma_f32_16x16x32_bf16 v[84:87], v[208:211], a[124:127], v[84:87]
  ds_read_b64_tr_b16 v[114:115], v59 offset:51200
  v_mfma_f32_16x16x32_bf16 v[80:83], v[208:211], a[120:123], v[80:83]
  ds_read_b64_tr_b16 v[116:117], v59 offset:57344
  v_mfma_f32_16x16x32_bf16 v[80:83], v[204:207], a[112:115], v[80:83]
  ds_read_b64_tr_b16 v[118:119], v59 offset:59392
  s_waitcnt vmcnt(4) lgkmcnt(8)
  v_mfma_f32_16x16x32_bf16 v[20:23], v[88:91], a[128:131], v[20:23]
  v_mfma_f32_16x16x32_bf16 v[20:23], v[92:95], a[136:139], v[20:23]
  v_mfma_f32_16x16x32_bf16 v[64:67], v[100:103], a[136:139], v[64:67]
  v_mfma_f32_16x16x32_bf16 v[64:67], v[96:99], a[128:131], v[64:67]
  s_waitcnt lgkmcnt(6)
  s_nop 0
  v_mfma_f32_16x16x32_bf16 v[72:75], v[104:107], a[128:131], v[72:75]
  s_waitcnt lgkmcnt(4)
  v_mfma_f32_16x16x32_bf16 v[72:75], v[108:111], a[136:139], v[72:75]
  s_waitcnt lgkmcnt(0)
  v_mfma_f32_16x16x32_bf16 v[80:83], v[116:119], a[136:139], v[80:83]
  v_mfma_f32_16x16x32_bf16 v[80:83], v[112:115], a[128:131], v[80:83]
  v_mfma_f32_16x16x32_bf16 v[60:63], v[92:95], a[140:143], v[60:63]
  v_mfma_f32_16x16x32_bf16 v[60:63], v[88:91], a[132:135], v[60:63]
  v_cvt_pk_bf16_f32 v176, v20, v21
  v_cvt_pk_bf16_f32 v177, v22, v23
  v_mfma_f32_16x16x32_bf16 v[68:71], v[96:99], a[132:135], v[68:71]
  v_cvt_pk_bf16_f32 v188, v64, v65
  v_cvt_pk_bf16_f32 v189, v66, v67
  v_mfma_f32_16x16x32_bf16 v[68:71], v[100:103], a[140:143], v[68:71]
  v_cvt_pk_bf16_f32 v196, v72, v73
  v_cvt_pk_bf16_f32 v197, v74, v75
  v_mfma_f32_16x16x32_bf16 v[76:79], v[108:111], a[140:143], v[76:79]
  v_cvt_pk_bf16_f32 v204, v80, v81
  v_cvt_pk_bf16_f32 v205, v82, v83
  v_mfma_f32_16x16x32_bf16 v[76:79], v[104:107], a[132:135], v[76:79]
  ds_write_b64 v129, v[176:177] offset:16384
  v_mfma_f32_16x16x32_bf16 v[84:87], v[112:115], a[132:135], v[84:87]
  ds_write_b64 v130, v[188:189] offset:16384
  v_mfma_f32_16x16x32_bf16 v[84:87], v[116:119], a[140:143], v[84:87]
  ds_write_b64 v131, v[196:197] offset:16384
  ds_write_b64 v132, v[204:205] offset:16384
  ds_read_b128 v[180:183], v133 offset:16384
  ds_read_b128 v[192:195], v133 offset:17408
  v_cvt_pk_bf16_f32 v178, v60, v61
  v_cvt_pk_bf16_f32 v179, v62, v63
  v_cvt_pk_bf16_f32 v190, v68, v69
  v_cvt_pk_bf16_f32 v191, v70, v71
  v_cvt_pk_bf16_f32 v198, v76, v77
  v_cvt_pk_bf16_f32 v199, v78, v79
  v_cvt_pk_bf16_f32 v206, v84, v85
  v_cvt_pk_bf16_f32 v207, v86, v87
  ds_write_b64 v129, v[178:179] offset:18432
  ds_write_b64 v130, v[190:191] offset:18432
  s_waitcnt lgkmcnt(3)
  buffer_store_dwordx4 v[180:183], v126, s[20:23], s61 offen sc1
  s_add_u32 s61, s61, s50
  ds_write_b64 v131, v[198:199] offset:18432
  s_waitcnt lgkmcnt(3)
  buffer_store_dwordx4 v[192:195], v126, s[20:23], s61 offen sc1
  ds_write_b64 v132, v[206:207] offset:18432
  ds_read_b128 v[200:203], v133 offset:18432
  s_add_u32 s61, s61, s50
  ds_read_b128 v[208:211], v133 offset:19456
  s_waitcnt lgkmcnt(1)
  buffer_store_dwordx4 v[200:203], v126, s[20:23], s61 offen sc1
  s_add_u32 s61, s61, 32768
  s_waitcnt lgkmcnt(0)
  buffer_store_dwordx4 v[208:211], v126, s[20:23], s61 offen sc1
L_end:
  s_endpgm
L_ci_retry:
  s_mov_b32 s70, 0
L_ci_loop:
  s_nop 7
  v_cmp_gt_u32 vcc, 64, v12
  s_nop 0
  s_cbranch_vccz L_ci_full
  s_mov_b64 exec, vcc
  s_sleep 1
  v_and_b32 v12, 3, v1
  v_lshlrev_b32 v12, 6, v12
  global_load_dword v12, v12, s[44:45] sc1
  s_waitcnt vmcnt(0)
  s_mov_b64 exec, -1
  s_add_u32 s70, s70, 1
  s_cmp_lt_u32 s70, 0x80000
  s_cbranch_scc1 L_ci_loop
L_ci_full:
  s_nop 7
  s_branch L_ci_ok
L_h1_retry:
  s_mov_b32 s70, 0
L_h1_loop:
  s_nop 7
  v_cmp_eq_u32 vcc, -1, v152
  s_nop 0
  s_cbranch_vccz L_h1_full
  s_mov_b64 exec, vcc
  s_sleep 1
  buffer_load_dword v152, v47, s[24:27], s91 offen sc1
  s_waitcnt vmcnt(0)
  s_mov_b64 exec, -1
  s_add_u32 s70, s70, 1
  s_cmp_lt_u32 s70, 0x80000
  s_cbranch_scc1 L_h1_loop
L_h1_full:
  s_nop 7
  s_branch L_h1_ok
L_a2_retry:
  s_mov_b32 s70, 0
L_a2_loop:
  s_nop 7
  v_cmp_eq_u32 vcc, -1, v136
  s_nop 0
  s_cbranch_vccz L_a2_full
  s_mov_b64 exec, vcc
  s_sleep 1
  buffer_load_dword v136, v226, s[24:27], s90 offen sc1
  s_waitcnt vmcnt(0)
  s_mov_b64 exec, -1
  s_add_u32 s70, s70, 1
  s_cmp_lt_u32 s70, 0x80000
  s_cbranch_scc1 L_a2_loop
L_a2_full:
  buffer_load_dwordx4 v[128:131], v13, s[24:27], s89 offen sc1
  buffer_load_dwordx4 v[132:135], v13, s[24:27], s89 offen offset:1024 sc1
  buffer_load_dwordx4 v[136:139], v226, s[24:27], s90 offen sc1
  s_waitcnt vmcnt(0)
  v_max3_u32 v44, v136, v137, v138
  v_max3_u32 v45, v131, v132, v133
  v_max3_u32 v44, v44, v134, v135
  v_max3_u32 v45, v45, v128, v129
  v_max3_u32 v44, v44, v130, v139
  v_max_u32 v44, v44, v45
  v_cmp_eq_u32 vcc, -1, v44
  s_nop 0
  s_cbranch_vccz L_a2_done
  s_sleep 1
  s_add_u32 s70, s70, 1
  s_cmp_lt_u32 s70, 0x80000
  s_cbranch_scc1 L_a2_full
L_a2_done:
  s_nop 7
  s_branch L_a2_ok
L_fc_retry:
  s_mov_b32 s70, 0
L_fc_loop:
  s_nop 7
  v_cmp_ne_u32 vcc, 0, v12
  s_nop 0
  s_cbranch_vccz L_fc_full
  s_mov_b64 exec, vcc
  s_sleep 1
  buffer_load_dword v12, v14, s[24:27], s89 offen sc1
  s_waitcnt vmcnt(0)
  s_mov_b64 exec, -1
  s_add_u32 s70, s70, 1
  s_cmp_lt_u32 s70, 0x80000
  s_cbranch_scc1 L_fc_loop
L_fc_full:
  s_nop 7
  s_branch L_fc_ok
L_fb_retry:
  s_mov_b32 s70, 0
L_fb_loop:
  s_nop 7
  v_cmp_ne_u32 vcc, 0, v12
  s_nop 0
  s_cbranch_vccz L_fb_full
  s_mov_b64 exec, vcc
  s_sleep 1
  buffer_load_dword v12, v14, s[24:27], s89 offen sc1
  s_waitcnt vmcnt(0)
  s_mov_b64 exec, -1
  s_add_u32 s70, s70, 1
  s_cmp_lt_u32 s70, 0x80000
  s_cbranch_scc1 L_fb_loop
L_fb_full:
  s_nop 7
  s_branch L_fb_ok
L_fy_retry:
  s_mov_b32 s70, 0
L_fy_loop:
  s_nop 7
  v_cmp_ne_u32 vcc, 0, v27
  s_nop 0
  s_cbranch_vccz L_fy_full
  s_mov_b64 exec, vcc
  s_sleep 1
  buffer_load_dword v27, v120, s[24:27], s85 offen sc1
  s_waitcnt vmcnt(0)
  s_mov_b64 exec, -1
  s_add_u32 s70, s70, 1
  s_cmp_lt_u32 s70, 0x80000
  s_cbranch_scc1 L_fy_loop
L_fy_full:
  s_nop 7
  s_branch L_fy_ok
.p2align 8
L_tab:
.long 0x0,0x0,0x0,0x0,0x0,0x0,0x0,0x0
.long 0x0,0x0,0x0,0x0,0x0,0x0,0x0,0x0
.long 0x0,0x0,0x0,0x0,0x0,0x0,0x0,0x0
.long 0x0,0x0,0x0,0x0,0x0,0x0,0x0,0x0
.long 0x0,0x0,0x0,0x0,0x0,0x0,0x0,0x0
.long 0x0,0x0,0x0,0x0,0x0,0x0,0x0,0x0
.long 0x0,0x0,0x0,0x0,0x0,0x0,0x0,0x0
.long 0x0,0x0,0x0,0x0,0x0,0x0,0x0,0x0
.long 0x0,0x3f800000,0x3f803f80,0x0,0x0,0x0,0x3f803f80,0x3f80
.long 0x0,0x0,0x3f800000,0x3f803f80,0x0,0x0,0x0,0x3f803f80
.long 0x0,0x0,0x0,0x3f800000,0x0,0x0,0x0,0x0
.long 0x0,0x0,0x0,0x0,0x0,0x0,0x0,0x0
.long 0x0,0x0,0x0,0x0,0x0,0x0,0x0,0x0
.long 0x0,0x0,0x0,0x0,0x0,0x0,0x0,0x0
.long 0x0,0x0,0x0,0x0,0x0,0x0,0x0,0x0
.long 0x0,0x0,0x0,0x0,0x0,0x0,0x0,0x0
.long 0x0,0x0,0x0,0x0,0x0,0x0,0x0,0x0
.long 0x0,0x0,0x0,0x0,0x3f80,0x0,0x0,0x0
.long 0x3f803f80,0x0,0x0,0x0,0x3f803f80,0x3f80,0x0,0x0
.long 0x3f800000,0x3f803f80,0x0,0x0,0x0,0x3f803f80,0x3f80,0x0
.long 0x0,0x3f800000,0x3f803f80,0x0,0x0,0x0,0x3f803f80,0x3f80
.long 0x0,0x0,0x3f800000,0x3f803f80,0x0,0x0,0x0,0x3f803f80
.long 0x0,0x0,0x0,0x3f800000,0x0,0x0,0x0,0x0
.long 0x0,0x0,0x0,0x0,0x0,0x0,0x0,0x0
.long 0x0,0x0,0x0,0x0,0x0,0x0,0x0,0x0
.long 0x0,0x0,0x0,0x0,0x0,0x0,0x0,0x0
.long 0x0,0x0,0x0,0x0,0x0,0x0,0x0,0x0
.long 0x0,0x0,0x0,0x0,0x0,0x0,0x0,0x0
.long 0x0,0x0,0x0,0x0,0x0,0x0,0x0,0x0
.long 0x0,0x0,0x0,0x0,0x3f80,0x0,0x0,0x0
.long 0x3f803f80,0x0,0x0,0x0,0x3f803f80,0x3f80,0x0,0x0
.long 0x3f800000,0x3f803f80,0x0,0x0,0x0,0x3f803f80,0x3f80,0x0
.long 0x0,0x0,0x0,0x3f803f80,0x0,0x0,0x0,0x3f800000
.long 0x0,0x0,0x0,0x0,0x0,0x0,0x0,0x0
.long 0x0,0x0,0x0,0x0,0x0,0x0,0x0,0x0
.long 0x0,0x0,0x0,0x0,0x0,0x0,0x0,0x0
.long 0x0,0x0,0x0,0x0,0x0,0x0,0x0,0x0
.long 0x0,0x0,0x0,0x0,0x0,0x0,0x0,0x0
.long 0x0,0x0,0x0,0x0,0x0,0x0,0x0,0x0
.long 0x0,0x0,0x0,0x0,0x0,0x0,0x0,0x0
.long 0x3f803f80,0x3f80,0x0,0x0,0x3f803f80,0x3f803f80,0x0,0x0
.long 0x3f803f80,0x3f803f80,0x3f80,0x0,0x3f800000,0x3f803f80,0x3f803f80,0x0
.long 0x0,0x3f803f80,0x3f803f80,0x3f80,0x0,0x3f800000,0x3f803f80,0x3f803f80
.long 0x0,0x0,0x3f803f80,0x3f803f80,0x0,0x0,0x3f800000,0x3f803f80
.long 0x0,0x0,0x0,0x3f803f80,0x0,0x0,0x0,0x3f800000
.long 0x0,0x0,0x0,0x0,0x0,0x0,0x0,0x0
.long 0x0,0x0,0x0,0x0,0x0,0x0,0x0,0x0
.long 0x0,0x0,0x0,0x0,0x0,0x0,0x0,0x0
.long 0x0,0x0,0x0,0x0,0x0,0x0,0x0,0x0
.long 0x0,0x0,0x0,0x0,0x0,0x0,0x0,0x0
.long 0x0,0x0,0x0,0x0,0x0,0x0,0x0,0x0
.long 0x3f80,0x0,0x0,0x0,0x3f803f80,0x0,0x0,0x0
.long 0x3f803f80,0x3f80,0x0,0x0,0x3f803f80,0x3f803f80,0x0,0x0
.long 0x3f803f80,0x3f803f80,0x3f80,0x0,0x3f800000,0x3f803f80,0x3f803f80,0x0
.long 0x0,0x3f803f80,0x3f803f80,0x3f80,0x0,0x3f800000,0x3f803f80,0x3f803f80
.long 0x0,0x0,0x3f803f80,0x3f803f80,0x0,0x0,0x3f800000,0x3f803f80
.long 0x0,0x0,0x0,0x0,0x0,0x0,0x0,0x0
.long 0x0,0x0,0x0,0x0,0x0,0x0,0x0,0x0
.long 0x0,0x0,0x0,0x0,0x0,0x0,0x0,0x0
.long 0x0,0x0,0x0,0x0,0x0,0x0,0x0,0x0
.long 0x0,0x0,0x0,0x0,0x0,0x0,0x0,0x0
.long 0x0,0x0,0x0,0x0,0x0,0x0,0x0,0x0
.long 0x0,0x0,0x0,0x0,0x0,0x0,0x0,0x0
.long 0x3f80,0x0,0x0,0x0,0x3f803f80,0x0,0x0,0x0
.long 0x0,0x3f800000,0x3f803f80,0x0,0x0,0x0,0x3f803f80,0x3f80
.long 0x0,0x0,0x3f800000,0x3f803f80,0x0,0x0,0x0,0x3f803f80
.long 0x0,0x0,0x0,0x3f800000,0x0,0x0,0x0,0x0
.long 0x0,0x0,0x0,0x0,0x0,0x0,0x0,0x0
.long 0x0,0x0,0x0,0x0,0x0,0x0,0x0,0x0
.long 0x0,0x0,0x0,0x0,0x0,0x0,0x0,0x0
.long 0x0,0x0,0x0,0x0,0x0,0x0,0x0,0x0
.long 0x0,0x0,0x0,0x0,0x0,0x0,0x0,0x0
.long 0x0,0x0,0x0,0x0,0x0,0x0,0x0,0x0
.long 0x0,0x0,0x0,0x0,0x3f80,0x0,0x0,0x0
.long 0x3f803f80,0x0,0x0,0x0,0x3f803f80,0x3f80,0x0,0x0
.long 0x3f800000,0x3f803f80,0x0,0x0,0x0,0x3f803f80,0x3f80,0x0
.long 0x0,0x3f800000,0x3f803f80,0x0,0x0,0x0,0x3f803f80,0x3f80
.long 0x0,0x0,0x3f800000,0x3f803f80,0x0,0x0,0x0,0x3f803f80
.long 0x0,0x0,0x0,0x3f800000,0x0,0x0,0x0,0x0
.long 0x0,0x0,0x0,0x0,0x0,0x0,0x0,0x0
.long 0x0,0x0,0x0,0x0,0x0,0x0,0x0,0x0
.long 0x0,0x0,0x0,0x0,0x0,0x0,0x0,0x0
.long 0x0,0x0,0x0,0x0,0x0,0x0,0x0,0x0
.long 0x0,0x0,0x0,0x0,0x0,0x0,0x0,0x0
.long 0x0,0x0,0x0,0x0,0x0,0x0,0x0,0x0
.long 0x0,0x0,0x0,0x0,0x3f80,0x0,0x0,0x0
.long 0x3f803f80,0x0,0x0,0x0,0x3f803f80,0x3f80,0x0,0x0
.long 0x3f800000,0x3f803f80,0x0,0x0,0x0,0x3f803f80,0x3f80,0x0
.long 0x0,0x0,0x0,0x0,0x0,0x0,0x0,0x0
.long 0x0,0x0,0x0,0x0,0x0,0x0,0x0,0x0
.long 0x0,0x0,0x0,0x0,0x0,0x0,0x0,0x0
.long 0x0,0x0,0x0,0x0,0x0,0x0,0x0,0x0
.long 0x0,0x0,0x0,0x0,0x0,0x0,0x0,0x0
.long 0x0,0x0,0x0,0x0,0x0,0x0,0x0,0x0
.long 0x0,0x0,0x0,0x0,0x0,0x0,0x0,0x0
.long 0x0,0x0,0x0,0x0,0x0,0x0,0x0,0x0
.long 0x0,0x0,0x3f800000,0x3f803f80,0x0,0x0,0x0,0x3f803f80
.long 0x0,0x0,0x0,0x3f800000,0x0,0x0,0x0,0x0
.long 0x0,0x0,0x0,0x0,0x0,0x0,0x0,0x0
.long 0x0,0x0,0x0,0x0,0x0,0x0,0x0,0x0
.long 0x0,0x0,0x0,0x0,0x0,0x0,0x0,0x0
.long 0x0,0x0,0x0,0x0,0x0,0x0,0x0,0x0
.long 0x0,0x0,0x0,0x0,0x0,0x0,0x0,0x0
.long 0x0,0x0,0x0,0x0,0x0,0x0,0x0,0x0
.long 0x3f803f80,0x3f803f80,0x0,0x0,0x3f803f80,0x3f803f80,0x3f80,0x0
.long 0x3f803f80,0x3f803f80,0x3f803f80,0x0,0x3f803f80,0x3f803f80,0x3f803f80,0x3f80
.long 0x3f800000,0x3f803f80,0x3f803f80,0x3f803f80,0x0,0x3f803f80,0x3f803f80,0x3f803f80
.long 0x0,0x3f800000,0x3f803f80,0x3f803f80,0x0,0x0,0x3f803f80,0x3f803f80
.long 0x0,0x0,0x3f800000,0x3f803f80,0x0,0x0,0x0,0x3f803f80
.long 0x0,0x0,0x0,0x3f800000,0x0,0x0,0x0,0x0
.long 0x0,0x0,0x0,0x0,0x0,0x0,0x0,0x0
.long 0x0,0x0,0x0,0x0,0x0,0x0,0x0,0x0
.long 0x0,0x0,0x0,0x0,0x0,0x0,0x0,0x0
.long 0x0,0x0,0x0,0x0,0x0,0x0,0x0,0x0
.long 0x0,0x0,0x0,0x0,0x3f80,0x0,0x0,0x0
.long 0x3f803f80,0x0,0x0,0x0,0x3f803f80,0x3f80,0x0,0x0
.long 0x3f803f80,0x3f803f80,0x0,0x0,0x3f803f80,0x3f803f80,0x3f80,0x0
.long 0x3f803f80,0x3f803f80,0x3f803f80,0x0,0x3f803f80,0x3f803f80,0x3f803f80,0x3f80
.long 0x3f800000,0x3f803f80,0x3f803f80,0x3f803f80,0x0,0x3f803f80,0x3f803f80,0x3f803f80
.long 0x0,0x3f800000,0x3f803f80,0x3f803f80,0x0,0x0,0x3f803f80,0x3f803f80
.long 0x0,0x0,0x0,0x0,0x0,0x0,0x0,0x0
.long 0x0,0x0,0x0,0x0,0x0,0x0,0x0,0x0
.long 0x0,0x0,0x0,0x0,0x0,0x0,0x0,0x0
.long 0x0,0x0,0x0,0x0,0x0,0x0,0x0,0x0
.long 0x0,0x0,0x0,0x0,0x0,0x0,0x0,0x0
.long 0x0,0x0,0x0,0x0,0x0,0x0,0x0,0x0
.long 0x0,0x0,0x0,0x0,0x3f80,0x0,0x0,0x0
.long 0x3f803f80,0x0,0x0,0x0,0x3f803f80,0x3f80,0x0,0x0
.long 0x0,0x0,0x3f803f80,0x3f803f80,0x0,0x0,0x3f800000,0x3f803f80
.long 0x0,0x0,0x0,0x3f803f80,0x0,0x0,0x0,0x3f800000
.long 0x0,0x0,0x0,0x0,0x0,0x0,0x0,0x0
.long 0x0,0x0,0x0,0x0,0x0,0x0,0x0,0x0
.long 0x0,0x0,0x0,0x0,0x0,0x0,0x0,0x0
.long 0x0,0x0,0x0,0x0,0x0,0x0,0x0,0x0
.long 0x0,0x0,0x0,0x0,0x0,0x0,0x0,0x0
.long 0x0,0x0,0x0,0x0,0x0,0x0,0x0,0x0
.long 0x3f803f80,0x3f803f80,0x3f80,0x0,0x3f803f80,0x3f803f80,0x3f803f80,0x0
.long 0x3f803f80,0x3f803f80,0x3f803f80,0x3f80,0x3f803f80,0x3f803f80,0x3f803f80,0x3f803f80
.long 0x3f803f80,0x3f803f80,0x3f803f80,0x3f803f80,0x3f800000,0x3f803f80,0x3f803f80,0x3f803f80
.long 0x0,0x3f803f80,0x3f803f80,0x3f803f80,0x0,0x3f800000,0x3f803f80,0x3f803f80
.long 0x0,0x0,0x3f803f80,0x3f803f80,0x0,0x0,0x3f800000,0x3f803f80
.long 0x0,0x0,0x0,0x3f803f80,0x0,0x0,0x0,0x3f800000
.long 0x0,0x0,0x0,0x0,0x0,0x0,0x0,0x0
.long 0x0,0x0,0x0,0x0,0x0,0x0,0x0,0x0
.long 0x0,0x0,0x0,0x0,0x0,0x0,0x0,0x0
.long 0x0,0x0,0x0,0x0,0x0,0x0,0x0,0x0
.long 0x3f80,0x0,0x0,0x0,0x3f803f80,0x0,0x0,0x0
.long 0x3f803f80,0x3f80,0x0,0x0,0x3f803f80,0x3f803f80,0x0,0x0
.long 0x3f803f80,0x3f803f80,0x3f80,0x0,0x3f803f80,0x3f803f80,0x3f803f80,0x0
.long 0x3f803f80,0x3f803f80,0x3f803f80,0x3f80,0x3f803f80,0x3f803f80,0x3f803f80,0x3f803f80
.long 0x3f803f80,0x3f803f80,0x3f803f80,0x3f803f80,0x3f800000,0x3f803f80,0x3f803f80,0x3f803f80
.long 0x0,0x3f803f80,0x3f803f80,0x3f803f80,0x0,0x3f800000,0x3f803f80,0x3f803f80
.long 0x0,0x0,0x0,0x0,0x0,0x0,0x0,0x0
.long 0x0,0x0,0x0,0x0,0x0,0x0,0x0,0x0
.long 0x0,0x0,0x0,0x0,0x0,0x0,0x0,0x0
.long 0x0,0x0,0x0,0x0,0x0,0x0,0x0,0x0
.long 0x0,0x0,0x0,0x0,0x0,0x0,0x0,0x0
.long 0x0,0x0,0x0,0x0,0x0,0x0,0x0,0x0
.long 0x3f80,0x0,0x0,0x0,0x3f803f80,0x0,0x0,0x0
.long 0x3f803f80,0x3f80,0x0,0x0,0x3f803f80,0x3f803f80,0x0,0x0
.long 0x0,0x0,0x0,0x0,0x0,0x0,0x0,0x0
.long 0x0,0x0,0x0,0x0,0x0,0x0,0x0,0x0
.long 0x0,0x0,0x0,0x0,0x0,0x0,0x0,0x0
.long 0x0,0x0,0x0,0x0,0x0,0x0,0x0,0x0
.long 0x0,0x0,0x0,0x0,0x0,0x0,0x0,0x0
.long 0x0,0x0,0x0,0x0,0x0,0x0,0x0,0x0
.long 0x0,0x0,0x0,0x0,0x0,0x0,0x0,0x0
.long 0x0,0x0,0x0,0x0,0x0,0x0,0x0,0x0
.long 0x0,0x0,0xffffffff,0x0,0x0,0x0,0xffff0000,0xffff
.long 0x0,0x0,0x0,0xffffffff,0x0,0x0,0x0,0xffff0000
.long 0x0,0x0,0x0,0x0,0x0,0x0,0x0,0x0
.long 0x0,0x0,0x0,0x0,0x0,0x0,0x0,0x0
.long 0x0,0x0,0x0,0x0,0x0,0x0,0x0,0x0
.long 0x0,0x0,0x0,0x0,0x0,0x0,0x0,0x0
.long 0x0,0x0,0x0,0x0,0x0,0x0,0x0,0x0
.long 0x0,0x0,0x0,0x0,0x0,0x0,0x0,0x0
.long 0x0,0x0,0x0,0x0,0x0,0x0,0x0,0x0
.long 0x0,0x0,0x0,0x0,0xffff,0x0,0x0,0x0
.long 0xffffffff,0x0,0x0,0x0,0xffff0000,0xffff,0x0,0x0
.long 0x0,0xffffffff,0x0,0x0,0x0,0xffff0000,0xffff,0x0
.long 0x0,0x0,0xffffffff,0x0,0x0,0x0,0xffff0000,0xffff
.long 0x0,0x0,0x0,0xffffffff,0x0,0x0,0x0,0xffff0000
.long 0x0,0x0,0x0,0x0,0x0,0x0,0x0,0x0
.long 0x0,0x0,0x0,0x0,0x0,0x0,0x0,0x0
.long 0x0,0x0,0x0,0x0,0x0,0x0,0x0,0x0
.long 0x0,0x0,0x0,0x0,0x0,0x0,0x0,0x0
.long 0x0,0x0,0x0,0x0,0x0,0x0,0x0,0x0
.long 0x0,0x0,0x0,0x0,0x0,0x0,0x0,0x0
.long 0x0,0x0,0x0,0x0,0x0,0x0,0x0,0x0
.long 0x0,0x0,0x0,0x0,0xffff,0x0,0x0,0x0
.long 0xffffffff,0x0,0x0,0x0,0xffff0000,0xffff,0x0,0x0
.long 0x0,0xffffffff,0x0,0x0,0x0,0xffff0000,0xffff,0x0
.long 0x3f80,0x0,0x3f80,0x0,0x3f800000,0x0,0x3f800000,0x0
.long 0x0,0x3f80,0x0,0x3f80,0x0,0x3f800000,0x0,0x3f800000
.long 0x3f80,0x0,0x3f80,0x0,0x3f800000,0x0,0x3f800000,0x0
.long 0x0,0x3f80,0x0,0x3f80,0x0,0x3f800000,0x0,0x3f800000
.long 0x3f80,0x0,0x3f80,0x0,0x3f800000,0x0,0x3f800000,0x0
.long 0x0,0x3f80,0x0,0x3f80,0x0,0x3f800000,0x0,0x3f800000
.long 0x3f80,0x0,0x3f80,0x0,0x3f800000,0x0,0x3f800000,0x0
.long 0x0,0x3f80,0x0,0x3f80,0x0,0x3f800000,0x0,0x3f800000
.long 0x3f80,0x0,0x3f80,0x0,0x3f800000,0x0,0x3f800000,0x0
.long 0x0,0x3f80,0x0,0x3f80,0x0,0x3f800000,0x0,0x3f800000
.long 0x3f80,0x0,0x3f80,0x0,0x3f800000,0x0,0x3f800000,0x0
.long 0x0,0x3f80,0x0,0x3f80,0x0,0x3f800000,0x0,0x3f800000
.long 0x3f80,0x0,0x3f80,0x0,0x3f800000,0x0,0x3f800000,0x0
.long 0x0,0x3f80,0x0,0x3f80,0x0,0x3f800000,0x0,0x3f800000
.long 0x3f80,0x0,0x3f80,0x0,0x3f800000,0x0,0x3f800000,0x0
.long 0x0,0x3f80,0x0,0x3f80,0x0,0x3f800000,0x0,0x3f800000
.long 0x3f80,0x0,0x3f80,0x0,0x3f800000,0x0,0x3f800000,0x0
.long 0x0,0x3f80,0x0,0x3f80,0x0,0x3f800000,0x0,0x3f800000
.long 0x3f80,0x0,0x3f80,0x0,0x3f800000,0x0,0x3f800000,0x0
.long 0x0,0x3f80,0x0,0x3f80,0x0,0x3f800000,0x0,0x3f800000
.long 0x3f80,0x0,0x3f80,0x0,0x3f800000,0x0,0x3f800000,0x0
.long 0x0,0x3f80,0x0,0x3f80,0x0,0x3f800000,0x0,0x3f800000
.long 0x3f80,0x0,0x3f80,0x0,0x3f800000,0x0,0x3f800000,0x0
.long 0x0,0x3f80,0x0,0x3f80,0x0,0x3f800000,0x0,0x3f800000
.long 0x3f80,0x0,0x3f80,0x0,0x3f800000,0x0,0x3f800000,0x0
.long 0x0,0x3f80,0x0,0x3f80,0x0,0x3f800000,0x0,0x3f800000
.long 0x3f80,0x0,0x3f80,0x0,0x3f800000,0x0,0x3f800000,0x0
.long 0x0,0x3f80,0x0,0x3f80,0x0,0x3f800000,0x0,0x3f800000
.long 0x3f80,0x0,0x3f80,0x0,0x3f800000,0x0,0x3f800000,0x0
.long 0x0,0x3f80,0x0,0x3f80,0x0,0x3f800000,0x0,0x3f800000
.long 0x3f80,0x0,0x3f80,0x0,0x3f800000,0x0,0x3f800000,0x0
.long 0x0,0x3f80,0x0,0x3f80,0x0,0x3f800000,0x0,0x3f800000
.long 0x0,0x0,0x0,0x0,0x0,0x0,0x0,0x0
.long 0x0,0x0,0x0,0x0,0x0,0x0,0x0,0x0
.long 0x0,0x0,0x0,0x0,0x0,0x0,0x0,0x0
.long 0x0,0x0,0x0,0x0,0x0,0x0,0x0,0x0
.long 0x0,0x0,0x0,0x0,0x0,0x0,0x0,0x0
.long 0x0,0x0,0x0,0x0,0x0,0x0,0x0,0x0
.long 0x0,0x0,0x0,0x0,0x0,0x0,0x0,0x0
.long 0x0,0x0,0x0,0x0,0x0,0x0,0x0,0x0
.long 0x0,0x0,0x0,0x0,0x0,0x0,0x0,0x0
.long 0x0,0x0,0x0,0x0,0x0,0x0,0x0,0x0
.long 0x0,0x0,0x0,0x0,0x0,0x0,0x0,0x0
.long 0x0,0x0,0x0,0x0,0x0,0x0,0x0,0x0
.long 0x0,0x0,0x0,0x0,0x0,0x0,0x0,0x0
.long 0x0,0x0,0x0,0x0,0x0,0x0,0x0,0x0
.long 0x0,0x0,0x0,0x0,0x0,0x0,0x0,0x0
.long 0x0,0x0,0x0,0x0,0x0,0x0,0x0,0x0
.long 0x0,0x0,0x0,0x0,0x0,0x0,0x0,0x0
.long 0x0,0x0,0x0,0x0,0x0,0x0,0x0,0x0
.long 0x0,0x0,0x0,0x0,0x0,0x0,0x0,0x0
.long 0x0,0x0,0x0,0x0,0x0,0x0,0x0,0x0
.long 0x0,0x0,0x0,0x0,0x0,0x0,0x0,0x0
.long 0x0,0x0,0x0,0x0,0x0,0x0,0x0,0x0
.long 0x0,0x0,0x0,0x0,0x0,0x0,0x0,0x0
.long 0x0,0x0,0x0,0x0,0x0,0x0,0x0,0x0
.long 0x0,0x0,0x0,0x0,0x0,0x0,0x0,0x0
.long 0x0,0x0,0x0,0x0,0x0,0x0,0x0,0x0
.long 0x0,0x0,0x0,0x0,0x0,0x0,0x0,0x0
.long 0x0,0x0,0x0,0x0,0x0,0x0,0x0,0x0
.long 0x0,0x0,0x0,0x0,0x0,0x0,0x0,0x0
.long 0x0,0x0,0x0,0x0,0x0,0x0,0x0,0x0
.long 0x0,0x0,0x0,0x0,0x0,0x0,0x0,0x0
.long 0x0,0x0,0x0,0x0,0x0,0x0,0x0,0x0
L_codeend:
L_z1:
L_z2:
.section .rodata,"a"
.p2align 6
.amdhsa_kernel concat_heads__linear_kernel_hedgehog__ssm_conv_s4d__prompt_kernel
  .amdhsa_next_free_vgpr 512
  .amdhsa_next_free_sgpr 102
  .amdhsa_accum_offset 256
  .amdhsa_group_segment_fixed_size 0
  .amdhsa_kernarg_size 112
  .amdhsa_user_sgpr_count 2
  .amdhsa_user_sgpr_kernarg_segment_ptr 1
  .amdhsa_system_sgpr_workgroup_id_x 1
.end_amdhsa_kernel
```
